```python
import torch

def _softmax(x, axis=-1):
    return torch.softmax(x, dim=axis)

def _gelu(x):
    return torch.nn.functional.gelu(x, approximate='tanh')

def _silu(x):
    return torch.nn.functional.silu(x)

def _sigmoid(x):
    return torch.sigmoid(x)

def _layernorm(x, axis=-1, eps=1e-05):
    m = x.mean(dim=axis, keepdim=True)
    v = x.var(dim=axis, keepdim=True, unbiased=False)
    return (x - m) / torch.sqrt(v + eps)

def _scatter_add(tgt, idx, src, axis=0):
    return tgt.clone().index_add_(axis, idx, src)

def _segment_sum(src, seg, n):
    out = torch.zeros((n,) + src.shape[1:], dtype=src.dtype)
    return out.index_add_(0, seg, src)

def _pad(x, pw):
    flat = tuple((v for pair in reversed(pw) for v in pair))
    return torch.nn.functional.pad(x, flat)
kernel_name = 'adaLN_cond__memory_aug_recurrent_mem_tr__glu_gated_bilinear__prompt'

def setup_inputs():

    _w = lambda a: (lambda t: t.to(torch.bfloat16) if t.is_floating_point() else t)(torch.as_tensor(a))

    def _A_setup():
        B, S, Dm = (1, 2048, 512)
        H, Dh = (32, 128)
        M, seg = (8, 32)
        seg = min(seg, S)
        S = S // seg * seg
        return {'x': _w((lambda *s: torch.randn(*s, dtype=torch.bfloat16) * 0.05)(B, S, Dm)), 'mem0': _w((lambda *s: torch.randn(*s, dtype=torch.bfloat16) * 0.8)(B, M, Dm)), 'Wq': _w((lambda *s: torch.randn(*s, dtype=torch.bfloat16) * 1.6)(Dm, H, Dh) * Dm ** (-0.5)), 'Wk': _w((lambda *s: torch.randn(*s, dtype=torch.bfloat16) * 1.6)(Dm, H, Dh) * Dm ** (-0.5)), 'Wv': _w((lambda *s: torch.randn(*s, dtype=torch.bfloat16) * 0.8)(Dm, H, Dh) * Dm ** (-0.5)), 'Wo': _w((lambda *s: torch.randn(*s, dtype=torch.bfloat16) * 0.8)(H, Dh, Dm) * (H * Dh) ** (-0.5)), 'seg_len': seg}
    _A_in = _A_setup()

    def _B_setup():
        B, S, D, F = (1, 2048, 512, 1792)
        return {'x': _w((lambda *s: torch.randn(*s, dtype=torch.bfloat16) * 0.05)(B, S, D)), 'w_gate': _w((lambda *s: torch.randn(*s, dtype=torch.bfloat16) * 0.8)(D, F) * D ** (-0.5)), 'w_up': _w((lambda *s: torch.randn(*s, dtype=torch.bfloat16) * 0.8)(D, F) * D ** (-0.5)), 'w_down': _w((lambda *s: torch.randn(*s, dtype=torch.bfloat16) * 0.8)(F, D) * F ** (-0.5))}
    _B_in = _B_setup()
    return {'A_x': _A_in['x'], 'A_mem0': _A_in['mem0'], 'A_Wq': _A_in['Wq'], 'A_Wk': _A_in['Wk'], 'A_Wv': _A_in['Wv'], 'A_Wo': _A_in['Wo'], 'A_seg_len': _A_in['seg_len'], 'B_x': _B_in['x'], 'B_w_gate': _B_in['w_gate'], 'B_w_up': _B_in['w_up'], 'B_w_down': _B_in['w_down'], 'c': _w((lambda *s: torch.randn(*s, dtype=torch.bfloat16) * 0.1)(1, 512) * 8.0), 'w_mod': _w((lambda *s: torch.randn(*s, dtype=torch.bfloat16) * 0.1)(512, 6 * 512) * 512 ** (-0.5) * 8.0)}

def reference(A_x, A_mem0, A_Wq, A_Wk, A_Wv, A_Wo, A_seg_len, B_x, B_w_gate, B_w_up, B_w_down, c, w_mod):

    def _A_ref(x, mem0, Wq, Wk, Wv, Wo, seg_len):
        B, S, Dm = x.shape
        H, Dh = (Wq.shape[1], Wq.shape[2])
        M = mem0.shape[1]
        scale = Dh ** (-0.5)
        n_seg = S // seg_len
        L = M + seg_len
        idx = torch.arange(L)
        mask = (idx[:, None] < M) | (idx[:, None] >= idx[None, :])
        mem = mem0
        outs = []
        for s in range(n_seg):
            xs = x[:, s * seg_len:(s + 1) * seg_len, :].clone()
            h = torch.concatenate([mem, xs], axis=1)
            q = torch.einsum('btd,dhe->bhte', h, Wq)
            k = torch.einsum('btd,dhe->bhte', h, Wk)
            v = torch.einsum('btd,dhe->bhte', h, Wv)
            scores = torch.einsum('bhqe,bhke->bhqk', q, k) * scale
            scores = torch.where(mask[None, None], scores, -1000000000.0)
            p = _softmax(scores, axis=-1)
            o = torch.einsum('bhqk,bhke->bhqe', p, v)
            o = torch.einsum('bhte,hed->btd', o, Wo)
            mem = o[:, :M, :].clone()
            outs.append(o[:, M:, :])
        return torch.concatenate(outs, axis=1)

    def _B_ref(x, w_gate, w_up, w_down):
        g = torch.einsum('bsd,df->bsf', x, w_gate)
        u = torch.einsum('bsd,df->bsf', x, w_up)
        h = g * u
        return torch.einsum('bsf,fd->bsd', h, w_down)
    x = A_x
    mod = (_silu(c) @ w_mod).reshape(c.shape[0], 6, 1, -1)
    sa, ca, ga, sb, cb, gb = (mod[:, 0].clone(), mod[:, 1].clone(), mod[:, 2].clone(), mod[:, 3].clone(), mod[:, 4].clone(), mod[:, 5].clone())
    h = _layernorm(x, axis=-1) * (1 + ca) + sa
    x = x + ga * _A_ref(h, A_mem0, A_Wq, A_Wk, A_Wv, A_Wo, A_seg_len)
    h = _layernorm(x, axis=-1) * (1 + cb) + sb
    x = x + gb * _B_ref(h, B_w_gate, B_w_up, B_w_down)
    return x
```

```asm
; @launch grid=(256,1,1) block=(256,1,1) lds=163840
.amdgcn_target "amdgcn-amd-amdhsa--gfx950"
.text
.globl adaLN_cond__memory_aug_recurrent_mem_tr__glu_gated_bilinear__prompt_kernel
.p2align 8
.type adaLN_cond__memory_aug_recurrent_mem_tr__glu_gated_bilinear__prompt_kernel,@function
adaLN_cond__memory_aug_recurrent_mem_tr__glu_gated_bilinear__prompt_kernel:
    s_cmp_ge_u32 s2, 256
    s_cbranch_scc1 L_exit
    s_load_dwordx4 s[48:51], s[0:1], 112
    s_load_dwordx16 s[32:47], s[0:1], 0
    s_getreg_b32 s3, hwreg(HW_REG_XCC_ID)
    s_and_b32 s3, s3, 7
    s_lshl_b32 s16, s3, 2
    s_lshr_b32 s3, 0x74350126, s16
    s_and_b32 s3, s3, 7
    v_lshrrev_b32 v1, 6, v0
    s_lshr_b32 s14, s2, 3
    v_readfirstlane_b32 s15, v1
    s_mov_b32 s75, 0
    s_waitcnt lgkmcnt(0)
    s_mov_b32 s12, s48
    s_mov_b32 s13, s49
    s_mov_b32 s4, s50
    s_and_b32 s5, s51, 0xffff
    s_mov_b32 s6, 0x10000000
    s_mov_b32 s7, 0x00020000
    s_getpc_b64 s[16:17]
    s_and_b32 s16, s16, 0xffffff00
    s_lshl_b32 s18, s14, 12
    s_lshl_b32 s19, s15, 10
    s_add_u32 s18, s18, s19
    v_and_b32 v123, 7, v0
    v_lshlrev_b32 v123, 7, v123
    v_add_u32 v123, s18, v123
    v_min_u32 v123, CODE_BYTES, v123
    s_mov_b64 exec, 0xff
    global_load_dword v122, v123, s[16:17]
    s_mov_b64 exec, -1
L_role:
    s_cmp_eq_u32 s3, 1
    s_cbranch_scc1 L_P
    s_cmp_ge_u32 s3, 4
    s_cbranch_scc1 L_T
    s_cmp_ge_u32 s3, 2
    s_cbranch_scc1 L_G
    s_load_dwordx16 s[32:47], s[0:1], 0
    s_waitcnt lgkmcnt(0)
    v_bfe_u32 v31, v0, 5, 1
    v_lshlrev_b32 v28, 5, v31
    v_bfe_u32 v31, v0, 0, 4
    v_lshlrev_b32 v29, 4, v31
    v_xor_b32 v28, v28, v29
    v_bfe_u32 v31, v0, 4, 2
    v_lshlrev_b32 v30, 13, v31
    v_add_u32 v32, v28, v30
    v_xor_b32 v33, 64, v32
    v_xor_b32 v34, 128, v32
    v_xor_b32 v35, 192, v32
    s_bfe_u32 s50, s14, 0x50000
    s_lshl_b32 s50, s50, 8
    s_bfe_u32 s49, s15, 0x20000
    s_lshl_b32 s49, s49, 18
    s_add_u32 s50, s50, s49
    s_bfe_u32 s51, s15, 0x20000
    s_lshl_b32 s51, s51, 13
    s_add_u32 s51, s51, 0x8000
    s_mov_b32 s8, s36
    s_and_b32 s9, s37, 0xffff
    s_mov_b32 s10, 0x400000
    s_mov_b32 s11, 0x00020000
    s_mov_b32 m0, s51
    s_mov_b32 s48, s50
    s_movk_i32 s16, 0x400
    s_mov_b32 s17, 0x8000
    s_mov_b32 s18, 4
R_d0:
    buffer_load_dwordx4 v32, s[8:11], s48 offen lds
    s_add_u32 m0, m0, s16
    s_add_u32 s48, s48, s17
    buffer_load_dwordx4 v33, s[8:11], s48 offen lds
    s_add_u32 m0, m0, s16
    s_add_u32 s48, s48, s17
    buffer_load_dwordx4 v32, s[8:11], s48 offen lds
    s_add_u32 m0, m0, s16
    s_add_u32 s48, s48, s17
    buffer_load_dwordx4 v33, s[8:11], s48 offen lds
    s_add_u32 m0, m0, s16
    s_add_u32 s48, s48, s17
    buffer_load_dwordx4 v34, s[8:11], s48 offen lds
    s_add_u32 m0, m0, s16
    s_add_u32 s48, s48, s17
    buffer_load_dwordx4 v35, s[8:11], s48 offen lds
    s_add_u32 m0, m0, s16
    s_add_u32 s48, s48, s17
    buffer_load_dwordx4 v34, s[8:11], s48 offen lds
    s_add_u32 m0, m0, s16
    s_add_u32 s48, s48, s17
    buffer_load_dwordx4 v35, s[8:11], s48 offen lds
    s_add_u32 m0, m0, s16
    s_add_u32 s48, s48, s17
    s_add_u32 m0, m0, 24576
    s_add_u32 s48, s48, 0xc0000
    s_sub_u32 s18, s18, 1
    s_cmp_lg_u32 s18, 0
    s_cbranch_scc1 R_d0
    s_branch R_cont
L_P:
    s_mov_b32 s16, s14
L_Ploop:
    s_load_dwordx2 s[32:33], s[0:1], 0
    s_load_dwordx4 s[36:39], s[0:1], 88
    s_mov_b32 s17, 0xffff0000
    v_bfe_u32 v31, v0, 0, 4
    v_lshlrev_b32 v1, 10, v31
    v_bfe_u32 v31, v0, 4, 2
    v_lshl_add_u32 v1, v31, 4, v1
    v_bfe_u32 v31, v0, 6, 2
    v_lshl_add_u32 v1, v31, 8, v1
    s_lshl_b32 s48, s16, 14
    s_waitcnt lgkmcnt(0)
    s_mov_b32 s8, s32
    s_and_b32 s9, s33, 0xffff
    s_mov_b32 s10, 0x200000
    s_mov_b32 s11, 0x00020000
    buffer_load_dwordx4 v[32:35], v1, s[8:11], s48 offen offset:0
    buffer_load_dwordx4 v[36:39], v1, s[8:11], s48 offen offset:64
    buffer_load_dwordx4 v[40:43], v1, s[8:11], s48 offen offset:128
    buffer_load_dwordx4 v[44:47], v1, s[8:11], s48 offen offset:192
    s_cmp_lt_u32 s16, 96
    s_cbranch_scc1 P_mod
    s_waitcnt vmcnt(0)
    s_branch P_nomod
P_mod:
    s_mov_b32 s40, s36
    s_and_b32 s41, s37, 0xffff
    s_mov_b32 s42, 0x400
    s_mov_b32 s43, 0x00020000
    s_mov_b32 s44, s38
    s_and_b32 s45, s39, 0xffff
    s_mov_b32 s46, 0x300000
    s_mov_b32 s47, 0x00020000
    v_bfe_u32 v31, v0, 2, 6
    v_lshlrev_b32 v2, 4, v31
    buffer_load_dwordx4 v[4:7], v2, s[40:43], 0 offen
    v_lshrrev_b32 v2, 2, v0
    v_mul_u32_u24 v2, 49152, v2
    v_and_b32 v3, 3, v0
    v_lshl_add_u32 v2, v3, 4, v2
    s_lshl_b32 s48, s16, 6
    buffer_load_dwordx4 v[64:67], v2, s[44:47], s48 offen
    s_add_u32 s48, s48, 6144
    buffer_load_dwordx4 v[68:71], v2, s[44:47], s48 offen
    s_add_u32 s48, s48, 6144
    buffer_load_dwordx4 v[72:75], v2, s[44:47], s48 offen
    s_add_u32 s48, s48, 6144
    buffer_load_dwordx4 v[76:79], v2, s[44:47], s48 offen
    s_add_u32 s48, s48, 6144
    buffer_load_dwordx4 v[80:83], v2, s[44:47], s48 offen
    s_add_u32 s48, s48, 6144
    buffer_load_dwordx4 v[84:87], v2, s[44:47], s48 offen
    s_add_u32 s48, s48, 6144
    buffer_load_dwordx4 v[88:91], v2, s[44:47], s48 offen
    s_add_u32 s48, s48, 6144
    buffer_load_dwordx4 v[92:95], v2, s[44:47], s48 offen
    s_or_b32 s48, s75, s15
    s_cbranch_scc1 cl_1
    s_lshl_b32 s48, s3, 2
    s_add_u32 s48, s48, 60
    s_cmp_eq_u32 s3, 0
    s_cselect_b32 s48, 0, s48
    s_lshl_b32 s49, 1, s14
    v_mov_b32 v124, s48
    v_mov_b32 v125, s49
    s_mov_b64 exec, 1
    global_atomic_or v126, v124, v125, s[12:13] sc0
    s_mov_b64 exec, -1
cl_1:
    s_waitcnt vmcnt(8)
    v_lshlrev_b32 v8, 16, v4
    v_and_b32 v9, s17, v4
    v_lshlrev_b32 v10, 16, v5
    v_and_b32 v11, s17, v5
    v_lshlrev_b32 v12, 16, v6
    v_and_b32 v13, s17, v6
    v_lshlrev_b32 v14, 16, v7
    v_and_b32 v15, s17, v7
    s_mov_b32 s48, 0xbfb8aa3b
    v_mul_f32 v16, s48, v8
    v_mul_f32 v17, s48, v9
    v_mul_f32 v18, s48, v10
    v_mul_f32 v19, s48, v11
    v_mul_f32 v20, s48, v12
    v_mul_f32 v21, s48, v13
    v_mul_f32 v22, s48, v14
    v_mul_f32 v23, s48, v15
    v_exp_f32 v16, v16
    v_exp_f32 v17, v17
    v_exp_f32 v18, v18
    v_exp_f32 v19, v19
    v_exp_f32 v20, v20
    v_exp_f32 v21, v21
    v_exp_f32 v22, v22
    v_exp_f32 v23, v23
    v_add_f32 v16, 1.0, v16
    v_add_f32 v17, 1.0, v17
    v_add_f32 v18, 1.0, v18
    v_add_f32 v19, 1.0, v19
    v_add_f32 v20, 1.0, v20
    v_add_f32 v21, 1.0, v21
    v_add_f32 v22, 1.0, v22
    v_add_f32 v23, 1.0, v23
    v_rcp_f32 v16, v16
    v_rcp_f32 v17, v17
    v_rcp_f32 v18, v18
    v_rcp_f32 v19, v19
    v_rcp_f32 v20, v20
    v_rcp_f32 v21, v21
    v_rcp_f32 v22, v22
    v_rcp_f32 v23, v23
    v_mul_f32 v8, v8, v16
    v_mul_f32 v9, v9, v17
    v_mul_f32 v10, v10, v18
    v_mul_f32 v11, v11, v19
    v_mul_f32 v12, v12, v20
    v_mul_f32 v13, v13, v21
    v_mul_f32 v14, v14, v22
    v_mul_f32 v15, v15, v23
    v_cvt_pk_bf16_f32 v31, v8, v9
    v_lshlrev_b32 v8, 16, v31
    v_and_b32 v9, s17, v31
    v_cvt_pk_bf16_f32 v31, v10, v11
    v_lshlrev_b32 v10, 16, v31
    v_and_b32 v11, s17, v31
    v_cvt_pk_bf16_f32 v31, v12, v13
    v_lshlrev_b32 v12, 16, v31
    v_and_b32 v13, s17, v31
    v_cvt_pk_bf16_f32 v31, v14, v15
    v_lshlrev_b32 v14, 16, v31
    v_and_b32 v15, s17, v31
    v_mov_b32 v16, 0
    v_mov_b32 v17, 0
    v_mov_b32 v18, 0
    v_mov_b32 v19, 0
    v_mov_b32 v20, 0
    v_mov_b32 v21, 0
    v_mov_b32 v22, 0
    v_mov_b32 v23, 0
    s_waitcnt vmcnt(0)
    v_lshlrev_b32 v24, 16, v64
    v_and_b32 v25, s17, v64
    v_fmac_f32 v16, v8, v24
    v_fmac_f32 v17, v8, v25
    v_lshlrev_b32 v24, 16, v65
    v_and_b32 v25, s17, v65
    v_fmac_f32 v18, v8, v24
    v_fmac_f32 v19, v8, v25
    v_lshlrev_b32 v24, 16, v66
    v_and_b32 v25, s17, v66
    v_fmac_f32 v20, v8, v24
    v_fmac_f32 v21, v8, v25
    v_lshlrev_b32 v24, 16, v67
    v_and_b32 v25, s17, v67
    v_fmac_f32 v22, v8, v24
    v_fmac_f32 v23, v8, v25
    v_lshlrev_b32 v24, 16, v68
    v_and_b32 v25, s17, v68
    v_fmac_f32 v16, v9, v24
    v_fmac_f32 v17, v9, v25
    v_lshlrev_b32 v24, 16, v69
    v_and_b32 v25, s17, v69
    v_fmac_f32 v18, v9, v24
    v_fmac_f32 v19, v9, v25
    v_lshlrev_b32 v24, 16, v70
    v_and_b32 v25, s17, v70
    v_fmac_f32 v20, v9, v24
    v_fmac_f32 v21, v9, v25
    v_lshlrev_b32 v24, 16, v71
    v_and_b32 v25, s17, v71
    v_fmac_f32 v22, v9, v24
    v_fmac_f32 v23, v9, v25
    v_lshlrev_b32 v24, 16, v72
    v_and_b32 v25, s17, v72
    v_fmac_f32 v16, v10, v24
    v_fmac_f32 v17, v10, v25
    v_lshlrev_b32 v24, 16, v73
    v_and_b32 v25, s17, v73
    v_fmac_f32 v18, v10, v24
    v_fmac_f32 v19, v10, v25
    v_lshlrev_b32 v24, 16, v74
    v_and_b32 v25, s17, v74
    v_fmac_f32 v20, v10, v24
    v_fmac_f32 v21, v10, v25
    v_lshlrev_b32 v24, 16, v75
    v_and_b32 v25, s17, v75
    v_fmac_f32 v22, v10, v24
    v_fmac_f32 v23, v10, v25
    v_lshlrev_b32 v24, 16, v76
    v_and_b32 v25, s17, v76
    v_fmac_f32 v16, v11, v24
    v_fmac_f32 v17, v11, v25
    v_lshlrev_b32 v24, 16, v77
    v_and_b32 v25, s17, v77
    v_fmac_f32 v18, v11, v24
    v_fmac_f32 v19, v11, v25
    v_lshlrev_b32 v24, 16, v78
    v_and_b32 v25, s17, v78
    v_fmac_f32 v20, v11, v24
    v_fmac_f32 v21, v11, v25
    v_lshlrev_b32 v24, 16, v79
    v_and_b32 v25, s17, v79
    v_fmac_f32 v22, v11, v24
    v_fmac_f32 v23, v11, v25
    v_lshlrev_b32 v24, 16, v80
    v_and_b32 v25, s17, v80
    v_fmac_f32 v16, v12, v24
    v_fmac_f32 v17, v12, v25
    v_lshlrev_b32 v24, 16, v81
    v_and_b32 v25, s17, v81
    v_fmac_f32 v18, v12, v24
    v_fmac_f32 v19, v12, v25
    v_lshlrev_b32 v24, 16, v82
    v_and_b32 v25, s17, v82
    v_fmac_f32 v20, v12, v24
    v_fmac_f32 v21, v12, v25
    v_lshlrev_b32 v24, 16, v83
    v_and_b32 v25, s17, v83
    v_fmac_f32 v22, v12, v24
    v_fmac_f32 v23, v12, v25
    v_lshlrev_b32 v24, 16, v84
    v_and_b32 v25, s17, v84
    v_fmac_f32 v16, v13, v24
    v_fmac_f32 v17, v13, v25
    v_lshlrev_b32 v24, 16, v85
    v_and_b32 v25, s17, v85
    v_fmac_f32 v18, v13, v24
    v_fmac_f32 v19, v13, v25
    v_lshlrev_b32 v24, 16, v86
    v_and_b32 v25, s17, v86
    v_fmac_f32 v20, v13, v24
    v_fmac_f32 v21, v13, v25
    v_lshlrev_b32 v24, 16, v87
    v_and_b32 v25, s17, v87
    v_fmac_f32 v22, v13, v24
    v_fmac_f32 v23, v13, v25
    v_lshlrev_b32 v24, 16, v88
    v_and_b32 v25, s17, v88
    v_fmac_f32 v16, v14, v24
    v_fmac_f32 v17, v14, v25
    v_lshlrev_b32 v24, 16, v89
    v_and_b32 v25, s17, v89
    v_fmac_f32 v18, v14, v24
    v_fmac_f32 v19, v14, v25
    v_lshlrev_b32 v24, 16, v90
    v_and_b32 v25, s17, v90
    v_fmac_f32 v20, v14, v24
    v_fmac_f32 v21, v14, v25
    v_lshlrev_b32 v24, 16, v91
    v_and_b32 v25, s17, v91
    v_fmac_f32 v22, v14, v24
    v_fmac_f32 v23, v14, v25
    v_lshlrev_b32 v24, 16, v92
    v_and_b32 v25, s17, v92
    v_fmac_f32 v16, v15, v24
    v_fmac_f32 v17, v15, v25
    v_lshlrev_b32 v24, 16, v93
    v_and_b32 v25, s17, v93
    v_fmac_f32 v18, v15, v24
    v_fmac_f32 v19, v15, v25
    v_lshlrev_b32 v24, 16, v94
    v_and_b32 v25, s17, v94
    v_fmac_f32 v20, v15, v24
    v_fmac_f32 v21, v15, v25
    v_lshlrev_b32 v24, 16, v95
    v_and_b32 v25, s17, v95
    v_fmac_f32 v22, v15, v24
    v_fmac_f32 v23, v15, v25
    s_nop 1
    v_add_f32_dpp v16, v16, v16 row_ror:4 row_mask:0xf bank_mask:0xf
    v_add_f32_dpp v17, v17, v17 row_ror:4 row_mask:0xf bank_mask:0xf
    v_add_f32_dpp v18, v18, v18 row_ror:4 row_mask:0xf bank_mask:0xf
    v_add_f32_dpp v19, v19, v19 row_ror:4 row_mask:0xf bank_mask:0xf
    v_add_f32_dpp v20, v20, v20 row_ror:4 row_mask:0xf bank_mask:0xf
    v_add_f32_dpp v21, v21, v21 row_ror:4 row_mask:0xf bank_mask:0xf
    v_add_f32_dpp v22, v22, v22 row_ror:4 row_mask:0xf bank_mask:0xf
    v_add_f32_dpp v23, v23, v23 row_ror:4 row_mask:0xf bank_mask:0xf
    v_add_f32_dpp v16, v16, v16 row_ror:8 row_mask:0xf bank_mask:0xf
    v_add_f32_dpp v17, v17, v17 row_ror:8 row_mask:0xf bank_mask:0xf
    v_add_f32_dpp v18, v18, v18 row_ror:8 row_mask:0xf bank_mask:0xf
    v_add_f32_dpp v19, v19, v19 row_ror:8 row_mask:0xf bank_mask:0xf
    v_add_f32_dpp v20, v20, v20 row_ror:8 row_mask:0xf bank_mask:0xf
    v_add_f32_dpp v21, v21, v21 row_ror:8 row_mask:0xf bank_mask:0xf
    v_add_f32_dpp v22, v22, v22 row_ror:8 row_mask:0xf bank_mask:0xf
    v_add_f32_dpp v23, v23, v23 row_ror:8 row_mask:0xf bank_mask:0xf
    v_bfe_u32 v31, v0, 4, 4
    v_lshlrev_b32 v2, 7, v31
    v_bfe_u32 v31, v0, 0, 2
    v_lshl_add_u32 v2, v31, 5, v2
    ds_write_b128 v2, v[16:19] offset:1024
    ds_write_b128 v2, v[20:23] offset:1040
    s_waitcnt lgkmcnt(0)
    s_barrier
    s_cmp_lg_u32 s75, 0
    s_cbranch_scc1 vc_2_done
    v_mov_b32 v125, 163776
    s_cmp_lg_u32 s15, 0
    s_cbranch_scc1 vc_2_w
    s_waitcnt vmcnt(0)
    s_mov_b64 exec, 1
    ds_write_b32 v125, v126
    s_mov_b64 exec, -1
    s_waitcnt lgkmcnt(0)
vc_2_w:
    s_barrier
    ds_read_b32 v124, v125
    s_waitcnt lgkmcnt(0)
    v_readfirstlane_b32 s48, v124
    s_mov_b32 s75, 1
    s_nop 2
    s_bitcmp1_b32 s48, s14
    s_cbranch_scc1 L_overflow
vc_2_done:
    s_cmp_lg_u32 s15, 0
    s_cbranch_scc1 P_nomod
    v_bfe_u32 v31, v0, 0, 5
    v_lshlrev_b32 v2, 2, v31
    ds_read_b32 v64, v2 offset:1024
    ds_read_b32 v65, v2 offset:1152
    ds_read_b32 v66, v2 offset:1280
    ds_read_b32 v67, v2 offset:1408
    ds_read_b32 v68, v2 offset:1536
    ds_read_b32 v69, v2 offset:1664
    ds_read_b32 v70, v2 offset:1792
    ds_read_b32 v71, v2 offset:1920
    ds_read_b32 v72, v2 offset:2048
    ds_read_b32 v73, v2 offset:2176
    ds_read_b32 v74, v2 offset:2304
    ds_read_b32 v75, v2 offset:2432
    ds_read_b32 v76, v2 offset:2560
    ds_read_b32 v77, v2 offset:2688
    ds_read_b32 v78, v2 offset:2816
    ds_read_b32 v79, v2 offset:2944
    s_waitcnt lgkmcnt(0)
    v_add_f32 v64, v64, v65
    v_add_f32 v66, v66, v67
    v_add_f32 v68, v68, v69
    v_add_f32 v70, v70, v71
    v_add_f32 v72, v72, v73
    v_add_f32 v74, v74, v75
    v_add_f32 v76, v76, v77
    v_add_f32 v78, v78, v79
    v_add_f32 v64, v64, v66
    v_add_f32 v68, v68, v70
    v_add_f32 v72, v72, v74
    v_add_f32 v76, v76, v78
    v_add_f32 v64, v64, v68
    v_add_f32 v72, v72, v76
    v_add_f32 v64, v64, v72
    v_cvt_pk_bf16_f32 v64, v64, v64
    v_bfe_u32 v31, v0, 0, 5
    v_lshlrev_b32 v2, 1, v31
    v_bfe_u32 v31, v0, 5, 1
    v_lshl_add_u32 v2, v31, 30, v2
    s_lshl_b32 s48, s16, 6
    s_add_u32 s48, s48, 0x7200000
    buffer_store_short v64, v2, s[4:7], s48 offen sc1
    s_bitcmp1_b32 s16, 5
    s_cbranch_scc1 P_nomod
    s_waitcnt vmcnt(0)
    s_cmp_lt_u32 s16, 32
    s_cselect_b32 s48, 32, 57
    s_lshl_b32 s48, s48, 2
    v_mov_b32 v24, s48
    v_mov_b32 v25, 1
    s_mov_b64 exec, 1
    global_atomic_add v24, v25, s[12:13] offset:0
    s_mov_b64 exec, -1
P_nomod:
    v_lshlrev_b32 v64, 16, v32
    v_and_b32 v65, s17, v32
    v_lshlrev_b32 v66, 16, v33
    v_and_b32 v67, s17, v33
    v_lshlrev_b32 v68, 16, v34
    v_and_b32 v69, s17, v34
    v_lshlrev_b32 v70, 16, v35
    v_and_b32 v71, s17, v35
    v_lshlrev_b32 v72, 16, v36
    v_and_b32 v73, s17, v36
    v_lshlrev_b32 v74, 16, v37
    v_and_b32 v75, s17, v37
    v_lshlrev_b32 v76, 16, v38
    v_and_b32 v77, s17, v38
    v_lshlrev_b32 v78, 16, v39
    v_and_b32 v79, s17, v39
    v_lshlrev_b32 v80, 16, v40
    v_and_b32 v81, s17, v40
    v_lshlrev_b32 v82, 16, v41
    v_and_b32 v83, s17, v41
    v_lshlrev_b32 v84, 16, v42
    v_and_b32 v85, s17, v42
    v_lshlrev_b32 v86, 16, v43
    v_and_b32 v87, s17, v43
    v_lshlrev_b32 v88, 16, v44
    v_and_b32 v89, s17, v44
    v_lshlrev_b32 v90, 16, v45
    v_and_b32 v91, s17, v45
    v_lshlrev_b32 v92, 16, v46
    v_and_b32 v93, s17, v46
    v_lshlrev_b32 v94, 16, v47
    v_and_b32 v95, s17, v47
    v_bfe_u32 v31, v0, 0, 4
    v_lshlrev_b32 v2, 4, v31
    v_bfe_u32 v31, v0, 6, 2
    v_lshl_add_u32 v2, v31, 2, v2
    v_bfe_u32 v31, v0, 0, 4
    v_lshlrev_b32 v3, 4, v31
    v_add_f32 v96, v64, v65
    v_add_f32 v97, v66, v67
    v_add_f32 v98, v68, v69
    v_add_f32 v99, v70, v71
    v_add_f32 v100, v72, v73
    v_add_f32 v101, v74, v75
    v_add_f32 v102, v76, v77
    v_add_f32 v103, v78, v79
    v_add_f32 v104, v80, v81
    v_add_f32 v105, v82, v83
    v_add_f32 v106, v84, v85
    v_add_f32 v107, v86, v87
    v_add_f32 v108, v88, v89
    v_add_f32 v109, v90, v91
    v_add_f32 v110, v92, v93
    v_add_f32 v111, v94, v95
    v_add_f32 v96, v96, v97
    v_add_f32 v98, v98, v99
    v_add_f32 v100, v100, v101
    v_add_f32 v102, v102, v103
    v_add_f32 v104, v104, v105
    v_add_f32 v106, v106, v107
    v_add_f32 v108, v108, v109
    v_add_f32 v110, v110, v111
    v_add_f32 v96, v96, v98
    v_add_f32 v100, v100, v102
    v_add_f32 v104, v104, v106
    v_add_f32 v108, v108, v110
    v_add_f32 v96, v96, v100
    v_add_f32 v104, v104, v108
    v_add_f32 v96, v96, v104
    v_mov_b32 v31, v96
    s_nop 1
    v_permlane32_swap_b32 v96, v31
    v_add_f32 v96, v96, v31
    v_mov_b32 v31, v96
    s_nop 1
    v_permlane16_swap_b32 v96, v31
    v_add_f32 v96, v96, v31
    ds_write_b32 v2, v96
    s_waitcnt lgkmcnt(0)
    s_barrier
    ds_read_b128 v[4:7], v3
    s_waitcnt lgkmcnt(0)
    v_add_f32 v4, v4, v5
    v_add_f32 v6, v6, v7
    v_add_f32 v4, v4, v6
    v_mul_f32 v8, 0x3b000000, v4
    v_sub_f32 v96, v64, v8
    v_sub_f32 v97, v65, v8
    v_sub_f32 v98, v66, v8
    v_sub_f32 v99, v67, v8
    v_sub_f32 v100, v68, v8
    v_sub_f32 v101, v69, v8
    v_sub_f32 v102, v70, v8
    v_sub_f32 v103, v71, v8
    v_sub_f32 v104, v72, v8
    v_sub_f32 v105, v73, v8
    v_sub_f32 v106, v74, v8
    v_sub_f32 v107, v75, v8
    v_sub_f32 v108, v76, v8
    v_sub_f32 v109, v77, v8
    v_sub_f32 v110, v78, v8
    v_sub_f32 v111, v79, v8
    v_sub_f32 v112, v80, v8
    v_sub_f32 v113, v81, v8
    v_sub_f32 v114, v82, v8
    v_sub_f32 v115, v83, v8
    v_sub_f32 v116, v84, v8
    v_sub_f32 v117, v85, v8
    v_sub_f32 v118, v86, v8
    v_sub_f32 v119, v87, v8
    v_sub_f32 v120, v88, v8
    v_sub_f32 v121, v89, v8
    v_sub_f32 v122, v90, v8
    v_sub_f32 v123, v91, v8
    v_sub_f32 v124, v92, v8
    v_sub_f32 v125, v93, v8
    v_sub_f32 v126, v94, v8
    v_sub_f32 v127, v95, v8
    v_mul_f32 v96, v96, v96
    v_mul_f32 v97, v97, v97
    v_mul_f32 v98, v98, v98
    v_mul_f32 v99, v99, v99
    v_mul_f32 v100, v100, v100
    v_mul_f32 v101, v101, v101
    v_mul_f32 v102, v102, v102
    v_mul_f32 v103, v103, v103
    v_mul_f32 v104, v104, v104
    v_mul_f32 v105, v105, v105
    v_mul_f32 v106, v106, v106
    v_mul_f32 v107, v107, v107
    v_mul_f32 v108, v108, v108
    v_mul_f32 v109, v109, v109
    v_mul_f32 v110, v110, v110
    v_mul_f32 v111, v111, v111
    v_mul_f32 v112, v112, v112
    v_mul_f32 v113, v113, v113
    v_mul_f32 v114, v114, v114
    v_mul_f32 v115, v115, v115
    v_mul_f32 v116, v116, v116
    v_mul_f32 v117, v117, v117
    v_mul_f32 v118, v118, v118
    v_mul_f32 v119, v119, v119
    v_mul_f32 v120, v120, v120
    v_mul_f32 v121, v121, v121
    v_mul_f32 v122, v122, v122
    v_mul_f32 v123, v123, v123
    v_mul_f32 v124, v124, v124
    v_mul_f32 v125, v125, v125
    v_mul_f32 v126, v126, v126
    v_mul_f32 v127, v127, v127
    v_add_f32 v96, v96, v97
    v_add_f32 v98, v98, v99
    v_add_f32 v100, v100, v101
    v_add_f32 v102, v102, v103
    v_add_f32 v104, v104, v105
    v_add_f32 v106, v106, v107
    v_add_f32 v108, v108, v109
    v_add_f32 v110, v110, v111
    v_add_f32 v112, v112, v113
    v_add_f32 v114, v114, v115
    v_add_f32 v116, v116, v117
    v_add_f32 v118, v118, v119
    v_add_f32 v120, v120, v121
    v_add_f32 v122, v122, v123
    v_add_f32 v124, v124, v125
    v_add_f32 v126, v126, v127
    v_add_f32 v96, v96, v98
    v_add_f32 v100, v100, v102
    v_add_f32 v104, v104, v106
    v_add_f32 v108, v108, v110
    v_add_f32 v112, v112, v114
    v_add_f32 v116, v116, v118
    v_add_f32 v120, v120, v122
    v_add_f32 v124, v124, v126
    v_add_f32 v96, v96, v100
    v_add_f32 v104, v104, v108
    v_add_f32 v112, v112, v116
    v_add_f32 v120, v120, v124
    v_add_f32 v96, v96, v104
    v_add_f32 v112, v112, v120
    v_add_f32 v96, v96, v112
    v_mov_b32 v31, v96
    s_nop 1
    v_permlane32_swap_b32 v96, v31
    v_add_f32 v96, v96, v31
    v_mov_b32 v31, v96
    s_nop 1
    v_permlane16_swap_b32 v96, v31
    v_add_f32 v96, v96, v31
    ds_write_b32 v2, v96 offset:256
    s_waitcnt lgkmcnt(0)
    s_barrier
    ds_read_b128 v[4:7], v3 offset:256
    s_waitcnt lgkmcnt(0)
    v_add_f32 v4, v4, v5
    v_add_f32 v6, v6, v7
    v_add_f32 v4, v4, v6
    v_mul_f32 v9, 0x3b000000, v4
    v_cvt_pk_bf16_f32 v8, v8, v8
    v_and_b32 v8, s17, v8
    v_cvt_pk_bf16_f32 v9, v9, v9
    v_and_b32 v9, s17, v9
    v_add_f32 v9, 0x3727c5ac, v9
    v_cvt_pk_bf16_f32 v9, v9, v9
    v_and_b32 v9, s17, v9
    v_sqrt_f32 v9, v9
    s_nop 0
    v_cvt_pk_bf16_f32 v9, v9, v9
    v_and_b32 v9, s17, v9
    v_rcp_f32 v9, v9
    v_sub_f32 v64, v64, v8
    v_sub_f32 v65, v65, v8
    v_sub_f32 v66, v66, v8
    v_sub_f32 v67, v67, v8
    v_sub_f32 v68, v68, v8
    v_sub_f32 v69, v69, v8
    v_sub_f32 v70, v70, v8
    v_sub_f32 v71, v71, v8
    v_sub_f32 v72, v72, v8
    v_sub_f32 v73, v73, v8
    v_sub_f32 v74, v74, v8
    v_sub_f32 v75, v75, v8
    v_sub_f32 v76, v76, v8
    v_sub_f32 v77, v77, v8
    v_sub_f32 v78, v78, v8
    v_sub_f32 v79, v79, v8
    v_sub_f32 v80, v80, v8
    v_sub_f32 v81, v81, v8
    v_sub_f32 v82, v82, v8
    v_sub_f32 v83, v83, v8
    v_sub_f32 v84, v84, v8
    v_sub_f32 v85, v85, v8
    v_sub_f32 v86, v86, v8
    v_sub_f32 v87, v87, v8
    v_sub_f32 v88, v88, v8
    v_sub_f32 v89, v89, v8
    v_sub_f32 v90, v90, v8
    v_sub_f32 v91, v91, v8
    v_sub_f32 v92, v92, v8
    v_sub_f32 v93, v93, v8
    v_sub_f32 v94, v94, v8
    v_sub_f32 v95, v95, v8
    v_cvt_pk_bf16_f32 v31, v64, v65
    v_lshlrev_b32 v64, 16, v31
    v_and_b32 v65, s17, v31
    v_cvt_pk_bf16_f32 v31, v66, v67
    v_lshlrev_b32 v66, 16, v31
    v_and_b32 v67, s17, v31
    v_cvt_pk_bf16_f32 v31, v68, v69
    v_lshlrev_b32 v68, 16, v31
    v_and_b32 v69, s17, v31
    v_cvt_pk_bf16_f32 v31, v70, v71
    v_lshlrev_b32 v70, 16, v31
    v_and_b32 v71, s17, v31
    v_cvt_pk_bf16_f32 v31, v72, v73
    v_lshlrev_b32 v72, 16, v31
    v_and_b32 v73, s17, v31
    v_cvt_pk_bf16_f32 v31, v74, v75
    v_lshlrev_b32 v74, 16, v31
    v_and_b32 v75, s17, v31
    v_cvt_pk_bf16_f32 v31, v76, v77
    v_lshlrev_b32 v76, 16, v31
    v_and_b32 v77, s17, v31
    v_cvt_pk_bf16_f32 v31, v78, v79
    v_lshlrev_b32 v78, 16, v31
    v_and_b32 v79, s17, v31
    v_cvt_pk_bf16_f32 v31, v80, v81
    v_lshlrev_b32 v80, 16, v31
    v_and_b32 v81, s17, v31
    v_cvt_pk_bf16_f32 v31, v82, v83
    v_lshlrev_b32 v82, 16, v31
    v_and_b32 v83, s17, v31
    v_cvt_pk_bf16_f32 v31, v84, v85
    v_lshlrev_b32 v84, 16, v31
    v_and_b32 v85, s17, v31
    v_cvt_pk_bf16_f32 v31, v86, v87
    v_lshlrev_b32 v86, 16, v31
    v_and_b32 v87, s17, v31
    v_cvt_pk_bf16_f32 v31, v88, v89
    v_lshlrev_b32 v88, 16, v31
    v_and_b32 v89, s17, v31
    v_cvt_pk_bf16_f32 v31, v90, v91
    v_lshlrev_b32 v90, 16, v31
    v_and_b32 v91, s17, v31
    v_cvt_pk_bf16_f32 v31, v92, v93
    v_lshlrev_b32 v92, 16, v31
    v_and_b32 v93, s17, v31
    v_cvt_pk_bf16_f32 v31, v94, v95
    v_lshlrev_b32 v94, 16, v31
    v_and_b32 v95, s17, v31
    v_mul_f32 v64, v64, v9
    v_mul_f32 v65, v65, v9
    v_mul_f32 v66, v66, v9
    v_mul_f32 v67, v67, v9
    v_mul_f32 v68, v68, v9
    v_mul_f32 v69, v69, v9
    v_mul_f32 v70, v70, v9
    v_mul_f32 v71, v71, v9
    v_mul_f32 v72, v72, v9
    v_mul_f32 v73, v73, v9
    v_mul_f32 v74, v74, v9
    v_mul_f32 v75, v75, v9
    v_mul_f32 v76, v76, v9
    v_mul_f32 v77, v77, v9
    v_mul_f32 v78, v78, v9
    v_mul_f32 v79, v79, v9
    v_mul_f32 v80, v80, v9
    v_mul_f32 v81, v81, v9
    v_mul_f32 v82, v82, v9
    v_mul_f32 v83, v83, v9
    v_mul_f32 v84, v84, v9
    v_mul_f32 v85, v85, v9
    v_mul_f32 v86, v86, v9
    v_mul_f32 v87, v87, v9
    v_mul_f32 v88, v88, v9
    v_mul_f32 v89, v89, v9
    v_mul_f32 v90, v90, v9
    v_mul_f32 v91, v91, v9
    v_mul_f32 v92, v92, v9
    v_mul_f32 v93, v93, v9
    v_mul_f32 v94, v94, v9
    v_mul_f32 v95, v95, v9
    v_cvt_pk_bf16_f32 v31, v64, v65
    v_lshlrev_b32 v64, 16, v31
    v_and_b32 v65, s17, v31
    v_cvt_pk_bf16_f32 v31, v66, v67
    v_lshlrev_b32 v66, 16, v31
    v_and_b32 v67, s17, v31
    v_cvt_pk_bf16_f32 v31, v68, v69
    v_lshlrev_b32 v68, 16, v31
    v_and_b32 v69, s17, v31
    v_cvt_pk_bf16_f32 v31, v70, v71
    v_lshlrev_b32 v70, 16, v31
    v_and_b32 v71, s17, v31
    v_cvt_pk_bf16_f32 v31, v72, v73
    v_lshlrev_b32 v72, 16, v31
    v_and_b32 v73, s17, v31
    v_cvt_pk_bf16_f32 v31, v74, v75
    v_lshlrev_b32 v74, 16, v31
    v_and_b32 v75, s17, v31
    v_cvt_pk_bf16_f32 v31, v76, v77
    v_lshlrev_b32 v76, 16, v31
    v_and_b32 v77, s17, v31
    v_cvt_pk_bf16_f32 v31, v78, v79
    v_lshlrev_b32 v78, 16, v31
    v_and_b32 v79, s17, v31
    v_cvt_pk_bf16_f32 v31, v80, v81
    v_lshlrev_b32 v80, 16, v31
    v_and_b32 v81, s17, v31
    v_cvt_pk_bf16_f32 v31, v82, v83
    v_lshlrev_b32 v82, 16, v31
    v_and_b32 v83, s17, v31
    v_cvt_pk_bf16_f32 v31, v84, v85
    v_lshlrev_b32 v84, 16, v31
    v_and_b32 v85, s17, v31
    v_cvt_pk_bf16_f32 v31, v86, v87
    v_lshlrev_b32 v86, 16, v31
    v_and_b32 v87, s17, v31
    v_cvt_pk_bf16_f32 v31, v88, v89
    v_lshlrev_b32 v88, 16, v31
    v_and_b32 v89, s17, v31
    v_cvt_pk_bf16_f32 v31, v90, v91
    v_lshlrev_b32 v90, 16, v31
    v_and_b32 v91, s17, v31
    v_cvt_pk_bf16_f32 v31, v92, v93
    v_lshlrev_b32 v92, 16, v31
    v_and_b32 v93, s17, v31
    v_cvt_pk_bf16_f32 v31, v94, v95
    v_lshlrev_b32 v94, 16, v31
    v_and_b32 v95, s17, v31
    s_cmp_ge_u32 s16, 32
    s_cbranch_scc1 P_go
    s_load_dwordx2 s[34:35], s[0:1], 8
    s_waitcnt lgkmcnt(0)
    s_mov_b32 s8, s34
    s_and_b32 s9, s35, 0xffff
    s_mov_b32 s10, 0x2000
    s_mov_b32 s11, 0x00020000
    v_bfe_u32 v31, v0, 4, 1
    v_lshlrev_b32 v16, 10, v31
    v_bfe_u32 v31, v0, 0, 2
    v_lshl_add_u32 v16, v31, 2, v16
    v_bfe_u32 v31, v0, 5, 1
    v_lshl_add_u32 v16, v31, 1, v16
    s_bfe_u32 s48, s16, 0x20001
    s_lshl_b32 s48, s48, 11
    s_bfe_u32 s49, s16, 0x20003
    s_lshl_b32 s49, s49, 8
    s_add_u32 s48, s48, s49
    s_bfe_u32 s49, s15, 0x20000
    s_lshl_b32 s49, s49, 6
    s_add_u32 s48, s48, s49
    s_bfe_u32 s49, s16, 0x10000
    s_lshl_b32 s49, s49, 4
    s_add_u32 s48, s48, s49
    buffer_load_ushort v17, v16, s[8:11], s48 offen
    buffer_load_ushort v18, v16, s[8:11], s48 offen offset:32
    v_bfe_u32 v31, v0, 0, 6
    v_lshlrev_b32 v20, 4, v31
    v_bfe_u32 v31, v0, 4, 1
    v_lshlrev_b32 v21, 5, v31
    v_bfe_u32 v31, v0, 0, 2
    v_lshl_add_u32 v21, v31, 3, v21
    v_bfe_u32 v31, v0, 5, 1
    v_lshl_add_u32 v21, v31, 2, v21
    v_bfe_u32 v31, v0, 2, 2
    v_lshl_add_u32 v21, v31, 30, v21
    v_mov_b32 v24, 0
    v_mov_b32 v25, 0
    v_mov_b32 v26, 0
    v_mov_b32 v27, 0
    v_mov_b32 v19, -1
    s_bfe_u32 s48, s16, 0x50000
    s_lshl_b32 s48, s48, 13
    s_bfe_u32 s49, s15, 0x20000
    s_lshl_b32 s49, s49, 11
    s_add_u32 s48, s48, s49
    s_add_u32 s48, s48, 0x6c00000
    buffer_store_dwordx4 v[24:27], v20, s[4:7], s48 offen sc1
    buffer_store_dwordx4 v[24:27], v20, s[4:7], s48 offen offset:1024 sc1
    s_bfe_u32 s50, s16, 0x20003
    s_lshl_b32 s50, s50, 11
    s_bfe_u32 s49, s15, 0x20000
    s_lshl_b32 s49, s49, 9
    s_add_u32 s50, s50, s49
    s_bfe_u32 s49, s16, 0x10000
    s_lshl_b32 s49, s49, 8
    s_add_u32 s50, s50, s49
    s_bfe_u32 s49, s16, 0x20001
    s_lshl_b32 s49, s49, 6
    s_add_u32 s50, s50, s49
    s_add_u32 s50, s50, 0x6c80000
    s_add_u32 s48, s50, 8192
    buffer_store_dword v19, v21, s[4:7], s48 offen sc1
    s_add_u32 s48, s50, 16384
    buffer_store_dword v19, v21, s[4:7], s48 offen sc1
    s_waitcnt vmcnt(4)
    v_lshl_or_b32 v17, v18, 16, v17
    buffer_store_dword v17, v21, s[4:7], s50 offen sc1
    v_bfe_u32 v31, v0, 0, 2
    v_lshlrev_b32 v16, 4, v31
    s_lshl_b32 s48, s16, 7
    s_add_u32 s48, s48, 0x7210000
    s_mov_b64 exec, 7
    buffer_store_dword v24, v16, s[4:7], s48 offen sc1
    s_mov_b64 exec, -1
    s_cmp_lg_u32 s15, 0
    s_cbranch_scc1 dw_3_ok
    v_mov_b32 v24, 0
    s_mov_b32 s49, 0
    s_mov_b64 exec, 1
dw_3:
    global_load_dword v25, v24, s[12:13] offset:128 sc1
    s_waitcnt vmcnt(0)
    v_readfirstlane_b32 s48, v25
    s_cmp_ge_u32 s48, 32
    s_cbranch_scc1 dw_3_x
    s_sleep 8
    s_add_u32 s49, s49, 1
    s_cmp_lt_u32 s49, 100000
    s_cbranch_scc1 dw_3
dw_3_x:
    s_mov_b64 exec, -1
dw_3_ok:
    s_barrier
P_go:
    v_bfe_u32 v31, v0, 4, 2
    v_lshlrev_b32 v2, 4, v31
    v_bfe_u32 v31, v0, 6, 2
    v_lshl_add_u32 v2, v31, 8, v2
    s_mov_b32 s48, 0x7200000
    buffer_load_dwordx4 v[32:35], v2, s[4:7], s48 offen offset:1024 sc1
    buffer_load_dwordx4 v[36:39], v2, s[4:7], s48 offen offset:1088 sc1
    buffer_load_dwordx4 v[40:43], v2, s[4:7], s48 offen offset:1152 sc1
    buffer_load_dwordx4 v[44:47], v2, s[4:7], s48 offen offset:1216 sc1
    buffer_load_dwordx4 v[48:51], v2, s[4:7], s48 offen offset:0 sc1
    buffer_load_dwordx4 v[52:55], v2, s[4:7], s48 offen offset:64 sc1
    buffer_load_dwordx4 v[56:59], v2, s[4:7], s48 offen offset:128 sc1
    buffer_load_dwordx4 v[60:63], v2, s[4:7], s48 offen offset:192 sc1
    s_waitcnt vmcnt(4)
    v_lshlrev_b32 v96, 16, v32
    v_and_b32 v97, s17, v32
    v_lshlrev_b32 v98, 16, v33
    v_and_b32 v99, s17, v33
    v_lshlrev_b32 v100, 16, v34
    v_and_b32 v101, s17, v34
    v_lshlrev_b32 v102, 16, v35
    v_and_b32 v103, s17, v35
    v_lshlrev_b32 v104, 16, v36
    v_and_b32 v105, s17, v36
    v_lshlrev_b32 v106, 16, v37
    v_and_b32 v107, s17, v37
    v_lshlrev_b32 v108, 16, v38
    v_and_b32 v109, s17, v38
    v_lshlrev_b32 v110, 16, v39
    v_and_b32 v111, s17, v39
    v_lshlrev_b32 v112, 16, v40
    v_and_b32 v113, s17, v40
    v_lshlrev_b32 v114, 16, v41
    v_and_b32 v115, s17, v41
    v_lshlrev_b32 v116, 16, v42
    v_and_b32 v117, s17, v42
    v_lshlrev_b32 v118, 16, v43
    v_and_b32 v119, s17, v43
    v_lshlrev_b32 v120, 16, v44
    v_and_b32 v121, s17, v44
    v_lshlrev_b32 v122, 16, v45
    v_and_b32 v123, s17, v45
    v_lshlrev_b32 v124, 16, v46
    v_and_b32 v125, s17, v46
    v_lshlrev_b32 v126, 16, v47
    v_and_b32 v127, s17, v47
    v_add_f32 v96, 1.0, v96
    v_add_f32 v97, 1.0, v97
    v_add_f32 v98, 1.0, v98
    v_add_f32 v99, 1.0, v99
    v_add_f32 v100, 1.0, v100
    v_add_f32 v101, 1.0, v101
    v_add_f32 v102, 1.0, v102
    v_add_f32 v103, 1.0, v103
    v_add_f32 v104, 1.0, v104
    v_add_f32 v105, 1.0, v105
    v_add_f32 v106, 1.0, v106
    v_add_f32 v107, 1.0, v107
    v_add_f32 v108, 1.0, v108
    v_add_f32 v109, 1.0, v109
    v_add_f32 v110, 1.0, v110
    v_add_f32 v111, 1.0, v111
    v_add_f32 v112, 1.0, v112
    v_add_f32 v113, 1.0, v113
    v_add_f32 v114, 1.0, v114
    v_add_f32 v115, 1.0, v115
    v_add_f32 v116, 1.0, v116
    v_add_f32 v117, 1.0, v117
    v_add_f32 v118, 1.0, v118
    v_add_f32 v119, 1.0, v119
    v_add_f32 v120, 1.0, v120
    v_add_f32 v121, 1.0, v121
    v_add_f32 v122, 1.0, v122
    v_add_f32 v123, 1.0, v123
    v_add_f32 v124, 1.0, v124
    v_add_f32 v125, 1.0, v125
    v_add_f32 v126, 1.0, v126
    v_add_f32 v127, 1.0, v127
    v_cvt_pk_bf16_f32 v31, v96, v97
    v_lshlrev_b32 v96, 16, v31
    v_and_b32 v97, s17, v31
    v_cvt_pk_bf16_f32 v31, v98, v99
    v_lshlrev_b32 v98, 16, v31
    v_and_b32 v99, s17, v31
    v_cvt_pk_bf16_f32 v31, v100, v101
    v_lshlrev_b32 v100, 16, v31
    v_and_b32 v101, s17, v31
    v_cvt_pk_bf16_f32 v31, v102, v103
    v_lshlrev_b32 v102, 16, v31
    v_and_b32 v103, s17, v31
    v_cvt_pk_bf16_f32 v31, v104, v105
    v_lshlrev_b32 v104, 16, v31
    v_and_b32 v105, s17, v31
    v_cvt_pk_bf16_f32 v31, v106, v107
    v_lshlrev_b32 v106, 16, v31
    v_and_b32 v107, s17, v31
    v_cvt_pk_bf16_f32 v31, v108, v109
    v_lshlrev_b32 v108, 16, v31
    v_and_b32 v109, s17, v31
    v_cvt_pk_bf16_f32 v31, v110, v111
    v_lshlrev_b32 v110, 16, v31
    v_and_b32 v111, s17, v31
    v_cvt_pk_bf16_f32 v31, v112, v113
    v_lshlrev_b32 v112, 16, v31
    v_and_b32 v113, s17, v31
    v_cvt_pk_bf16_f32 v31, v114, v115
    v_lshlrev_b32 v114, 16, v31
    v_and_b32 v115, s17, v31
    v_cvt_pk_bf16_f32 v31, v116, v117
    v_lshlrev_b32 v116, 16, v31
    v_and_b32 v117, s17, v31
    v_cvt_pk_bf16_f32 v31, v118, v119
    v_lshlrev_b32 v118, 16, v31
    v_and_b32 v119, s17, v31
    v_cvt_pk_bf16_f32 v31, v120, v121
    v_lshlrev_b32 v120, 16, v31
    v_and_b32 v121, s17, v31
    v_cvt_pk_bf16_f32 v31, v122, v123
    v_lshlrev_b32 v122, 16, v31
    v_and_b32 v123, s17, v31
    v_cvt_pk_bf16_f32 v31, v124, v125
    v_lshlrev_b32 v124, 16, v31
    v_and_b32 v125, s17, v31
    v_cvt_pk_bf16_f32 v31, v126, v127
    v_lshlrev_b32 v126, 16, v31
    v_and_b32 v127, s17, v31
    v_mul_f32 v64, v64, v96
    v_mul_f32 v65, v65, v97
    v_mul_f32 v66, v66, v98
    v_mul_f32 v67, v67, v99
    v_mul_f32 v68, v68, v100
    v_mul_f32 v69, v69, v101
    v_mul_f32 v70, v70, v102
    v_mul_f32 v71, v71, v103
    v_mul_f32 v72, v72, v104
    v_mul_f32 v73, v73, v105
    v_mul_f32 v74, v74, v106
    v_mul_f32 v75, v75, v107
    v_mul_f32 v76, v76, v108
    v_mul_f32 v77, v77, v109
    v_mul_f32 v78, v78, v110
    v_mul_f32 v79, v79, v111
    v_mul_f32 v80, v80, v112
    v_mul_f32 v81, v81, v113
    v_mul_f32 v82, v82, v114
    v_mul_f32 v83, v83, v115
    v_mul_f32 v84, v84, v116
    v_mul_f32 v85, v85, v117
    v_mul_f32 v86, v86, v118
    v_mul_f32 v87, v87, v119
    v_mul_f32 v88, v88, v120
    v_mul_f32 v89, v89, v121
    v_mul_f32 v90, v90, v122
    v_mul_f32 v91, v91, v123
    v_mul_f32 v92, v92, v124
    v_mul_f32 v93, v93, v125
    v_mul_f32 v94, v94, v126
    v_mul_f32 v95, v95, v127
    v_cvt_pk_bf16_f32 v31, v64, v65
    v_lshlrev_b32 v64, 16, v31
    v_and_b32 v65, s17, v31
    v_cvt_pk_bf16_f32 v31, v66, v67
    v_lshlrev_b32 v66, 16, v31
    v_and_b32 v67, s17, v31
    v_cvt_pk_bf16_f32 v31, v68, v69
    v_lshlrev_b32 v68, 16, v31
    v_and_b32 v69, s17, v31
    v_cvt_pk_bf16_f32 v31, v70, v71
    v_lshlrev_b32 v70, 16, v31
    v_and_b32 v71, s17, v31
    v_cvt_pk_bf16_f32 v31, v72, v73
    v_lshlrev_b32 v72, 16, v31
    v_and_b32 v73, s17, v31
    v_cvt_pk_bf16_f32 v31, v74, v75
    v_lshlrev_b32 v74, 16, v31
    v_and_b32 v75, s17, v31
    v_cvt_pk_bf16_f32 v31, v76, v77
    v_lshlrev_b32 v76, 16, v31
    v_and_b32 v77, s17, v31
    v_cvt_pk_bf16_f32 v31, v78, v79
    v_lshlrev_b32 v78, 16, v31
    v_and_b32 v79, s17, v31
    v_cvt_pk_bf16_f32 v31, v80, v81
    v_lshlrev_b32 v80, 16, v31
    v_and_b32 v81, s17, v31
    v_cvt_pk_bf16_f32 v31, v82, v83
    v_lshlrev_b32 v82, 16, v31
    v_and_b32 v83, s17, v31
    v_cvt_pk_bf16_f32 v31, v84, v85
    v_lshlrev_b32 v84, 16, v31
    v_and_b32 v85, s17, v31
    v_cvt_pk_bf16_f32 v31, v86, v87
    v_lshlrev_b32 v86, 16, v31
    v_and_b32 v87, s17, v31
    v_cvt_pk_bf16_f32 v31, v88, v89
    v_lshlrev_b32 v88, 16, v31
    v_and_b32 v89, s17, v31
    v_cvt_pk_bf16_f32 v31, v90, v91
    v_lshlrev_b32 v90, 16, v31
    v_and_b32 v91, s17, v31
    v_cvt_pk_bf16_f32 v31, v92, v93
    v_lshlrev_b32 v92, 16, v31
    v_and_b32 v93, s17, v31
    v_cvt_pk_bf16_f32 v31, v94, v95
    v_lshlrev_b32 v94, 16, v31
    v_and_b32 v95, s17, v31
    s_waitcnt vmcnt(0)
    v_lshlrev_b32 v96, 16, v48
    v_and_b32 v97, s17, v48
    v_lshlrev_b32 v98, 16, v49
    v_and_b32 v99, s17, v49
    v_lshlrev_b32 v100, 16, v50
    v_and_b32 v101, s17, v50
    v_lshlrev_b32 v102, 16, v51
    v_and_b32 v103, s17, v51
    v_lshlrev_b32 v104, 16, v52
    v_and_b32 v105, s17, v52
    v_lshlrev_b32 v106, 16, v53
    v_and_b32 v107, s17, v53
    v_lshlrev_b32 v108, 16, v54
    v_and_b32 v109, s17, v54
    v_lshlrev_b32 v110, 16, v55
    v_and_b32 v111, s17, v55
    v_lshlrev_b32 v112, 16, v56
    v_and_b32 v113, s17, v56
    v_lshlrev_b32 v114, 16, v57
    v_and_b32 v115, s17, v57
    v_lshlrev_b32 v116, 16, v58
    v_and_b32 v117, s17, v58
    v_lshlrev_b32 v118, 16, v59
    v_and_b32 v119, s17, v59
    v_lshlrev_b32 v120, 16, v60
    v_and_b32 v121, s17, v60
    v_lshlrev_b32 v122, 16, v61
    v_and_b32 v123, s17, v61
    v_lshlrev_b32 v124, 16, v62
    v_and_b32 v125, s17, v62
    v_lshlrev_b32 v126, 16, v63
    v_and_b32 v127, s17, v63
    v_add_f32 v64, v64, v96
    v_add_f32 v65, v65, v97
    v_add_f32 v66, v66, v98
    v_add_f32 v67, v67, v99
    v_add_f32 v68, v68, v100
    v_add_f32 v69, v69, v101
    v_add_f32 v70, v70, v102
    v_add_f32 v71, v71, v103
    v_add_f32 v72, v72, v104
    v_add_f32 v73, v73, v105
    v_add_f32 v74, v74, v106
    v_add_f32 v75, v75, v107
    v_add_f32 v76, v76, v108
    v_add_f32 v77, v77, v109
    v_add_f32 v78, v78, v110
    v_add_f32 v79, v79, v111
    v_add_f32 v80, v80, v112
    v_add_f32 v81, v81, v113
    v_add_f32 v82, v82, v114
    v_add_f32 v83, v83, v115
    v_add_f32 v84, v84, v116
    v_add_f32 v85, v85, v117
    v_add_f32 v86, v86, v118
    v_add_f32 v87, v87, v119
    v_add_f32 v88, v88, v120
    v_add_f32 v89, v89, v121
    v_add_f32 v90, v90, v122
    v_add_f32 v91, v91, v123
    v_add_f32 v92, v92, v124
    v_add_f32 v93, v93, v125
    v_add_f32 v94, v94, v126
    v_add_f32 v95, v95, v127
    v_cvt_pk_bf16_f32 v32, v64, v65
    v_cvt_pk_bf16_f32 v33, v66, v67
    v_cvt_pk_bf16_f32 v34, v68, v69
    v_cvt_pk_bf16_f32 v35, v70, v71
    v_cvt_pk_bf16_f32 v36, v72, v73
    v_cvt_pk_bf16_f32 v37, v74, v75
    v_cvt_pk_bf16_f32 v38, v76, v77
    v_cvt_pk_bf16_f32 v39, v78, v79
    v_cvt_pk_bf16_f32 v40, v80, v81
    v_cvt_pk_bf16_f32 v41, v82, v83
    v_cvt_pk_bf16_f32 v42, v84, v85
    v_cvt_pk_bf16_f32 v43, v86, v87
    v_cvt_pk_bf16_f32 v44, v88, v89
    v_cvt_pk_bf16_f32 v45, v90, v91
    v_cvt_pk_bf16_f32 v46, v92, v93
    v_cvt_pk_bf16_f32 v47, v94, v95
    v_bfe_u32 v31, v0, 0, 6
    v_lshlrev_b32 v2, 4, v31
    v_bfe_u32 v31, v0, 6, 2
    v_lshl_add_u32 v2, v31, 12, v2
    s_lshl_b32 s48, s16, 14
    s_add_u32 s48, s48, 0x7000000
    buffer_store_dwordx4 v[32:35], v2, s[4:7], s48 offen offset:0 sc1
    buffer_store_dwordx4 v[36:39], v2, s[4:7], s48 offen offset:1024 sc1
    buffer_store_dwordx4 v[40:43], v2, s[4:7], s48 offen offset:2048 sc1
    buffer_store_dwordx4 v[44:47], v2, s[4:7], s48 offen offset:3072 sc1
    s_cmp_ge_u32 s16, 32
    s_cbranch_scc1 P_done
    s_waitcnt vmcnt(0)
    s_barrier
    s_cmp_lg_u32 s15, 0
    s_cbranch_scc1 P_done
    v_mov_b32 v24, 0
    v_mov_b32 v25, 1
    s_mov_b64 exec, 1
    global_atomic_add v24, v25, s[12:13] offset:160
    s_mov_b64 exec, -1
P_done:
    s_add_u32 s16, s16, 32
    s_cmp_lt_u32 s16, 128
    s_barrier
    s_cbranch_scc1 L_Ploop
    s_waitcnt vmcnt(0)
    s_barrier
    s_cmp_lg_u32 s15, 0
    s_cbranch_scc1 L_done
    v_mov_b32 v24, 0
    v_mov_b32 v25, 1
    s_mov_b64 exec, 1
    global_atomic_add v24, v25, s[12:13] offset:224
    s_mov_b64 exec, -1
    s_branch L_done
R_cont:
    s_bfe_u32 s53, s14, 0x50000
    s_lshl_b32 s53, s53, 17
    s_bfe_u32 s49, s15, 0x20000
    s_lshl_b32 s49, s49, 15
    s_add_u32 s53, s53, s49
    v_bfe_u32 v31, v0, 0, 6
    v_lshlrev_b32 v1, 4, v31
    v_bfe_u32 v31, v0, 6, 2
    v_lshl_add_u32 v1, v31, 11, v1
    v_bfe_u32 v31, v0, 0, 6
    v_lshlrev_b32 v2, 4, v31
    v_bfe_u32 v31, v0, 6, 2
    v_lshlrev_b32 v3, 10, v31
    v_bfe_u32 v31, v0, 0, 4
    v_lshl_add_u32 v3, v31, 5, v3
    v_bfe_u32 v31, v0, 4, 2
    v_lshl_add_u32 v3, v31, 3, v3
    v_add_u32 v3, 24576, v3
    v_bfe_u32 v31, v0, 2, 2
    v_lshlrev_b32 v16, 3, v31
    v_xor_b32 v3, v3, v16
    v_bfe_u32 v31, v0, 0, 6
    v_lshlrev_b32 v4, 3, v31
    v_add_u32 v4, 24576, v4
    v_bfe_u32 v31, v0, 4, 2
    v_lshlrev_b32 v16, 3, v31
    v_xor_b32 v4, v4, v16
    v_bfe_u32 v31, v0, 6, 2
    v_lshlrev_b32 v5, 9, v31
    v_bfe_u32 v31, v0, 5, 1
    v_lshl_add_u32 v5, v31, 8, v5
    v_bfe_u32 v31, v0, 2, 2
    v_lshl_add_u32 v5, v31, 6, v5
    v_bfe_u32 v31, v0, 0, 1
    v_lshl_add_u32 v5, v31, 5, v5
    v_bfe_u32 v31, v0, 4, 1
    v_lshl_add_u32 v5, v31, 4, v5
    v_add_u32 v5, 28672, v5
    v_bfe_u32 v31, v0, 5, 1
    v_lshlrev_b32 v16, 8, v31
    v_bfe_u32 v31, v0, 2, 2
    v_lshl_add_u32 v16, v31, 6, v16
    v_bfe_u32 v31, v0, 0, 1
    v_lshl_add_u32 v16, v31, 5, v16
    v_bfe_u32 v31, v0, 4, 1
    v_lshl_add_u32 v16, v31, 4, v16
    v_add_u32 v16, 31744, v16
    v_and_b32 v17, 2, v0
    v_cmp_ne_u32 vcc, 0, v17
    s_nop 1
    v_cndmask_b32 v5, v5, v16, vcc
    v_mov_b32 v10, 0
    v_mov_b32 v11, 0
    v_mov_b32 v14, 0
    v_mov_b32 v15, 0
    v_bfe_u32 v31, v0, 6, 2
    v_lshlrev_b32 v6, 15, v31
    v_bfe_u32 v31, v0, 0, 6
    v_lshl_add_u32 v6, v31, 4, v6
    v_add_u32 v6, 32768, v6
    v_bfe_u32 v31, v0, 4, 2
    v_lshlrev_b32 v7, 14, v31
    v_bfe_u32 v31, v0, 3, 1
    v_lshl_add_u32 v7, v31, 13, v7
    v_bfe_u32 v31, v0, 0, 3
    v_lshl_add_u32 v7, v31, 3, v7
    v_bfe_u32 v31, v0, 4, 1
    v_lshlrev_b32 v8, 5, v31
    v_bfe_u32 v31, v0, 0, 2
    v_lshl_add_u32 v8, v31, 3, v8
    v_bfe_u32 v31, v0, 5, 1
    v_lshl_add_u32 v8, v31, 2, v8
    v_bfe_u32 v31, v0, 2, 2
    v_lshl_add_u32 v8, v31, 30, v8
    v_and_b32 v16, 1, v0
    v_mul_u32_u24 v9, 0xaaaa, v16
    v_add_u32 v9, 0x4444, v9
    v_and_b32 v16, 3, v0
    v_bfe_u32 v17, v0, 2, 2
    v_mov_b32 v18, 0x3f80
    v_mov_b32 v19, 0x3f800000
    v_cmp_eq_u32 vcc, 1, v16
    s_nop 1
    v_cndmask_b32 v18, v18, v19, vcc
    v_cmp_gt_u32 vcc, 2, v16
    s_nop 1
    v_cndmask_b32 v18, 0, v18, vcc
    v_cmp_eq_u32 vcc, 0, v17
    s_nop 1
    v_cndmask_b32 v20, 0, v18, vcc
    v_cmp_eq_u32 vcc, 1, v17
    s_nop 1
    v_cndmask_b32 v21, 0, v18, vcc
    v_cmp_eq_u32 vcc, 2, v17
    s_nop 1
    v_cndmask_b32 v22, 0, v18, vcc
    v_cmp_eq_u32 vcc, 3, v17
    s_nop 1
    v_cndmask_b32 v23, 0, v18, vcc
    ds_write_b128 v2, v[20:23] offset:30720
    s_bfe_u32 s17, s15, 0x20000
    s_lshl_b32 s17, s17, 16
    s_bfe_u32 s49, s14, 0x50000
    s_lshl_b32 s49, s49, 6
    s_add_u32 s17, s17, s49
    s_add_u32 s17, s17, 0x6c00000
    s_bfe_u32 s18, s15, 0x20000
    s_lshl_b32 s18, s18, 16
    s_bfe_u32 s49, s14, 0x50000
    s_lshl_b32 s49, s49, 6
    s_add_u32 s18, s18, s49
    s_add_u32 s18, s18, 0x6c01000
    s_bfe_u32 s19, s14, 0x50000
    s_lshl_b32 s19, s19, 13
    s_bfe_u32 s49, s15, 0x20000
    s_lshl_b32 s49, s49, 11
    s_add_u32 s19, s19, s49
    s_add_u32 s19, s19, 0x6c00000
    s_bfe_u32 s52, s14, 0x20003
    s_lshl_b32 s52, s52, 11
    s_bfe_u32 s49, s15, 0x20000
    s_lshl_b32 s49, s49, 9
    s_add_u32 s52, s52, s49
    s_bfe_u32 s49, s14, 0x10000
    s_lshl_b32 s49, s49, 8
    s_add_u32 s52, s52, s49
    s_bfe_u32 s49, s14, 0x20001
    s_lshl_b32 s49, s49, 6
    s_add_u32 s52, s52, s49
    s_mov_b32 s22, 0x6c80000
    s_add_u32 s24, s52, 0x6c80000
    s_add_u32 s23, s52, 0x6c82000
    s_mul_i32 s48, s14, 1064960
    s_bfe_u32 s25, s15, 0x20000
    s_lshl_b32 s25, s25, 12
    s_add_u32 s25, s25, s48
    s_mul_i32 s48, s14, 266240
    s_bfe_u32 s27, s15, 0x20000
    s_lshl_b32 s27, s27, 10
    s_add_u32 s27, s27, 0x6000000
    s_add_u32 s27, s27, s48
    s_mov_b32 s16, 0
    s_mov_b32 s28, 1
    s_mov_b32 s29, 100000
    s_mov_b32 s31, 0x3e0293ee
    s_mov_b32 s58, s31
    s_mov_b32 s59, s31
    s_mov_b32 s46, 0x33333333
    s_mov_b32 s47, 0x33333333
    v_bfe_u32 v31, v0, 4, 1
    v_lshlrev_b32 v28, 5, v31
    v_bfe_u32 v31, v0, 0, 4
    v_lshlrev_b32 v29, 4, v31
    v_xor_b32 v28, v28, v29
    v_bfe_u32 v31, v0, 4, 2
    v_lshlrev_b32 v30, 10, v31
    v_add_u32 v36, v28, v30
    v_xor_b32 v37, 64, v36
    v_xor_b32 v38, 128, v36
    v_xor_b32 v39, 192, v36
    v_bfe_u32 v31, v0, 2, 1
    v_lshlrev_b32 v28, 12, v31
    v_bfe_u32 v31, v0, 5, 1
    v_lshl_add_u32 v28, v31, 11, v28
    v_bfe_u32 v31, v0, 4, 1
    v_lshl_add_u32 v28, v31, 9, v28
    v_bfe_u32 v31, v0, 3, 1
    v_lshl_add_u32 v28, v31, 10, v28
    v_bfe_u32 v31, v0, 0, 1
    v_lshl_add_u32 v28, v31, 3, v28
    v_bfe_u32 v31, v0, 6, 2
    v_lshlrev_b32 v29, 6, v31
    v_bfe_u32 v31, v0, 1, 1
    v_lshl_add_u32 v29, v31, 4, v29
    v_bfe_u32 v31, v0, 4, 1
    v_lshlrev_b32 v30, 5, v31
    v_bfe_u32 v31, v0, 3, 1
    v_lshl_add_u32 v30, v31, 6, v30
    v_bfe_u32 v31, v0, 2, 1
    v_lshl_add_u32 v30, v31, 7, v30
    v_xor_b32 v29, v29, v30
    v_add_u32 v40, v28, v29
    v_xor_b32 v41, 32, v40
    s_cmp_lg_u32 s15, 0
    s_cbranch_scc1 R_wl1
    s_waitcnt vmcnt(24)
    s_barrier
    v_add_u32 v26, 32768, v40
    v_add_u32 v27, 32768, v41
    ds_read_b64_tr_b16 a[0:1], v26 offset:0
    ds_read_b64_tr_b16 a[2:3], v26 offset:256
    ds_read_b64_tr_b16 a[4:5], v26 offset:8192
    ds_read_b64_tr_b16 a[6:7], v26 offset:8448
    ds_read_b64_tr_b16 a[64:65], v27 offset:0
    ds_read_b64_tr_b16 a[66:67], v27 offset:256
    ds_read_b64_tr_b16 a[68:69], v27 offset:8192
    ds_read_b64_tr_b16 a[70:71], v27 offset:8448
    ds_read_b64_tr_b16 a[8:9], v26 offset:16384
    ds_read_b64_tr_b16 a[10:11], v26 offset:16640
    ds_read_b64_tr_b16 a[12:13], v26 offset:24576
    ds_read_b64_tr_b16 a[14:15], v26 offset:24832
    ds_read_b64_tr_b16 a[72:73], v27 offset:16384
    ds_read_b64_tr_b16 a[74:75], v27 offset:16640
    ds_read_b64_tr_b16 a[76:77], v27 offset:24576
    ds_read_b64_tr_b16 a[78:79], v27 offset:24832
    s_waitcnt lgkmcnt(0)
    s_waitcnt vmcnt(16)
    s_barrier
    s_mov_b32 s8, s38
    s_and_b32 s9, s39, 0xffff
    s_mov_b32 s10, 0x400000
    s_mov_b32 s11, 0x00020000
    s_add_u32 m0, s51, 0
    s_add_u32 s48, s50, 0x0
    buffer_load_dwordx4 v32, s[8:11], s48 offen lds
    s_add_u32 m0, s51, 1024
    s_add_u32 s48, s50, 0x8000
    buffer_load_dwordx4 v33, s[8:11], s48 offen lds
    s_add_u32 m0, s51, 2048
    s_add_u32 s48, s50, 0x10000
    buffer_load_dwordx4 v32, s[8:11], s48 offen lds
    s_add_u32 m0, s51, 3072
    s_add_u32 s48, s50, 0x18000
    buffer_load_dwordx4 v33, s[8:11], s48 offen lds
    s_add_u32 m0, s51, 4096
    s_add_u32 s48, s50, 0x20000
    buffer_load_dwordx4 v34, s[8:11], s48 offen lds
    s_add_u32 m0, s51, 5120
    s_add_u32 s48, s50, 0x28000
    buffer_load_dwordx4 v35, s[8:11], s48 offen lds
    s_add_u32 m0, s51, 6144
    s_add_u32 s48, s50, 0x30000
    buffer_load_dwordx4 v34, s[8:11], s48 offen lds
    s_add_u32 m0, s51, 7168
    s_add_u32 s48, s50, 0x38000
    buffer_load_dwordx4 v35, s[8:11], s48 offen lds
    v_add_u32 v26, 65536, v40
    v_add_u32 v27, 65536, v41
    ds_read_b64_tr_b16 a[16:17], v26 offset:0
    ds_read_b64_tr_b16 a[18:19], v26 offset:256
    ds_read_b64_tr_b16 a[20:21], v26 offset:8192
    ds_read_b64_tr_b16 a[22:23], v26 offset:8448
    ds_read_b64_tr_b16 a[80:81], v27 offset:0
    ds_read_b64_tr_b16 a[82:83], v27 offset:256
    ds_read_b64_tr_b16 a[84:85], v27 offset:8192
    ds_read_b64_tr_b16 a[86:87], v27 offset:8448
    ds_read_b64_tr_b16 a[24:25], v26 offset:16384
    ds_read_b64_tr_b16 a[26:27], v26 offset:16640
    ds_read_b64_tr_b16 a[28:29], v26 offset:24576
    ds_read_b64_tr_b16 a[30:31], v26 offset:24832
    ds_read_b64_tr_b16 a[88:89], v27 offset:16384
    ds_read_b64_tr_b16 a[90:91], v27 offset:16640
    ds_read_b64_tr_b16 a[92:93], v27 offset:24576
    ds_read_b64_tr_b16 a[94:95], v27 offset:24832
    s_waitcnt lgkmcnt(0)
    s_waitcnt vmcnt(16)
    s_barrier
    s_add_u32 m0, s51, 32768
    s_add_u32 s48, s50, 0x100000
    buffer_load_dwordx4 v32, s[8:11], s48 offen lds
    s_add_u32 m0, s51, 33792
    s_add_u32 s48, s50, 0x108000
    buffer_load_dwordx4 v33, s[8:11], s48 offen lds
    s_add_u32 m0, s51, 34816
    s_add_u32 s48, s50, 0x110000
    buffer_load_dwordx4 v32, s[8:11], s48 offen lds
    s_add_u32 m0, s51, 35840
    s_add_u32 s48, s50, 0x118000
    buffer_load_dwordx4 v33, s[8:11], s48 offen lds
    s_add_u32 m0, s51, 36864
    s_add_u32 s48, s50, 0x120000
    buffer_load_dwordx4 v34, s[8:11], s48 offen lds
    s_add_u32 m0, s51, 37888
    s_add_u32 s48, s50, 0x128000
    buffer_load_dwordx4 v35, s[8:11], s48 offen lds
    s_add_u32 m0, s51, 38912
    s_add_u32 s48, s50, 0x130000
    buffer_load_dwordx4 v34, s[8:11], s48 offen lds
    s_add_u32 m0, s51, 39936
    s_add_u32 s48, s50, 0x138000
    buffer_load_dwordx4 v35, s[8:11], s48 offen lds
    v_add_u32 v26, 98304, v40
    v_add_u32 v27, 98304, v41
    ds_read_b64_tr_b16 a[32:33], v26 offset:0
    ds_read_b64_tr_b16 a[34:35], v26 offset:256
    ds_read_b64_tr_b16 a[36:37], v26 offset:8192
    ds_read_b64_tr_b16 a[38:39], v26 offset:8448
    ds_read_b64_tr_b16 a[96:97], v27 offset:0
    ds_read_b64_tr_b16 a[98:99], v27 offset:256
    ds_read_b64_tr_b16 a[100:101], v27 offset:8192
    ds_read_b64_tr_b16 a[102:103], v27 offset:8448
    ds_read_b64_tr_b16 a[40:41], v26 offset:16384
    ds_read_b64_tr_b16 a[42:43], v26 offset:16640
    ds_read_b64_tr_b16 a[44:45], v26 offset:24576
    ds_read_b64_tr_b16 a[46:47], v26 offset:24832
    ds_read_b64_tr_b16 a[104:105], v27 offset:16384
    ds_read_b64_tr_b16 a[106:107], v27 offset:16640
    ds_read_b64_tr_b16 a[108:109], v27 offset:24576
    ds_read_b64_tr_b16 a[110:111], v27 offset:24832
    s_waitcnt lgkmcnt(0)
    s_waitcnt vmcnt(16)
    s_barrier
    s_add_u32 m0, s51, 65536
    s_add_u32 s48, s50, 0x200000
    buffer_load_dwordx4 v32, s[8:11], s48 offen lds
    s_add_u32 m0, s51, 66560
    s_add_u32 s48, s50, 0x208000
    buffer_load_dwordx4 v33, s[8:11], s48 offen lds
    s_add_u32 m0, s51, 67584
    s_add_u32 s48, s50, 0x210000
    buffer_load_dwordx4 v32, s[8:11], s48 offen lds
    s_add_u32 m0, s51, 68608
    s_add_u32 s48, s50, 0x218000
    buffer_load_dwordx4 v33, s[8:11], s48 offen lds
    s_add_u32 m0, s51, 69632
    s_add_u32 s48, s50, 0x220000
    buffer_load_dwordx4 v34, s[8:11], s48 offen lds
    s_add_u32 m0, s51, 70656
    s_add_u32 s48, s50, 0x228000
    buffer_load_dwordx4 v35, s[8:11], s48 offen lds
    s_add_u32 m0, s51, 71680
    s_add_u32 s48, s50, 0x230000
    buffer_load_dwordx4 v34, s[8:11], s48 offen lds
    s_add_u32 m0, s51, 72704
    s_add_u32 s48, s50, 0x238000
    buffer_load_dwordx4 v35, s[8:11], s48 offen lds
    v_add_u32 v26, 131072, v40
    v_add_u32 v27, 131072, v41
    ds_read_b64_tr_b16 a[48:49], v26 offset:0
    ds_read_b64_tr_b16 a[50:51], v26 offset:256
    ds_read_b64_tr_b16 a[52:53], v26 offset:8192
    ds_read_b64_tr_b16 a[54:55], v26 offset:8448
    ds_read_b64_tr_b16 a[112:113], v27 offset:0
    ds_read_b64_tr_b16 a[114:115], v27 offset:256
    ds_read_b64_tr_b16 a[116:117], v27 offset:8192
    ds_read_b64_tr_b16 a[118:119], v27 offset:8448
    ds_read_b64_tr_b16 a[56:57], v26 offset:16384
    ds_read_b64_tr_b16 a[58:59], v26 offset:16640
    ds_read_b64_tr_b16 a[60:61], v26 offset:24576
    ds_read_b64_tr_b16 a[62:63], v26 offset:24832
    ds_read_b64_tr_b16 a[120:121], v27 offset:16384
    ds_read_b64_tr_b16 a[122:123], v27 offset:16640
    ds_read_b64_tr_b16 a[124:125], v27 offset:24576
    ds_read_b64_tr_b16 a[126:127], v27 offset:24832
    s_waitcnt lgkmcnt(0)
    s_waitcnt vmcnt(16)
    s_barrier
    s_add_u32 m0, s51, 98304
    s_add_u32 s48, s50, 0x300000
    buffer_load_dwordx4 v32, s[8:11], s48 offen lds
    s_add_u32 m0, s51, 99328
    s_add_u32 s48, s50, 0x308000
    buffer_load_dwordx4 v33, s[8:11], s48 offen lds
    s_add_u32 m0, s51, 100352
    s_add_u32 s48, s50, 0x310000
    buffer_load_dwordx4 v32, s[8:11], s48 offen lds
    s_add_u32 m0, s51, 101376
    s_add_u32 s48, s50, 0x318000
    buffer_load_dwordx4 v33, s[8:11], s48 offen lds
    s_add_u32 m0, s51, 102400
    s_add_u32 s48, s50, 0x320000
    buffer_load_dwordx4 v34, s[8:11], s48 offen lds
    s_add_u32 m0, s51, 103424
    s_add_u32 s48, s50, 0x328000
    buffer_load_dwordx4 v35, s[8:11], s48 offen lds
    s_add_u32 m0, s51, 104448
    s_add_u32 s48, s50, 0x330000
    buffer_load_dwordx4 v34, s[8:11], s48 offen lds
    s_add_u32 m0, s51, 105472
    s_add_u32 s48, s50, 0x338000
    buffer_load_dwordx4 v35, s[8:11], s48 offen lds
    v_add_u32 v26, 32768, v40
    v_add_u32 v27, 32768, v41
    ds_read_b64_tr_b16 a[128:129], v26 offset:0
    ds_read_b64_tr_b16 a[130:131], v26 offset:256
    ds_read_b64_tr_b16 a[132:133], v26 offset:8192
    ds_read_b64_tr_b16 a[134:135], v26 offset:8448
    ds_read_b64_tr_b16 a[192:193], v27 offset:0
    ds_read_b64_tr_b16 a[194:195], v27 offset:256
    ds_read_b64_tr_b16 a[196:197], v27 offset:8192
    ds_read_b64_tr_b16 a[198:199], v27 offset:8448
    ds_read_b64_tr_b16 a[136:137], v26 offset:16384
    ds_read_b64_tr_b16 a[138:139], v26 offset:16640
    ds_read_b64_tr_b16 a[140:141], v26 offset:24576
    ds_read_b64_tr_b16 a[142:143], v26 offset:24832
    ds_read_b64_tr_b16 a[200:201], v27 offset:16384
    ds_read_b64_tr_b16 a[202:203], v27 offset:16640
    ds_read_b64_tr_b16 a[204:205], v27 offset:24576
    ds_read_b64_tr_b16 a[206:207], v27 offset:24832
    s_waitcnt lgkmcnt(0)
    s_waitcnt vmcnt(16)
    s_barrier
    s_mov_b32 s8, s40
    s_and_b32 s9, s41, 0xffff
    s_mov_b32 s10, 0x400000
    s_mov_b32 s11, 0x00020000
    s_add_u32 m0, s51, 0
    s_add_u32 s48, s50, 0x0
    buffer_load_dwordx4 v32, s[8:11], s48 offen lds
    s_add_u32 m0, s51, 1024
    s_add_u32 s48, s50, 0x8000
    buffer_load_dwordx4 v33, s[8:11], s48 offen lds
    s_add_u32 m0, s51, 2048
    s_add_u32 s48, s50, 0x10000
    buffer_load_dwordx4 v32, s[8:11], s48 offen lds
    s_add_u32 m0, s51, 3072
    s_add_u32 s48, s50, 0x18000
    buffer_load_dwordx4 v33, s[8:11], s48 offen lds
    s_add_u32 m0, s51, 4096
    s_add_u32 s48, s50, 0x20000
    buffer_load_dwordx4 v34, s[8:11], s48 offen lds
    s_add_u32 m0, s51, 5120
    s_add_u32 s48, s50, 0x28000
    buffer_load_dwordx4 v35, s[8:11], s48 offen lds
    s_add_u32 m0, s51, 6144
    s_add_u32 s48, s50, 0x30000
    buffer_load_dwordx4 v34, s[8:11], s48 offen lds
    s_add_u32 m0, s51, 7168
    s_add_u32 s48, s50, 0x38000
    buffer_load_dwordx4 v35, s[8:11], s48 offen lds
    v_add_u32 v26, 65536, v40
    v_add_u32 v27, 65536, v41
    ds_read_b64_tr_b16 a[144:145], v26 offset:0
    ds_read_b64_tr_b16 a[146:147], v26 offset:256
    ds_read_b64_tr_b16 a[148:149], v26 offset:8192
    ds_read_b64_tr_b16 a[150:151], v26 offset:8448
    ds_read_b64_tr_b16 a[208:209], v27 offset:0
    ds_read_b64_tr_b16 a[210:211], v27 offset:256
    ds_read_b64_tr_b16 a[212:213], v27 offset:8192
    ds_read_b64_tr_b16 a[214:215], v27 offset:8448
    ds_read_b64_tr_b16 a[152:153], v26 offset:16384
    ds_read_b64_tr_b16 a[154:155], v26 offset:16640
    ds_read_b64_tr_b16 a[156:157], v26 offset:24576
    ds_read_b64_tr_b16 a[158:159], v26 offset:24832
    ds_read_b64_tr_b16 a[216:217], v27 offset:16384
    ds_read_b64_tr_b16 a[218:219], v27 offset:16640
    ds_read_b64_tr_b16 a[220:221], v27 offset:24576
    ds_read_b64_tr_b16 a[222:223], v27 offset:24832
    s_waitcnt lgkmcnt(0)
    s_waitcnt vmcnt(16)
    s_barrier
    s_add_u32 m0, s51, 32768
    s_add_u32 s48, s50, 0x100000
    buffer_load_dwordx4 v32, s[8:11], s48 offen lds
    s_add_u32 m0, s51, 33792
    s_add_u32 s48, s50, 0x108000
    buffer_load_dwordx4 v33, s[8:11], s48 offen lds
    s_add_u32 m0, s51, 34816
    s_add_u32 s48, s50, 0x110000
    buffer_load_dwordx4 v32, s[8:11], s48 offen lds
    s_add_u32 m0, s51, 35840
    s_add_u32 s48, s50, 0x118000
    buffer_load_dwordx4 v33, s[8:11], s48 offen lds
    s_add_u32 m0, s51, 36864
    s_add_u32 s48, s50, 0x120000
    buffer_load_dwordx4 v34, s[8:11], s48 offen lds
    s_add_u32 m0, s51, 37888
    s_add_u32 s48, s50, 0x128000
    buffer_load_dwordx4 v35, s[8:11], s48 offen lds
    s_add_u32 m0, s51, 38912
    s_add_u32 s48, s50, 0x130000
    buffer_load_dwordx4 v34, s[8:11], s48 offen lds
    s_add_u32 m0, s51, 39936
    s_add_u32 s48, s50, 0x138000
    buffer_load_dwordx4 v35, s[8:11], s48 offen lds
    s_or_b32 s48, s75, s15
    s_cbranch_scc1 cl_4
    s_lshl_b32 s48, s3, 2
    s_add_u32 s48, s48, 60
    s_cmp_eq_u32 s3, 0
    s_cselect_b32 s48, 0, s48
    s_lshl_b32 s49, 1, s14
    v_mov_b32 v124, s48
    v_mov_b32 v125, s49
    s_mov_b64 exec, 1
    global_atomic_or v126, v124, v125, s[12:13] sc0
    s_mov_b64 exec, -1
cl_4:
    v_add_u32 v26, 98304, v40
    v_add_u32 v27, 98304, v41
    ds_read_b64_tr_b16 a[160:161], v26 offset:0
    ds_read_b64_tr_b16 a[162:163], v26 offset:256
    ds_read_b64_tr_b16 a[164:165], v26 offset:8192
    ds_read_b64_tr_b16 a[166:167], v26 offset:8448
    ds_read_b64_tr_b16 a[224:225], v27 offset:0
    ds_read_b64_tr_b16 a[226:227], v27 offset:256
    ds_read_b64_tr_b16 a[228:229], v27 offset:8192
    ds_read_b64_tr_b16 a[230:231], v27 offset:8448
    ds_read_b64_tr_b16 a[168:169], v26 offset:16384
    ds_read_b64_tr_b16 a[170:171], v26 offset:16640
    ds_read_b64_tr_b16 a[172:173], v26 offset:24576
    ds_read_b64_tr_b16 a[174:175], v26 offset:24832
    ds_read_b64_tr_b16 a[232:233], v27 offset:16384
    ds_read_b64_tr_b16 a[234:235], v27 offset:16640
    ds_read_b64_tr_b16 a[236:237], v27 offset:24576
    ds_read_b64_tr_b16 a[238:239], v27 offset:24832
    s_waitcnt lgkmcnt(0)
    s_waitcnt vmcnt(16)
    s_barrier
    s_add_u32 m0, s51, 65536
    s_add_u32 s48, s50, 0x200000
    buffer_load_dwordx4 v32, s[8:11], s48 offen lds
    s_add_u32 m0, s51, 66560
    s_add_u32 s48, s50, 0x208000
    buffer_load_dwordx4 v33, s[8:11], s48 offen lds
    s_add_u32 m0, s51, 67584
    s_add_u32 s48, s50, 0x210000
    buffer_load_dwordx4 v32, s[8:11], s48 offen lds
    s_add_u32 m0, s51, 68608
    s_add_u32 s48, s50, 0x218000
    buffer_load_dwordx4 v33, s[8:11], s48 offen lds
    s_add_u32 m0, s51, 69632
    s_add_u32 s48, s50, 0x220000
    buffer_load_dwordx4 v34, s[8:11], s48 offen lds
    s_add_u32 m0, s51, 70656
    s_add_u32 s48, s50, 0x228000
    buffer_load_dwordx4 v35, s[8:11], s48 offen lds
    s_add_u32 m0, s51, 71680
    s_add_u32 s48, s50, 0x230000
    buffer_load_dwordx4 v34, s[8:11], s48 offen lds
    s_add_u32 m0, s51, 72704
    s_add_u32 s48, s50, 0x238000
    buffer_load_dwordx4 v35, s[8:11], s48 offen lds
    v_add_u32 v26, 131072, v40
    v_add_u32 v27, 131072, v41
    ds_read_b64_tr_b16 a[176:177], v26 offset:0
    ds_read_b64_tr_b16 a[178:179], v26 offset:256
    ds_read_b64_tr_b16 a[180:181], v26 offset:8192
    ds_read_b64_tr_b16 a[182:183], v26 offset:8448
    ds_read_b64_tr_b16 a[240:241], v27 offset:0
    ds_read_b64_tr_b16 a[242:243], v27 offset:256
    ds_read_b64_tr_b16 a[244:245], v27 offset:8192
    ds_read_b64_tr_b16 a[246:247], v27 offset:8448
    ds_read_b64_tr_b16 a[184:185], v26 offset:16384
    ds_read_b64_tr_b16 a[186:187], v26 offset:16640
    ds_read_b64_tr_b16 a[188:189], v26 offset:24576
    ds_read_b64_tr_b16 a[190:191], v26 offset:24832
    ds_read_b64_tr_b16 a[248:249], v27 offset:16384
    ds_read_b64_tr_b16 a[250:251], v27 offset:16640
    ds_read_b64_tr_b16 a[252:253], v27 offset:24576
    ds_read_b64_tr_b16 a[254:255], v27 offset:24832
    s_waitcnt lgkmcnt(0)
    s_waitcnt vmcnt(16)
    s_barrier
    s_add_u32 m0, s51, 98304
    s_add_u32 s48, s50, 0x300000
    buffer_load_dwordx4 v32, s[8:11], s48 offen lds
    s_add_u32 m0, s51, 99328
    s_add_u32 s48, s50, 0x308000
    buffer_load_dwordx4 v33, s[8:11], s48 offen lds
    s_add_u32 m0, s51, 100352
    s_add_u32 s48, s50, 0x310000
    buffer_load_dwordx4 v32, s[8:11], s48 offen lds
    s_add_u32 m0, s51, 101376
    s_add_u32 s48, s50, 0x318000
    buffer_load_dwordx4 v33, s[8:11], s48 offen lds
    s_add_u32 m0, s51, 102400
    s_add_u32 s48, s50, 0x320000
    buffer_load_dwordx4 v34, s[8:11], s48 offen lds
    s_add_u32 m0, s51, 103424
    s_add_u32 s48, s50, 0x328000
    buffer_load_dwordx4 v35, s[8:11], s48 offen lds
    s_add_u32 m0, s51, 104448
    s_add_u32 s48, s50, 0x330000
    buffer_load_dwordx4 v34, s[8:11], s48 offen lds
    s_add_u32 m0, s51, 105472
    s_add_u32 s48, s50, 0x338000
    buffer_load_dwordx4 v35, s[8:11], s48 offen lds
    v_add_u32 v26, 32768, v40
    v_add_u32 v27, 32768, v41
    ds_read_b64_tr_b16 v[128:129], v26 offset:0
    ds_read_b64_tr_b16 v[130:131], v26 offset:256
    ds_read_b64_tr_b16 v[132:133], v26 offset:8192
    ds_read_b64_tr_b16 v[134:135], v26 offset:8448
    ds_read_b64_tr_b16 v[192:193], v27 offset:0
    ds_read_b64_tr_b16 v[194:195], v27 offset:256
    ds_read_b64_tr_b16 v[196:197], v27 offset:8192
    ds_read_b64_tr_b16 v[198:199], v27 offset:8448
    ds_read_b64_tr_b16 v[136:137], v26 offset:16384
    ds_read_b64_tr_b16 v[138:139], v26 offset:16640
    ds_read_b64_tr_b16 v[140:141], v26 offset:24576
    ds_read_b64_tr_b16 v[142:143], v26 offset:24832
    ds_read_b64_tr_b16 v[200:201], v27 offset:16384
    ds_read_b64_tr_b16 v[202:203], v27 offset:16640
    ds_read_b64_tr_b16 v[204:205], v27 offset:24576
    ds_read_b64_tr_b16 v[206:207], v27 offset:24832
    s_waitcnt lgkmcnt(0)
    s_waitcnt vmcnt(16)
    s_barrier
    s_mov_b32 s8, s42
    s_and_b32 s9, s43, 0xffff
    s_mov_b32 s10, 0x400000
    s_mov_b32 s11, 0x00020000
    s_add_u32 m0, s51, 0
    s_add_u32 s48, s53, 0x0
    buffer_load_dwordx4 v36, s[8:11], s48 offen lds
    s_add_u32 m0, s51, 1024
    s_add_u32 s48, s53, 0x1000
    buffer_load_dwordx4 v37, s[8:11], s48 offen lds
    s_add_u32 m0, s51, 2048
    s_add_u32 s48, s53, 0x2000
    buffer_load_dwordx4 v36, s[8:11], s48 offen lds
    s_add_u32 m0, s51, 3072
    s_add_u32 s48, s53, 0x3000
    buffer_load_dwordx4 v37, s[8:11], s48 offen lds
    s_add_u32 m0, s51, 4096
    s_add_u32 s48, s53, 0x4000
    buffer_load_dwordx4 v38, s[8:11], s48 offen lds
    s_add_u32 m0, s51, 5120
    s_add_u32 s48, s53, 0x5000
    buffer_load_dwordx4 v39, s[8:11], s48 offen lds
    s_add_u32 m0, s51, 6144
    s_add_u32 s48, s53, 0x6000
    buffer_load_dwordx4 v38, s[8:11], s48 offen lds
    s_add_u32 m0, s51, 7168
    s_add_u32 s48, s53, 0x7000
    buffer_load_dwordx4 v39, s[8:11], s48 offen lds
    v_add_u32 v26, 65536, v40
    v_add_u32 v27, 65536, v41
    ds_read_b64_tr_b16 v[144:145], v26 offset:0
    ds_read_b64_tr_b16 v[146:147], v26 offset:256
    ds_read_b64_tr_b16 v[148:149], v26 offset:8192
    ds_read_b64_tr_b16 v[150:151], v26 offset:8448
    ds_read_b64_tr_b16 v[208:209], v27 offset:0
    ds_read_b64_tr_b16 v[210:211], v27 offset:256
    ds_read_b64_tr_b16 v[212:213], v27 offset:8192
    ds_read_b64_tr_b16 v[214:215], v27 offset:8448
    ds_read_b64_tr_b16 v[152:153], v26 offset:16384
    ds_read_b64_tr_b16 v[154:155], v26 offset:16640
    ds_read_b64_tr_b16 v[156:157], v26 offset:24576
    ds_read_b64_tr_b16 v[158:159], v26 offset:24832
    ds_read_b64_tr_b16 v[216:217], v27 offset:16384
    ds_read_b64_tr_b16 v[218:219], v27 offset:16640
    ds_read_b64_tr_b16 v[220:221], v27 offset:24576
    ds_read_b64_tr_b16 v[222:223], v27 offset:24832
    s_waitcnt lgkmcnt(0)
    s_waitcnt vmcnt(16)
    s_barrier
    s_add_u32 m0, s51, 32768
    s_add_u32 s48, s53, 0x100
    buffer_load_dwordx4 v36, s[8:11], s48 offen lds
    s_add_u32 m0, s51, 33792
    s_add_u32 s48, s53, 0x1100
    buffer_load_dwordx4 v37, s[8:11], s48 offen lds
    s_add_u32 m0, s51, 34816
    s_add_u32 s48, s53, 0x2100
    buffer_load_dwordx4 v36, s[8:11], s48 offen lds
    s_add_u32 m0, s51, 35840
    s_add_u32 s48, s53, 0x3100
    buffer_load_dwordx4 v37, s[8:11], s48 offen lds
    s_add_u32 m0, s51, 36864
    s_add_u32 s48, s53, 0x4100
    buffer_load_dwordx4 v38, s[8:11], s48 offen lds
    s_add_u32 m0, s51, 37888
    s_add_u32 s48, s53, 0x5100
    buffer_load_dwordx4 v39, s[8:11], s48 offen lds
    s_add_u32 m0, s51, 38912
    s_add_u32 s48, s53, 0x6100
    buffer_load_dwordx4 v38, s[8:11], s48 offen lds
    s_add_u32 m0, s51, 39936
    s_add_u32 s48, s53, 0x7100
    buffer_load_dwordx4 v39, s[8:11], s48 offen lds
    v_add_u32 v26, 98304, v40
    v_add_u32 v27, 98304, v41
    ds_read_b64_tr_b16 v[160:161], v26 offset:0
    ds_read_b64_tr_b16 v[162:163], v26 offset:256
    ds_read_b64_tr_b16 v[164:165], v26 offset:8192
    ds_read_b64_tr_b16 v[166:167], v26 offset:8448
    ds_read_b64_tr_b16 v[224:225], v27 offset:0
    ds_read_b64_tr_b16 v[226:227], v27 offset:256
    ds_read_b64_tr_b16 v[228:229], v27 offset:8192
    ds_read_b64_tr_b16 v[230:231], v27 offset:8448
    ds_read_b64_tr_b16 v[168:169], v26 offset:16384
    ds_read_b64_tr_b16 v[170:171], v26 offset:16640
    ds_read_b64_tr_b16 v[172:173], v26 offset:24576
    ds_read_b64_tr_b16 v[174:175], v26 offset:24832
    ds_read_b64_tr_b16 v[232:233], v27 offset:16384
    ds_read_b64_tr_b16 v[234:235], v27 offset:16640
    ds_read_b64_tr_b16 v[236:237], v27 offset:24576
    ds_read_b64_tr_b16 v[238:239], v27 offset:24832
    s_waitcnt lgkmcnt(0)
    s_waitcnt vmcnt(16)
    s_barrier
    s_add_u32 m0, s51, 65536
    s_add_u32 s48, s53, 0x200
    buffer_load_dwordx4 v36, s[8:11], s48 offen lds
    s_add_u32 m0, s51, 66560
    s_add_u32 s48, s53, 0x1200
    buffer_load_dwordx4 v37, s[8:11], s48 offen lds
    s_add_u32 m0, s51, 67584
    s_add_u32 s48, s53, 0x2200
    buffer_load_dwordx4 v36, s[8:11], s48 offen lds
    s_add_u32 m0, s51, 68608
    s_add_u32 s48, s53, 0x3200
    buffer_load_dwordx4 v37, s[8:11], s48 offen lds
    s_add_u32 m0, s51, 69632
    s_add_u32 s48, s53, 0x4200
    buffer_load_dwordx4 v38, s[8:11], s48 offen lds
    s_add_u32 m0, s51, 70656
    s_add_u32 s48, s53, 0x5200
    buffer_load_dwordx4 v39, s[8:11], s48 offen lds
    s_add_u32 m0, s51, 71680
    s_add_u32 s48, s53, 0x6200
    buffer_load_dwordx4 v38, s[8:11], s48 offen lds
    s_add_u32 m0, s51, 72704
    s_add_u32 s48, s53, 0x7200
    buffer_load_dwordx4 v39, s[8:11], s48 offen lds
    v_lshrrev_b32 v122, 2, v2
    v_add_u32 v26, 131072, v40
    v_add_u32 v27, 131072, v41
    ds_read_b64_tr_b16 v[176:177], v26 offset:0
    ds_read_b64_tr_b16 v[178:179], v26 offset:256
    ds_read_b64_tr_b16 v[180:181], v26 offset:8192
    ds_read_b64_tr_b16 v[182:183], v26 offset:8448
    ds_read_b64_tr_b16 v[240:241], v27 offset:0
    ds_read_b64_tr_b16 v[242:243], v27 offset:256
    ds_read_b64_tr_b16 v[244:245], v27 offset:8192
    ds_read_b64_tr_b16 v[246:247], v27 offset:8448
    ds_read_b64_tr_b16 v[184:185], v26 offset:16384
    ds_read_b64_tr_b16 v[186:187], v26 offset:16640
    ds_read_b64_tr_b16 v[188:189], v26 offset:24576
    ds_read_b64_tr_b16 v[190:191], v26 offset:24832
    ds_read_b64_tr_b16 v[248:249], v27 offset:16384
    ds_read_b64_tr_b16 v[250:251], v27 offset:16640
    ds_read_b64_tr_b16 v[252:253], v27 offset:24576
    ds_read_b64_tr_b16 v[254:255], v27 offset:24832
    s_waitcnt lgkmcnt(0)
    s_barrier
    s_add_u32 m0, s51, 98304
    s_add_u32 s48, s53, 0x300
    buffer_load_dwordx4 v36, s[8:11], s48 offen lds
    s_add_u32 m0, s51, 99328
    s_add_u32 s48, s53, 0x1300
    buffer_load_dwordx4 v37, s[8:11], s48 offen lds
    s_add_u32 m0, s51, 100352
    s_add_u32 s48, s53, 0x2300
    buffer_load_dwordx4 v36, s[8:11], s48 offen lds
    s_add_u32 m0, s51, 101376
    s_add_u32 s48, s53, 0x3300
    buffer_load_dwordx4 v37, s[8:11], s48 offen lds
    s_add_u32 m0, s51, 102400
    s_add_u32 s48, s53, 0x4300
    buffer_load_dwordx4 v38, s[8:11], s48 offen lds
    s_add_u32 m0, s51, 103424
    s_add_u32 s48, s53, 0x5300
    buffer_load_dwordx4 v39, s[8:11], s48 offen lds
    s_add_u32 m0, s51, 104448
    s_add_u32 s48, s53, 0x6300
    buffer_load_dwordx4 v38, s[8:11], s48 offen lds
    s_add_u32 m0, s51, 105472
    s_add_u32 s48, s53, 0x7300
    buffer_load_dwordx4 v39, s[8:11], s48 offen lds
    s_mov_b32 exec_lo, 1
    s_mov_b32 exec_hi, 256
    global_load_dword v123, v122, s[12:13] sc1
    s_mov_b64 exec, -1
    s_waitcnt vmcnt(0)
    ds_write_b32 v122, v123 offset:31744
    s_waitcnt lgkmcnt(0)
    s_branch R_wdone
R_wl1:
    s_cmp_lg_u32 s15, 1
    s_cbranch_scc1 R_wl2
    s_waitcnt vmcnt(24)
    s_barrier
    v_add_u32 v26, 32768, v40
    v_add_u32 v27, 32768, v41
    ds_read_b64_tr_b16 a[16:17], v26 offset:0
    ds_read_b64_tr_b16 a[18:19], v26 offset:256
    ds_read_b64_tr_b16 a[20:21], v26 offset:8192
    ds_read_b64_tr_b16 a[22:23], v26 offset:8448
    ds_read_b64_tr_b16 a[80:81], v27 offset:0
    ds_read_b64_tr_b16 a[82:83], v27 offset:256
    ds_read_b64_tr_b16 a[84:85], v27 offset:8192
    ds_read_b64_tr_b16 a[86:87], v27 offset:8448
    ds_read_b64_tr_b16 a[24:25], v26 offset:16384
    ds_read_b64_tr_b16 a[26:27], v26 offset:16640
    ds_read_b64_tr_b16 a[28:29], v26 offset:24576
    ds_read_b64_tr_b16 a[30:31], v26 offset:24832
    ds_read_b64_tr_b16 a[88:89], v27 offset:16384
    ds_read_b64_tr_b16 a[90:91], v27 offset:16640
    ds_read_b64_tr_b16 a[92:93], v27 offset:24576
    ds_read_b64_tr_b16 a[94:95], v27 offset:24832
    s_waitcnt lgkmcnt(0)
    s_waitcnt vmcnt(16)
    s_barrier
    s_mov_b32 s8, s38
    s_and_b32 s9, s39, 0xffff
    s_mov_b32 s10, 0x400000
    s_mov_b32 s11, 0x00020000
    s_add_u32 m0, s51, 0
    s_add_u32 s48, s50, 0x0
    buffer_load_dwordx4 v32, s[8:11], s48 offen lds
    s_add_u32 m0, s51, 1024
    s_add_u32 s48, s50, 0x8000
    buffer_load_dwordx4 v33, s[8:11], s48 offen lds
    s_add_u32 m0, s51, 2048
    s_add_u32 s48, s50, 0x10000
    buffer_load_dwordx4 v32, s[8:11], s48 offen lds
    s_add_u32 m0, s51, 3072
    s_add_u32 s48, s50, 0x18000
    buffer_load_dwordx4 v33, s[8:11], s48 offen lds
    s_add_u32 m0, s51, 4096
    s_add_u32 s48, s50, 0x20000
    buffer_load_dwordx4 v34, s[8:11], s48 offen lds
    s_add_u32 m0, s51, 5120
    s_add_u32 s48, s50, 0x28000
    buffer_load_dwordx4 v35, s[8:11], s48 offen lds
    s_add_u32 m0, s51, 6144
    s_add_u32 s48, s50, 0x30000
    buffer_load_dwordx4 v34, s[8:11], s48 offen lds
    s_add_u32 m0, s51, 7168
    s_add_u32 s48, s50, 0x38000
    buffer_load_dwordx4 v35, s[8:11], s48 offen lds
    v_add_u32 v26, 65536, v40
    v_add_u32 v27, 65536, v41
    ds_read_b64_tr_b16 a[0:1], v26 offset:0
    ds_read_b64_tr_b16 a[2:3], v26 offset:256
    ds_read_b64_tr_b16 a[4:5], v26 offset:8192
    ds_read_b64_tr_b16 a[6:7], v26 offset:8448
    ds_read_b64_tr_b16 a[64:65], v27 offset:0
    ds_read_b64_tr_b16 a[66:67], v27 offset:256
    ds_read_b64_tr_b16 a[68:69], v27 offset:8192
    ds_read_b64_tr_b16 a[70:71], v27 offset:8448
    ds_read_b64_tr_b16 a[8:9], v26 offset:16384
    ds_read_b64_tr_b16 a[10:11], v26 offset:16640
    ds_read_b64_tr_b16 a[12:13], v26 offset:24576
    ds_read_b64_tr_b16 a[14:15], v26 offset:24832
    ds_read_b64_tr_b16 a[72:73], v27 offset:16384
    ds_read_b64_tr_b16 a[74:75], v27 offset:16640
    ds_read_b64_tr_b16 a[76:77], v27 offset:24576
    ds_read_b64_tr_b16 a[78:79], v27 offset:24832
    s_waitcnt lgkmcnt(0)
    s_waitcnt vmcnt(16)
    s_barrier
    s_add_u32 m0, s51, 32768
    s_add_u32 s48, s50, 0x100000
    buffer_load_dwordx4 v32, s[8:11], s48 offen lds
    s_add_u32 m0, s51, 33792
    s_add_u32 s48, s50, 0x108000
    buffer_load_dwordx4 v33, s[8:11], s48 offen lds
    s_add_u32 m0, s51, 34816
    s_add_u32 s48, s50, 0x110000
    buffer_load_dwordx4 v32, s[8:11], s48 offen lds
    s_add_u32 m0, s51, 35840
    s_add_u32 s48, s50, 0x118000
    buffer_load_dwordx4 v33, s[8:11], s48 offen lds
    s_add_u32 m0, s51, 36864
    s_add_u32 s48, s50, 0x120000
    buffer_load_dwordx4 v34, s[8:11], s48 offen lds
    s_add_u32 m0, s51, 37888
    s_add_u32 s48, s50, 0x128000
    buffer_load_dwordx4 v35, s[8:11], s48 offen lds
    s_add_u32 m0, s51, 38912
    s_add_u32 s48, s50, 0x130000
    buffer_load_dwordx4 v34, s[8:11], s48 offen lds
    s_add_u32 m0, s51, 39936
    s_add_u32 s48, s50, 0x138000
    buffer_load_dwordx4 v35, s[8:11], s48 offen lds
    v_add_u32 v26, 98304, v40
    v_add_u32 v27, 98304, v41
    ds_read_b64_tr_b16 a[48:49], v26 offset:0
    ds_read_b64_tr_b16 a[50:51], v26 offset:256
    ds_read_b64_tr_b16 a[52:53], v26 offset:8192
    ds_read_b64_tr_b16 a[54:55], v26 offset:8448
    ds_read_b64_tr_b16 a[112:113], v27 offset:0
    ds_read_b64_tr_b16 a[114:115], v27 offset:256
    ds_read_b64_tr_b16 a[116:117], v27 offset:8192
    ds_read_b64_tr_b16 a[118:119], v27 offset:8448
    ds_read_b64_tr_b16 a[56:57], v26 offset:16384
    ds_read_b64_tr_b16 a[58:59], v26 offset:16640
    ds_read_b64_tr_b16 a[60:61], v26 offset:24576
    ds_read_b64_tr_b16 a[62:63], v26 offset:24832
    ds_read_b64_tr_b16 a[120:121], v27 offset:16384
    ds_read_b64_tr_b16 a[122:123], v27 offset:16640
    ds_read_b64_tr_b16 a[124:125], v27 offset:24576
    ds_read_b64_tr_b16 a[126:127], v27 offset:24832
    s_waitcnt lgkmcnt(0)
    s_waitcnt vmcnt(16)
    s_barrier
    s_add_u32 m0, s51, 65536
    s_add_u32 s48, s50, 0x200000
    buffer_load_dwordx4 v32, s[8:11], s48 offen lds
    s_add_u32 m0, s51, 66560
    s_add_u32 s48, s50, 0x208000
    buffer_load_dwordx4 v33, s[8:11], s48 offen lds
    s_add_u32 m0, s51, 67584
    s_add_u32 s48, s50, 0x210000
    buffer_load_dwordx4 v32, s[8:11], s48 offen lds
    s_add_u32 m0, s51, 68608
    s_add_u32 s48, s50, 0x218000
    buffer_load_dwordx4 v33, s[8:11], s48 offen lds
    s_add_u32 m0, s51, 69632
    s_add_u32 s48, s50, 0x220000
    buffer_load_dwordx4 v34, s[8:11], s48 offen lds
    s_add_u32 m0, s51, 70656
    s_add_u32 s48, s50, 0x228000
    buffer_load_dwordx4 v35, s[8:11], s48 offen lds
    s_add_u32 m0, s51, 71680
    s_add_u32 s48, s50, 0x230000
    buffer_load_dwordx4 v34, s[8:11], s48 offen lds
    s_add_u32 m0, s51, 72704
    s_add_u32 s48, s50, 0x238000
    buffer_load_dwordx4 v35, s[8:11], s48 offen lds
    v_add_u32 v26, 131072, v40
    v_add_u32 v27, 131072, v41
    ds_read_b64_tr_b16 a[32:33], v26 offset:0
    ds_read_b64_tr_b16 a[34:35], v26 offset:256
    ds_read_b64_tr_b16 a[36:37], v26 offset:8192
    ds_read_b64_tr_b16 a[38:39], v26 offset:8448
    ds_read_b64_tr_b16 a[96:97], v27 offset:0
    ds_read_b64_tr_b16 a[98:99], v27 offset:256
    ds_read_b64_tr_b16 a[100:101], v27 offset:8192
    ds_read_b64_tr_b16 a[102:103], v27 offset:8448
    ds_read_b64_tr_b16 a[40:41], v26 offset:16384
    ds_read_b64_tr_b16 a[42:43], v26 offset:16640
    ds_read_b64_tr_b16 a[44:45], v26 offset:24576
    ds_read_b64_tr_b16 a[46:47], v26 offset:24832
    ds_read_b64_tr_b16 a[104:105], v27 offset:16384
    ds_read_b64_tr_b16 a[106:107], v27 offset:16640
    ds_read_b64_tr_b16 a[108:109], v27 offset:24576
    ds_read_b64_tr_b16 a[110:111], v27 offset:24832
    s_waitcnt lgkmcnt(0)
    s_waitcnt vmcnt(16)
    s_barrier
    s_add_u32 m0, s51, 98304
    s_add_u32 s48, s50, 0x300000
    buffer_load_dwordx4 v32, s[8:11], s48 offen lds
    s_add_u32 m0, s51, 99328
    s_add_u32 s48, s50, 0x308000
    buffer_load_dwordx4 v33, s[8:11], s48 offen lds
    s_add_u32 m0, s51, 100352
    s_add_u32 s48, s50, 0x310000
    buffer_load_dwordx4 v32, s[8:11], s48 offen lds
    s_add_u32 m0, s51, 101376
    s_add_u32 s48, s50, 0x318000
    buffer_load_dwordx4 v33, s[8:11], s48 offen lds
    s_add_u32 m0, s51, 102400
    s_add_u32 s48, s50, 0x320000
    buffer_load_dwordx4 v34, s[8:11], s48 offen lds
    s_add_u32 m0, s51, 103424
    s_add_u32 s48, s50, 0x328000
    buffer_load_dwordx4 v35, s[8:11], s48 offen lds
    s_add_u32 m0, s51, 104448
    s_add_u32 s48, s50, 0x330000
    buffer_load_dwordx4 v34, s[8:11], s48 offen lds
    s_add_u32 m0, s51, 105472
    s_add_u32 s48, s50, 0x338000
    buffer_load_dwordx4 v35, s[8:11], s48 offen lds
    v_add_u32 v26, 32768, v40
    v_add_u32 v27, 32768, v41
    ds_read_b64_tr_b16 a[144:145], v26 offset:0
    ds_read_b64_tr_b16 a[146:147], v26 offset:256
    ds_read_b64_tr_b16 a[148:149], v26 offset:8192
    ds_read_b64_tr_b16 a[150:151], v26 offset:8448
    ds_read_b64_tr_b16 a[208:209], v27 offset:0
    ds_read_b64_tr_b16 a[210:211], v27 offset:256
    ds_read_b64_tr_b16 a[212:213], v27 offset:8192
    ds_read_b64_tr_b16 a[214:215], v27 offset:8448
    ds_read_b64_tr_b16 a[152:153], v26 offset:16384
    ds_read_b64_tr_b16 a[154:155], v26 offset:16640
    ds_read_b64_tr_b16 a[156:157], v26 offset:24576
    ds_read_b64_tr_b16 a[158:159], v26 offset:24832
    ds_read_b64_tr_b16 a[216:217], v27 offset:16384
    ds_read_b64_tr_b16 a[218:219], v27 offset:16640
    ds_read_b64_tr_b16 a[220:221], v27 offset:24576
    ds_read_b64_tr_b16 a[222:223], v27 offset:24832
    s_waitcnt lgkmcnt(0)
    s_waitcnt vmcnt(16)
    s_barrier
    s_mov_b32 s8, s40
    s_and_b32 s9, s41, 0xffff
    s_mov_b32 s10, 0x400000
    s_mov_b32 s11, 0x00020000
    s_add_u32 m0, s51, 0
    s_add_u32 s48, s50, 0x0
    buffer_load_dwordx4 v32, s[8:11], s48 offen lds
    s_add_u32 m0, s51, 1024
    s_add_u32 s48, s50, 0x8000
    buffer_load_dwordx4 v33, s[8:11], s48 offen lds
    s_add_u32 m0, s51, 2048
    s_add_u32 s48, s50, 0x10000
    buffer_load_dwordx4 v32, s[8:11], s48 offen lds
    s_add_u32 m0, s51, 3072
    s_add_u32 s48, s50, 0x18000
    buffer_load_dwordx4 v33, s[8:11], s48 offen lds
    s_add_u32 m0, s51, 4096
    s_add_u32 s48, s50, 0x20000
    buffer_load_dwordx4 v34, s[8:11], s48 offen lds
    s_add_u32 m0, s51, 5120
    s_add_u32 s48, s50, 0x28000
    buffer_load_dwordx4 v35, s[8:11], s48 offen lds
    s_add_u32 m0, s51, 6144
    s_add_u32 s48, s50, 0x30000
    buffer_load_dwordx4 v34, s[8:11], s48 offen lds
    s_add_u32 m0, s51, 7168
    s_add_u32 s48, s50, 0x38000
    buffer_load_dwordx4 v35, s[8:11], s48 offen lds
    v_add_u32 v26, 65536, v40
    v_add_u32 v27, 65536, v41
    ds_read_b64_tr_b16 a[128:129], v26 offset:0
    ds_read_b64_tr_b16 a[130:131], v26 offset:256
    ds_read_b64_tr_b16 a[132:133], v26 offset:8192
    ds_read_b64_tr_b16 a[134:135], v26 offset:8448
    ds_read_b64_tr_b16 a[192:193], v27 offset:0
    ds_read_b64_tr_b16 a[194:195], v27 offset:256
    ds_read_b64_tr_b16 a[196:197], v27 offset:8192
    ds_read_b64_tr_b16 a[198:199], v27 offset:8448
    ds_read_b64_tr_b16 a[136:137], v26 offset:16384
    ds_read_b64_tr_b16 a[138:139], v26 offset:16640
    ds_read_b64_tr_b16 a[140:141], v26 offset:24576
    ds_read_b64_tr_b16 a[142:143], v26 offset:24832
    ds_read_b64_tr_b16 a[200:201], v27 offset:16384
    ds_read_b64_tr_b16 a[202:203], v27 offset:16640
    ds_read_b64_tr_b16 a[204:205], v27 offset:24576
    ds_read_b64_tr_b16 a[206:207], v27 offset:24832
    s_waitcnt lgkmcnt(0)
    s_waitcnt vmcnt(16)
    s_barrier
    s_add_u32 m0, s51, 32768
    s_add_u32 s48, s50, 0x100000
    buffer_load_dwordx4 v32, s[8:11], s48 offen lds
    s_add_u32 m0, s51, 33792
    s_add_u32 s48, s50, 0x108000
    buffer_load_dwordx4 v33, s[8:11], s48 offen lds
    s_add_u32 m0, s51, 34816
    s_add_u32 s48, s50, 0x110000
    buffer_load_dwordx4 v32, s[8:11], s48 offen lds
    s_add_u32 m0, s51, 35840
    s_add_u32 s48, s50, 0x118000
    buffer_load_dwordx4 v33, s[8:11], s48 offen lds
    s_add_u32 m0, s51, 36864
    s_add_u32 s48, s50, 0x120000
    buffer_load_dwordx4 v34, s[8:11], s48 offen lds
    s_add_u32 m0, s51, 37888
    s_add_u32 s48, s50, 0x128000
    buffer_load_dwordx4 v35, s[8:11], s48 offen lds
    s_add_u32 m0, s51, 38912
    s_add_u32 s48, s50, 0x130000
    buffer_load_dwordx4 v34, s[8:11], s48 offen lds
    s_add_u32 m0, s51, 39936
    s_add_u32 s48, s50, 0x138000
    buffer_load_dwordx4 v35, s[8:11], s48 offen lds
    v_add_u32 v26, 98304, v40
    v_add_u32 v27, 98304, v41
    ds_read_b64_tr_b16 a[176:177], v26 offset:0
    ds_read_b64_tr_b16 a[178:179], v26 offset:256
    ds_read_b64_tr_b16 a[180:181], v26 offset:8192
    ds_read_b64_tr_b16 a[182:183], v26 offset:8448
    ds_read_b64_tr_b16 a[240:241], v27 offset:0
    ds_read_b64_tr_b16 a[242:243], v27 offset:256
    ds_read_b64_tr_b16 a[244:245], v27 offset:8192
    ds_read_b64_tr_b16 a[246:247], v27 offset:8448
    ds_read_b64_tr_b16 a[184:185], v26 offset:16384
    ds_read_b64_tr_b16 a[186:187], v26 offset:16640
    ds_read_b64_tr_b16 a[188:189], v26 offset:24576
    ds_read_b64_tr_b16 a[190:191], v26 offset:24832
    ds_read_b64_tr_b16 a[248:249], v27 offset:16384
    ds_read_b64_tr_b16 a[250:251], v27 offset:16640
    ds_read_b64_tr_b16 a[252:253], v27 offset:24576
    ds_read_b64_tr_b16 a[254:255], v27 offset:24832
    s_waitcnt lgkmcnt(0)
    s_waitcnt vmcnt(16)
    s_barrier
    s_add_u32 m0, s51, 65536
    s_add_u32 s48, s50, 0x200000
    buffer_load_dwordx4 v32, s[8:11], s48 offen lds
    s_add_u32 m0, s51, 66560
    s_add_u32 s48, s50, 0x208000
    buffer_load_dwordx4 v33, s[8:11], s48 offen lds
    s_add_u32 m0, s51, 67584
    s_add_u32 s48, s50, 0x210000
    buffer_load_dwordx4 v32, s[8:11], s48 offen lds
    s_add_u32 m0, s51, 68608
    s_add_u32 s48, s50, 0x218000
    buffer_load_dwordx4 v33, s[8:11], s48 offen lds
    s_add_u32 m0, s51, 69632
    s_add_u32 s48, s50, 0x220000
    buffer_load_dwordx4 v34, s[8:11], s48 offen lds
    s_add_u32 m0, s51, 70656
    s_add_u32 s48, s50, 0x228000
    buffer_load_dwordx4 v35, s[8:11], s48 offen lds
    s_add_u32 m0, s51, 71680
    s_add_u32 s48, s50, 0x230000
    buffer_load_dwordx4 v34, s[8:11], s48 offen lds
    s_add_u32 m0, s51, 72704
    s_add_u32 s48, s50, 0x238000
    buffer_load_dwordx4 v35, s[8:11], s48 offen lds
    v_add_u32 v26, 131072, v40
    v_add_u32 v27, 131072, v41
    ds_read_b64_tr_b16 a[160:161], v26 offset:0
    ds_read_b64_tr_b16 a[162:163], v26 offset:256
    ds_read_b64_tr_b16 a[164:165], v26 offset:8192
    ds_read_b64_tr_b16 a[166:167], v26 offset:8448
    ds_read_b64_tr_b16 a[224:225], v27 offset:0
    ds_read_b64_tr_b16 a[226:227], v27 offset:256
    ds_read_b64_tr_b16 a[228:229], v27 offset:8192
    ds_read_b64_tr_b16 a[230:231], v27 offset:8448
    ds_read_b64_tr_b16 a[168:169], v26 offset:16384
    ds_read_b64_tr_b16 a[170:171], v26 offset:16640
    ds_read_b64_tr_b16 a[172:173], v26 offset:24576
    ds_read_b64_tr_b16 a[174:175], v26 offset:24832
    ds_read_b64_tr_b16 a[232:233], v27 offset:16384
    ds_read_b64_tr_b16 a[234:235], v27 offset:16640
    ds_read_b64_tr_b16 a[236:237], v27 offset:24576
    ds_read_b64_tr_b16 a[238:239], v27 offset:24832
    s_waitcnt lgkmcnt(0)
    s_waitcnt vmcnt(16)
    s_barrier
    s_add_u32 m0, s51, 98304
    s_add_u32 s48, s50, 0x300000
    buffer_load_dwordx4 v32, s[8:11], s48 offen lds
    s_add_u32 m0, s51, 99328
    s_add_u32 s48, s50, 0x308000
    buffer_load_dwordx4 v33, s[8:11], s48 offen lds
    s_add_u32 m0, s51, 100352
    s_add_u32 s48, s50, 0x310000
    buffer_load_dwordx4 v32, s[8:11], s48 offen lds
    s_add_u32 m0, s51, 101376
    s_add_u32 s48, s50, 0x318000
    buffer_load_dwordx4 v33, s[8:11], s48 offen lds
    s_add_u32 m0, s51, 102400
    s_add_u32 s48, s50, 0x320000
    buffer_load_dwordx4 v34, s[8:11], s48 offen lds
    s_add_u32 m0, s51, 103424
    s_add_u32 s48, s50, 0x328000
    buffer_load_dwordx4 v35, s[8:11], s48 offen lds
    s_add_u32 m0, s51, 104448
    s_add_u32 s48, s50, 0x330000
    buffer_load_dwordx4 v34, s[8:11], s48 offen lds
    s_add_u32 m0, s51, 105472
    s_add_u32 s48, s50, 0x338000
    buffer_load_dwordx4 v35, s[8:11], s48 offen lds
    v_add_u32 v26, 32768, v40
    v_add_u32 v27, 32768, v41
    ds_read_b64_tr_b16 v[144:145], v26 offset:0
    ds_read_b64_tr_b16 v[146:147], v26 offset:256
    ds_read_b64_tr_b16 v[148:149], v26 offset:8192
    ds_read_b64_tr_b16 v[150:151], v26 offset:8448
    ds_read_b64_tr_b16 v[208:209], v27 offset:0
    ds_read_b64_tr_b16 v[210:211], v27 offset:256
    ds_read_b64_tr_b16 v[212:213], v27 offset:8192
    ds_read_b64_tr_b16 v[214:215], v27 offset:8448
    ds_read_b64_tr_b16 v[152:153], v26 offset:16384
    ds_read_b64_tr_b16 v[154:155], v26 offset:16640
    ds_read_b64_tr_b16 v[156:157], v26 offset:24576
    ds_read_b64_tr_b16 v[158:159], v26 offset:24832
    ds_read_b64_tr_b16 v[216:217], v27 offset:16384
    ds_read_b64_tr_b16 v[218:219], v27 offset:16640
    ds_read_b64_tr_b16 v[220:221], v27 offset:24576
    ds_read_b64_tr_b16 v[222:223], v27 offset:24832
    s_waitcnt lgkmcnt(0)
    s_waitcnt vmcnt(16)
    s_barrier
    s_mov_b32 s8, s42
    s_and_b32 s9, s43, 0xffff
    s_mov_b32 s10, 0x400000
    s_mov_b32 s11, 0x00020000
    s_add_u32 m0, s51, 0
    s_add_u32 s48, s53, 0x0
    buffer_load_dwordx4 v36, s[8:11], s48 offen lds
    s_add_u32 m0, s51, 1024
    s_add_u32 s48, s53, 0x1000
    buffer_load_dwordx4 v37, s[8:11], s48 offen lds
    s_add_u32 m0, s51, 2048
    s_add_u32 s48, s53, 0x2000
    buffer_load_dwordx4 v36, s[8:11], s48 offen lds
    s_add_u32 m0, s51, 3072
    s_add_u32 s48, s53, 0x3000
    buffer_load_dwordx4 v37, s[8:11], s48 offen lds
    s_add_u32 m0, s51, 4096
    s_add_u32 s48, s53, 0x4000
    buffer_load_dwordx4 v38, s[8:11], s48 offen lds
    s_add_u32 m0, s51, 5120
    s_add_u32 s48, s53, 0x5000
    buffer_load_dwordx4 v39, s[8:11], s48 offen lds
    s_add_u32 m0, s51, 6144
    s_add_u32 s48, s53, 0x6000
    buffer_load_dwordx4 v38, s[8:11], s48 offen lds
    s_add_u32 m0, s51, 7168
    s_add_u32 s48, s53, 0x7000
    buffer_load_dwordx4 v39, s[8:11], s48 offen lds
    v_add_u32 v26, 65536, v40
    v_add_u32 v27, 65536, v41
    ds_read_b64_tr_b16 v[128:129], v26 offset:0
    ds_read_b64_tr_b16 v[130:131], v26 offset:256
    ds_read_b64_tr_b16 v[132:133], v26 offset:8192
    ds_read_b64_tr_b16 v[134:135], v26 offset:8448
    ds_read_b64_tr_b16 v[192:193], v27 offset:0
    ds_read_b64_tr_b16 v[194:195], v27 offset:256
    ds_read_b64_tr_b16 v[196:197], v27 offset:8192
    ds_read_b64_tr_b16 v[198:199], v27 offset:8448
    ds_read_b64_tr_b16 v[136:137], v26 offset:16384
    ds_read_b64_tr_b16 v[138:139], v26 offset:16640
    ds_read_b64_tr_b16 v[140:141], v26 offset:24576
    ds_read_b64_tr_b16 v[142:143], v26 offset:24832
    ds_read_b64_tr_b16 v[200:201], v27 offset:16384
    ds_read_b64_tr_b16 v[202:203], v27 offset:16640
    ds_read_b64_tr_b16 v[204:205], v27 offset:24576
    ds_read_b64_tr_b16 v[206:207], v27 offset:24832
    s_waitcnt lgkmcnt(0)
    s_waitcnt vmcnt(16)
    s_barrier
    s_add_u32 m0, s51, 32768
    s_add_u32 s48, s53, 0x100
    buffer_load_dwordx4 v36, s[8:11], s48 offen lds
    s_add_u32 m0, s51, 33792
    s_add_u32 s48, s53, 0x1100
    buffer_load_dwordx4 v37, s[8:11], s48 offen lds
    s_add_u32 m0, s51, 34816
    s_add_u32 s48, s53, 0x2100
    buffer_load_dwordx4 v36, s[8:11], s48 offen lds
    s_add_u32 m0, s51, 35840
    s_add_u32 s48, s53, 0x3100
    buffer_load_dwordx4 v37, s[8:11], s48 offen lds
    s_add_u32 m0, s51, 36864
    s_add_u32 s48, s53, 0x4100
    buffer_load_dwordx4 v38, s[8:11], s48 offen lds
    s_add_u32 m0, s51, 37888
    s_add_u32 s48, s53, 0x5100
    buffer_load_dwordx4 v39, s[8:11], s48 offen lds
    s_add_u32 m0, s51, 38912
    s_add_u32 s48, s53, 0x6100
    buffer_load_dwordx4 v38, s[8:11], s48 offen lds
    s_add_u32 m0, s51, 39936
    s_add_u32 s48, s53, 0x7100
    buffer_load_dwordx4 v39, s[8:11], s48 offen lds
    v_add_u32 v26, 98304, v40
    v_add_u32 v27, 98304, v41
    ds_read_b64_tr_b16 v[176:177], v26 offset:0
    ds_read_b64_tr_b16 v[178:179], v26 offset:256
    ds_read_b64_tr_b16 v[180:181], v26 offset:8192
    ds_read_b64_tr_b16 v[182:183], v26 offset:8448
    ds_read_b64_tr_b16 v[240:241], v27 offset:0
    ds_read_b64_tr_b16 v[242:243], v27 offset:256
    ds_read_b64_tr_b16 v[244:245], v27 offset:8192
    ds_read_b64_tr_b16 v[246:247], v27 offset:8448
    ds_read_b64_tr_b16 v[184:185], v26 offset:16384
    ds_read_b64_tr_b16 v[186:187], v26 offset:16640
    ds_read_b64_tr_b16 v[188:189], v26 offset:24576
    ds_read_b64_tr_b16 v[190:191], v26 offset:24832
    ds_read_b64_tr_b16 v[248:249], v27 offset:16384
    ds_read_b64_tr_b16 v[250:251], v27 offset:16640
    ds_read_b64_tr_b16 v[252:253], v27 offset:24576
    ds_read_b64_tr_b16 v[254:255], v27 offset:24832
    s_waitcnt lgkmcnt(0)
    s_waitcnt vmcnt(16)
    s_barrier
    s_add_u32 m0, s51, 65536
    s_add_u32 s48, s53, 0x200
    buffer_load_dwordx4 v36, s[8:11], s48 offen lds
    s_add_u32 m0, s51, 66560
    s_add_u32 s48, s53, 0x1200
    buffer_load_dwordx4 v37, s[8:11], s48 offen lds
    s_add_u32 m0, s51, 67584
    s_add_u32 s48, s53, 0x2200
    buffer_load_dwordx4 v36, s[8:11], s48 offen lds
    s_add_u32 m0, s51, 68608
    s_add_u32 s48, s53, 0x3200
    buffer_load_dwordx4 v37, s[8:11], s48 offen lds
    s_add_u32 m0, s51, 69632
    s_add_u32 s48, s53, 0x4200
    buffer_load_dwordx4 v38, s[8:11], s48 offen lds
    s_add_u32 m0, s51, 70656
    s_add_u32 s48, s53, 0x5200
    buffer_load_dwordx4 v39, s[8:11], s48 offen lds
    s_add_u32 m0, s51, 71680
    s_add_u32 s48, s53, 0x6200
    buffer_load_dwordx4 v38, s[8:11], s48 offen lds
    s_add_u32 m0, s51, 72704
    s_add_u32 s48, s53, 0x7200
    buffer_load_dwordx4 v39, s[8:11], s48 offen lds
    v_lshrrev_b32 v122, 2, v2
    v_add_u32 v26, 131072, v40
    v_add_u32 v27, 131072, v41
    ds_read_b64_tr_b16 v[160:161], v26 offset:0
    ds_read_b64_tr_b16 v[162:163], v26 offset:256
    ds_read_b64_tr_b16 v[164:165], v26 offset:8192
    ds_read_b64_tr_b16 v[166:167], v26 offset:8448
    ds_read_b64_tr_b16 v[224:225], v27 offset:0
    ds_read_b64_tr_b16 v[226:227], v27 offset:256
    ds_read_b64_tr_b16 v[228:229], v27 offset:8192
    ds_read_b64_tr_b16 v[230:231], v27 offset:8448
    ds_read_b64_tr_b16 v[168:169], v26 offset:16384
    ds_read_b64_tr_b16 v[170:171], v26 offset:16640
    ds_read_b64_tr_b16 v[172:173], v26 offset:24576
    ds_read_b64_tr_b16 v[174:175], v26 offset:24832
    ds_read_b64_tr_b16 v[232:233], v27 offset:16384
    ds_read_b64_tr_b16 v[234:235], v27 offset:16640
    ds_read_b64_tr_b16 v[236:237], v27 offset:24576
    ds_read_b64_tr_b16 v[238:239], v27 offset:24832
    s_waitcnt lgkmcnt(0)
    s_barrier
    s_add_u32 m0, s51, 98304
    s_add_u32 s48, s53, 0x300
    buffer_load_dwordx4 v36, s[8:11], s48 offen lds
    s_add_u32 m0, s51, 99328
    s_add_u32 s48, s53, 0x1300
    buffer_load_dwordx4 v37, s[8:11], s48 offen lds
    s_add_u32 m0, s51, 100352
    s_add_u32 s48, s53, 0x2300
    buffer_load_dwordx4 v36, s[8:11], s48 offen lds
    s_add_u32 m0, s51, 101376
    s_add_u32 s48, s53, 0x3300
    buffer_load_dwordx4 v37, s[8:11], s48 offen lds
    s_add_u32 m0, s51, 102400
    s_add_u32 s48, s53, 0x4300
    buffer_load_dwordx4 v38, s[8:11], s48 offen lds
    s_add_u32 m0, s51, 103424
    s_add_u32 s48, s53, 0x5300
    buffer_load_dwordx4 v39, s[8:11], s48 offen lds
    s_add_u32 m0, s51, 104448
    s_add_u32 s48, s53, 0x6300
    buffer_load_dwordx4 v38, s[8:11], s48 offen lds
    s_add_u32 m0, s51, 105472
    s_add_u32 s48, s53, 0x7300
    buffer_load_dwordx4 v39, s[8:11], s48 offen lds
    s_branch R_wdone
R_wl2:
    s_cmp_lg_u32 s15, 2
    s_cbranch_scc1 R_wl3
    s_waitcnt vmcnt(24)
    s_barrier
    v_add_u32 v26, 32768, v40
    v_add_u32 v27, 32768, v41
    ds_read_b64_tr_b16 a[32:33], v26 offset:0
    ds_read_b64_tr_b16 a[34:35], v26 offset:256
    ds_read_b64_tr_b16 a[36:37], v26 offset:8192
    ds_read_b64_tr_b16 a[38:39], v26 offset:8448
    ds_read_b64_tr_b16 a[96:97], v27 offset:0
    ds_read_b64_tr_b16 a[98:99], v27 offset:256
    ds_read_b64_tr_b16 a[100:101], v27 offset:8192
    ds_read_b64_tr_b16 a[102:103], v27 offset:8448
    ds_read_b64_tr_b16 a[40:41], v26 offset:16384
    ds_read_b64_tr_b16 a[42:43], v26 offset:16640
    ds_read_b64_tr_b16 a[44:45], v26 offset:24576
    ds_read_b64_tr_b16 a[46:47], v26 offset:24832
    ds_read_b64_tr_b16 a[104:105], v27 offset:16384
    ds_read_b64_tr_b16 a[106:107], v27 offset:16640
    ds_read_b64_tr_b16 a[108:109], v27 offset:24576
    ds_read_b64_tr_b16 a[110:111], v27 offset:24832
    s_waitcnt lgkmcnt(0)
    s_waitcnt vmcnt(16)
    s_barrier
    s_mov_b32 s8, s38
    s_and_b32 s9, s39, 0xffff
    s_mov_b32 s10, 0x400000
    s_mov_b32 s11, 0x00020000
    s_add_u32 m0, s51, 0
    s_add_u32 s48, s50, 0x0
    buffer_load_dwordx4 v32, s[8:11], s48 offen lds
    s_add_u32 m0, s51, 1024
    s_add_u32 s48, s50, 0x8000
    buffer_load_dwordx4 v33, s[8:11], s48 offen lds
    s_add_u32 m0, s51, 2048
    s_add_u32 s48, s50, 0x10000
    buffer_load_dwordx4 v32, s[8:11], s48 offen lds
    s_add_u32 m0, s51, 3072
    s_add_u32 s48, s50, 0x18000
    buffer_load_dwordx4 v33, s[8:11], s48 offen lds
    s_add_u32 m0, s51, 4096
    s_add_u32 s48, s50, 0x20000
    buffer_load_dwordx4 v34, s[8:11], s48 offen lds
    s_add_u32 m0, s51, 5120
    s_add_u32 s48, s50, 0x28000
    buffer_load_dwordx4 v35, s[8:11], s48 offen lds
    s_add_u32 m0, s51, 6144
    s_add_u32 s48, s50, 0x30000
    buffer_load_dwordx4 v34, s[8:11], s48 offen lds
    s_add_u32 m0, s51, 7168
    s_add_u32 s48, s50, 0x38000
    buffer_load_dwordx4 v35, s[8:11], s48 offen lds
    v_add_u32 v26, 65536, v40
    v_add_u32 v27, 65536, v41
    ds_read_b64_tr_b16 a[48:49], v26 offset:0
    ds_read_b64_tr_b16 a[50:51], v26 offset:256
    ds_read_b64_tr_b16 a[52:53], v26 offset:8192
    ds_read_b64_tr_b16 a[54:55], v26 offset:8448
    ds_read_b64_tr_b16 a[112:113], v27 offset:0
    ds_read_b64_tr_b16 a[114:115], v27 offset:256
    ds_read_b64_tr_b16 a[116:117], v27 offset:8192
    ds_read_b64_tr_b16 a[118:119], v27 offset:8448
    ds_read_b64_tr_b16 a[56:57], v26 offset:16384
    ds_read_b64_tr_b16 a[58:59], v26 offset:16640
    ds_read_b64_tr_b16 a[60:61], v26 offset:24576
    ds_read_b64_tr_b16 a[62:63], v26 offset:24832
    ds_read_b64_tr_b16 a[120:121], v27 offset:16384
    ds_read_b64_tr_b16 a[122:123], v27 offset:16640
    ds_read_b64_tr_b16 a[124:125], v27 offset:24576
    ds_read_b64_tr_b16 a[126:127], v27 offset:24832
    s_waitcnt lgkmcnt(0)
    s_waitcnt vmcnt(16)
    s_barrier
    s_add_u32 m0, s51, 32768
    s_add_u32 s48, s50, 0x100000
    buffer_load_dwordx4 v32, s[8:11], s48 offen lds
    s_add_u32 m0, s51, 33792
    s_add_u32 s48, s50, 0x108000
    buffer_load_dwordx4 v33, s[8:11], s48 offen lds
    s_add_u32 m0, s51, 34816
    s_add_u32 s48, s50, 0x110000
    buffer_load_dwordx4 v32, s[8:11], s48 offen lds
    s_add_u32 m0, s51, 35840
    s_add_u32 s48, s50, 0x118000
    buffer_load_dwordx4 v33, s[8:11], s48 offen lds
    s_add_u32 m0, s51, 36864
    s_add_u32 s48, s50, 0x120000
    buffer_load_dwordx4 v34, s[8:11], s48 offen lds
    s_add_u32 m0, s51, 37888
    s_add_u32 s48, s50, 0x128000
    buffer_load_dwordx4 v35, s[8:11], s48 offen lds
    s_add_u32 m0, s51, 38912
    s_add_u32 s48, s50, 0x130000
    buffer_load_dwordx4 v34, s[8:11], s48 offen lds
    s_add_u32 m0, s51, 39936
    s_add_u32 s48, s50, 0x138000
    buffer_load_dwordx4 v35, s[8:11], s48 offen lds
    v_add_u32 v26, 98304, v40
    v_add_u32 v27, 98304, v41
    ds_read_b64_tr_b16 a[0:1], v26 offset:0
    ds_read_b64_tr_b16 a[2:3], v26 offset:256
    ds_read_b64_tr_b16 a[4:5], v26 offset:8192
    ds_read_b64_tr_b16 a[6:7], v26 offset:8448
    ds_read_b64_tr_b16 a[64:65], v27 offset:0
    ds_read_b64_tr_b16 a[66:67], v27 offset:256
    ds_read_b64_tr_b16 a[68:69], v27 offset:8192
    ds_read_b64_tr_b16 a[70:71], v27 offset:8448
    ds_read_b64_tr_b16 a[8:9], v26 offset:16384
    ds_read_b64_tr_b16 a[10:11], v26 offset:16640
    ds_read_b64_tr_b16 a[12:13], v26 offset:24576
    ds_read_b64_tr_b16 a[14:15], v26 offset:24832
    ds_read_b64_tr_b16 a[72:73], v27 offset:16384
    ds_read_b64_tr_b16 a[74:75], v27 offset:16640
    ds_read_b64_tr_b16 a[76:77], v27 offset:24576
    ds_read_b64_tr_b16 a[78:79], v27 offset:24832
    s_waitcnt lgkmcnt(0)
    s_waitcnt vmcnt(16)
    s_barrier
    s_add_u32 m0, s51, 65536
    s_add_u32 s48, s50, 0x200000
    buffer_load_dwordx4 v32, s[8:11], s48 offen lds
    s_add_u32 m0, s51, 66560
    s_add_u32 s48, s50, 0x208000
    buffer_load_dwordx4 v33, s[8:11], s48 offen lds
    s_add_u32 m0, s51, 67584
    s_add_u32 s48, s50, 0x210000
    buffer_load_dwordx4 v32, s[8:11], s48 offen lds
    s_add_u32 m0, s51, 68608
    s_add_u32 s48, s50, 0x218000
    buffer_load_dwordx4 v33, s[8:11], s48 offen lds
    s_add_u32 m0, s51, 69632
    s_add_u32 s48, s50, 0x220000
    buffer_load_dwordx4 v34, s[8:11], s48 offen lds
    s_add_u32 m0, s51, 70656
    s_add_u32 s48, s50, 0x228000
    buffer_load_dwordx4 v35, s[8:11], s48 offen lds
    s_add_u32 m0, s51, 71680
    s_add_u32 s48, s50, 0x230000
    buffer_load_dwordx4 v34, s[8:11], s48 offen lds
    s_add_u32 m0, s51, 72704
    s_add_u32 s48, s50, 0x238000
    buffer_load_dwordx4 v35, s[8:11], s48 offen lds
    v_add_u32 v26, 131072, v40
    v_add_u32 v27, 131072, v41
    ds_read_b64_tr_b16 a[16:17], v26 offset:0
    ds_read_b64_tr_b16 a[18:19], v26 offset:256
    ds_read_b64_tr_b16 a[20:21], v26 offset:8192
    ds_read_b64_tr_b16 a[22:23], v26 offset:8448
    ds_read_b64_tr_b16 a[80:81], v27 offset:0
    ds_read_b64_tr_b16 a[82:83], v27 offset:256
    ds_read_b64_tr_b16 a[84:85], v27 offset:8192
    ds_read_b64_tr_b16 a[86:87], v27 offset:8448
    ds_read_b64_tr_b16 a[24:25], v26 offset:16384
    ds_read_b64_tr_b16 a[26:27], v26 offset:16640
    ds_read_b64_tr_b16 a[28:29], v26 offset:24576
    ds_read_b64_tr_b16 a[30:31], v26 offset:24832
    ds_read_b64_tr_b16 a[88:89], v27 offset:16384
    ds_read_b64_tr_b16 a[90:91], v27 offset:16640
    ds_read_b64_tr_b16 a[92:93], v27 offset:24576
    ds_read_b64_tr_b16 a[94:95], v27 offset:24832
    s_waitcnt lgkmcnt(0)
    s_waitcnt vmcnt(16)
    s_barrier
    s_add_u32 m0, s51, 98304
    s_add_u32 s48, s50, 0x300000
    buffer_load_dwordx4 v32, s[8:11], s48 offen lds
    s_add_u32 m0, s51, 99328
    s_add_u32 s48, s50, 0x308000
    buffer_load_dwordx4 v33, s[8:11], s48 offen lds
    s_add_u32 m0, s51, 100352
    s_add_u32 s48, s50, 0x310000
    buffer_load_dwordx4 v32, s[8:11], s48 offen lds
    s_add_u32 m0, s51, 101376
    s_add_u32 s48, s50, 0x318000
    buffer_load_dwordx4 v33, s[8:11], s48 offen lds
    s_add_u32 m0, s51, 102400
    s_add_u32 s48, s50, 0x320000
    buffer_load_dwordx4 v34, s[8:11], s48 offen lds
    s_add_u32 m0, s51, 103424
    s_add_u32 s48, s50, 0x328000
    buffer_load_dwordx4 v35, s[8:11], s48 offen lds
    s_add_u32 m0, s51, 104448
    s_add_u32 s48, s50, 0x330000
    buffer_load_dwordx4 v34, s[8:11], s48 offen lds
    s_add_u32 m0, s51, 105472
    s_add_u32 s48, s50, 0x338000
    buffer_load_dwordx4 v35, s[8:11], s48 offen lds
    v_add_u32 v26, 32768, v40
    v_add_u32 v27, 32768, v41
    ds_read_b64_tr_b16 a[160:161], v26 offset:0
    ds_read_b64_tr_b16 a[162:163], v26 offset:256
    ds_read_b64_tr_b16 a[164:165], v26 offset:8192
    ds_read_b64_tr_b16 a[166:167], v26 offset:8448
    ds_read_b64_tr_b16 a[224:225], v27 offset:0
    ds_read_b64_tr_b16 a[226:227], v27 offset:256
    ds_read_b64_tr_b16 a[228:229], v27 offset:8192
    ds_read_b64_tr_b16 a[230:231], v27 offset:8448
    ds_read_b64_tr_b16 a[168:169], v26 offset:16384
    ds_read_b64_tr_b16 a[170:171], v26 offset:16640
    ds_read_b64_tr_b16 a[172:173], v26 offset:24576
    ds_read_b64_tr_b16 a[174:175], v26 offset:24832
    ds_read_b64_tr_b16 a[232:233], v27 offset:16384
    ds_read_b64_tr_b16 a[234:235], v27 offset:16640
    ds_read_b64_tr_b16 a[236:237], v27 offset:24576
    ds_read_b64_tr_b16 a[238:239], v27 offset:24832
    s_waitcnt lgkmcnt(0)
    s_waitcnt vmcnt(16)
    s_barrier
    s_mov_b32 s8, s40
    s_and_b32 s9, s41, 0xffff
    s_mov_b32 s10, 0x400000
    s_mov_b32 s11, 0x00020000
    s_add_u32 m0, s51, 0
    s_add_u32 s48, s50, 0x0
    buffer_load_dwordx4 v32, s[8:11], s48 offen lds
    s_add_u32 m0, s51, 1024
    s_add_u32 s48, s50, 0x8000
    buffer_load_dwordx4 v33, s[8:11], s48 offen lds
    s_add_u32 m0, s51, 2048
    s_add_u32 s48, s50, 0x10000
    buffer_load_dwordx4 v32, s[8:11], s48 offen lds
    s_add_u32 m0, s51, 3072
    s_add_u32 s48, s50, 0x18000
    buffer_load_dwordx4 v33, s[8:11], s48 offen lds
    s_add_u32 m0, s51, 4096
    s_add_u32 s48, s50, 0x20000
    buffer_load_dwordx4 v34, s[8:11], s48 offen lds
    s_add_u32 m0, s51, 5120
    s_add_u32 s48, s50, 0x28000
    buffer_load_dwordx4 v35, s[8:11], s48 offen lds
    s_add_u32 m0, s51, 6144
    s_add_u32 s48, s50, 0x30000
    buffer_load_dwordx4 v34, s[8:11], s48 offen lds
    s_add_u32 m0, s51, 7168
    s_add_u32 s48, s50, 0x38000
    buffer_load_dwordx4 v35, s[8:11], s48 offen lds
    v_add_u32 v26, 65536, v40
    v_add_u32 v27, 65536, v41
    ds_read_b64_tr_b16 a[176:177], v26 offset:0
    ds_read_b64_tr_b16 a[178:179], v26 offset:256
    ds_read_b64_tr_b16 a[180:181], v26 offset:8192
    ds_read_b64_tr_b16 a[182:183], v26 offset:8448
    ds_read_b64_tr_b16 a[240:241], v27 offset:0
    ds_read_b64_tr_b16 a[242:243], v27 offset:256
    ds_read_b64_tr_b16 a[244:245], v27 offset:8192
    ds_read_b64_tr_b16 a[246:247], v27 offset:8448
    ds_read_b64_tr_b16 a[184:185], v26 offset:16384
    ds_read_b64_tr_b16 a[186:187], v26 offset:16640
    ds_read_b64_tr_b16 a[188:189], v26 offset:24576
    ds_read_b64_tr_b16 a[190:191], v26 offset:24832
    ds_read_b64_tr_b16 a[248:249], v27 offset:16384
    ds_read_b64_tr_b16 a[250:251], v27 offset:16640
    ds_read_b64_tr_b16 a[252:253], v27 offset:24576
    ds_read_b64_tr_b16 a[254:255], v27 offset:24832
    s_waitcnt lgkmcnt(0)
    s_waitcnt vmcnt(16)
    s_barrier
    s_add_u32 m0, s51, 32768
    s_add_u32 s48, s50, 0x100000
    buffer_load_dwordx4 v32, s[8:11], s48 offen lds
    s_add_u32 m0, s51, 33792
    s_add_u32 s48, s50, 0x108000
    buffer_load_dwordx4 v33, s[8:11], s48 offen lds
    s_add_u32 m0, s51, 34816
    s_add_u32 s48, s50, 0x110000
    buffer_load_dwordx4 v32, s[8:11], s48 offen lds
    s_add_u32 m0, s51, 35840
    s_add_u32 s48, s50, 0x118000
    buffer_load_dwordx4 v33, s[8:11], s48 offen lds
    s_add_u32 m0, s51, 36864
    s_add_u32 s48, s50, 0x120000
    buffer_load_dwordx4 v34, s[8:11], s48 offen lds
    s_add_u32 m0, s51, 37888
    s_add_u32 s48, s50, 0x128000
    buffer_load_dwordx4 v35, s[8:11], s48 offen lds
    s_add_u32 m0, s51, 38912
    s_add_u32 s48, s50, 0x130000
    buffer_load_dwordx4 v34, s[8:11], s48 offen lds
    s_add_u32 m0, s51, 39936
    s_add_u32 s48, s50, 0x138000
    buffer_load_dwordx4 v35, s[8:11], s48 offen lds
    v_add_u32 v26, 98304, v40
    v_add_u32 v27, 98304, v41
    ds_read_b64_tr_b16 a[128:129], v26 offset:0
    ds_read_b64_tr_b16 a[130:131], v26 offset:256
    ds_read_b64_tr_b16 a[132:133], v26 offset:8192
    ds_read_b64_tr_b16 a[134:135], v26 offset:8448
    ds_read_b64_tr_b16 a[192:193], v27 offset:0
    ds_read_b64_tr_b16 a[194:195], v27 offset:256
    ds_read_b64_tr_b16 a[196:197], v27 offset:8192
    ds_read_b64_tr_b16 a[198:199], v27 offset:8448
    ds_read_b64_tr_b16 a[136:137], v26 offset:16384
    ds_read_b64_tr_b16 a[138:139], v26 offset:16640
    ds_read_b64_tr_b16 a[140:141], v26 offset:24576
    ds_read_b64_tr_b16 a[142:143], v26 offset:24832
    ds_read_b64_tr_b16 a[200:201], v27 offset:16384
    ds_read_b64_tr_b16 a[202:203], v27 offset:16640
    ds_read_b64_tr_b16 a[204:205], v27 offset:24576
    ds_read_b64_tr_b16 a[206:207], v27 offset:24832
    s_waitcnt lgkmcnt(0)
    s_waitcnt vmcnt(16)
    s_barrier
    s_add_u32 m0, s51, 65536
    s_add_u32 s48, s50, 0x200000
    buffer_load_dwordx4 v32, s[8:11], s48 offen lds
    s_add_u32 m0, s51, 66560
    s_add_u32 s48, s50, 0x208000
    buffer_load_dwordx4 v33, s[8:11], s48 offen lds
    s_add_u32 m0, s51, 67584
    s_add_u32 s48, s50, 0x210000
    buffer_load_dwordx4 v32, s[8:11], s48 offen lds
    s_add_u32 m0, s51, 68608
    s_add_u32 s48, s50, 0x218000
    buffer_load_dwordx4 v33, s[8:11], s48 offen lds
    s_add_u32 m0, s51, 69632
    s_add_u32 s48, s50, 0x220000
    buffer_load_dwordx4 v34, s[8:11], s48 offen lds
    s_add_u32 m0, s51, 70656
    s_add_u32 s48, s50, 0x228000
    buffer_load_dwordx4 v35, s[8:11], s48 offen lds
    s_add_u32 m0, s51, 71680
    s_add_u32 s48, s50, 0x230000
    buffer_load_dwordx4 v34, s[8:11], s48 offen lds
    s_add_u32 m0, s51, 72704
    s_add_u32 s48, s50, 0x238000
    buffer_load_dwordx4 v35, s[8:11], s48 offen lds
    v_add_u32 v26, 131072, v40
    v_add_u32 v27, 131072, v41
    ds_read_b64_tr_b16 a[144:145], v26 offset:0
    ds_read_b64_tr_b16 a[146:147], v26 offset:256
    ds_read_b64_tr_b16 a[148:149], v26 offset:8192
    ds_read_b64_tr_b16 a[150:151], v26 offset:8448
    ds_read_b64_tr_b16 a[208:209], v27 offset:0
    ds_read_b64_tr_b16 a[210:211], v27 offset:256
    ds_read_b64_tr_b16 a[212:213], v27 offset:8192
    ds_read_b64_tr_b16 a[214:215], v27 offset:8448
    ds_read_b64_tr_b16 a[152:153], v26 offset:16384
    ds_read_b64_tr_b16 a[154:155], v26 offset:16640
    ds_read_b64_tr_b16 a[156:157], v26 offset:24576
    ds_read_b64_tr_b16 a[158:159], v26 offset:24832
    ds_read_b64_tr_b16 a[216:217], v27 offset:16384
    ds_read_b64_tr_b16 a[218:219], v27 offset:16640
    ds_read_b64_tr_b16 a[220:221], v27 offset:24576
    ds_read_b64_tr_b16 a[222:223], v27 offset:24832
    s_waitcnt lgkmcnt(0)
    s_waitcnt vmcnt(16)
    s_barrier
    s_add_u32 m0, s51, 98304
    s_add_u32 s48, s50, 0x300000
    buffer_load_dwordx4 v32, s[8:11], s48 offen lds
    s_add_u32 m0, s51, 99328
    s_add_u32 s48, s50, 0x308000
    buffer_load_dwordx4 v33, s[8:11], s48 offen lds
    s_add_u32 m0, s51, 100352
    s_add_u32 s48, s50, 0x310000
    buffer_load_dwordx4 v32, s[8:11], s48 offen lds
    s_add_u32 m0, s51, 101376
    s_add_u32 s48, s50, 0x318000
    buffer_load_dwordx4 v33, s[8:11], s48 offen lds
    s_add_u32 m0, s51, 102400
    s_add_u32 s48, s50, 0x320000
    buffer_load_dwordx4 v34, s[8:11], s48 offen lds
    s_add_u32 m0, s51, 103424
    s_add_u32 s48, s50, 0x328000
    buffer_load_dwordx4 v35, s[8:11], s48 offen lds
    s_add_u32 m0, s51, 104448
    s_add_u32 s48, s50, 0x330000
    buffer_load_dwordx4 v34, s[8:11], s48 offen lds
    s_add_u32 m0, s51, 105472
    s_add_u32 s48, s50, 0x338000
    buffer_load_dwordx4 v35, s[8:11], s48 offen lds
    v_add_u32 v26, 32768, v40
    v_add_u32 v27, 32768, v41
    ds_read_b64_tr_b16 v[160:161], v26 offset:0
    ds_read_b64_tr_b16 v[162:163], v26 offset:256
    ds_read_b64_tr_b16 v[164:165], v26 offset:8192
    ds_read_b64_tr_b16 v[166:167], v26 offset:8448
    ds_read_b64_tr_b16 v[224:225], v27 offset:0
    ds_read_b64_tr_b16 v[226:227], v27 offset:256
    ds_read_b64_tr_b16 v[228:229], v27 offset:8192
    ds_read_b64_tr_b16 v[230:231], v27 offset:8448
    ds_read_b64_tr_b16 v[168:169], v26 offset:16384
    ds_read_b64_tr_b16 v[170:171], v26 offset:16640
    ds_read_b64_tr_b16 v[172:173], v26 offset:24576
    ds_read_b64_tr_b16 v[174:175], v26 offset:24832
    ds_read_b64_tr_b16 v[232:233], v27 offset:16384
    ds_read_b64_tr_b16 v[234:235], v27 offset:16640
    ds_read_b64_tr_b16 v[236:237], v27 offset:24576
    ds_read_b64_tr_b16 v[238:239], v27 offset:24832
    s_waitcnt lgkmcnt(0)
    s_waitcnt vmcnt(16)
    s_barrier
    s_mov_b32 s8, s42
    s_and_b32 s9, s43, 0xffff
    s_mov_b32 s10, 0x400000
    s_mov_b32 s11, 0x00020000
    s_add_u32 m0, s51, 0
    s_add_u32 s48, s53, 0x0
    buffer_load_dwordx4 v36, s[8:11], s48 offen lds
    s_add_u32 m0, s51, 1024
    s_add_u32 s48, s53, 0x1000
    buffer_load_dwordx4 v37, s[8:11], s48 offen lds
    s_add_u32 m0, s51, 2048
    s_add_u32 s48, s53, 0x2000
    buffer_load_dwordx4 v36, s[8:11], s48 offen lds
    s_add_u32 m0, s51, 3072
    s_add_u32 s48, s53, 0x3000
    buffer_load_dwordx4 v37, s[8:11], s48 offen lds
    s_add_u32 m0, s51, 4096
    s_add_u32 s48, s53, 0x4000
    buffer_load_dwordx4 v38, s[8:11], s48 offen lds
    s_add_u32 m0, s51, 5120
    s_add_u32 s48, s53, 0x5000
    buffer_load_dwordx4 v39, s[8:11], s48 offen lds
    s_add_u32 m0, s51, 6144
    s_add_u32 s48, s53, 0x6000
    buffer_load_dwordx4 v38, s[8:11], s48 offen lds
    s_add_u32 m0, s51, 7168
    s_add_u32 s48, s53, 0x7000
    buffer_load_dwordx4 v39, s[8:11], s48 offen lds
    v_add_u32 v26, 65536, v40
    v_add_u32 v27, 65536, v41
    ds_read_b64_tr_b16 v[176:177], v26 offset:0
    ds_read_b64_tr_b16 v[178:179], v26 offset:256
    ds_read_b64_tr_b16 v[180:181], v26 offset:8192
    ds_read_b64_tr_b16 v[182:183], v26 offset:8448
    ds_read_b64_tr_b16 v[240:241], v27 offset:0
    ds_read_b64_tr_b16 v[242:243], v27 offset:256
    ds_read_b64_tr_b16 v[244:245], v27 offset:8192
    ds_read_b64_tr_b16 v[246:247], v27 offset:8448
    ds_read_b64_tr_b16 v[184:185], v26 offset:16384
    ds_read_b64_tr_b16 v[186:187], v26 offset:16640
    ds_read_b64_tr_b16 v[188:189], v26 offset:24576
    ds_read_b64_tr_b16 v[190:191], v26 offset:24832
    ds_read_b64_tr_b16 v[248:249], v27 offset:16384
    ds_read_b64_tr_b16 v[250:251], v27 offset:16640
    ds_read_b64_tr_b16 v[252:253], v27 offset:24576
    ds_read_b64_tr_b16 v[254:255], v27 offset:24832
    s_waitcnt lgkmcnt(0)
    s_waitcnt vmcnt(16)
    s_barrier
    s_add_u32 m0, s51, 32768
    s_add_u32 s48, s53, 0x100
    buffer_load_dwordx4 v36, s[8:11], s48 offen lds
    s_add_u32 m0, s51, 33792
    s_add_u32 s48, s53, 0x1100
    buffer_load_dwordx4 v37, s[8:11], s48 offen lds
    s_add_u32 m0, s51, 34816
    s_add_u32 s48, s53, 0x2100
    buffer_load_dwordx4 v36, s[8:11], s48 offen lds
    s_add_u32 m0, s51, 35840
    s_add_u32 s48, s53, 0x3100
    buffer_load_dwordx4 v37, s[8:11], s48 offen lds
    s_add_u32 m0, s51, 36864
    s_add_u32 s48, s53, 0x4100
    buffer_load_dwordx4 v38, s[8:11], s48 offen lds
    s_add_u32 m0, s51, 37888
    s_add_u32 s48, s53, 0x5100
    buffer_load_dwordx4 v39, s[8:11], s48 offen lds
    s_add_u32 m0, s51, 38912
    s_add_u32 s48, s53, 0x6100
    buffer_load_dwordx4 v38, s[8:11], s48 offen lds
    s_add_u32 m0, s51, 39936
    s_add_u32 s48, s53, 0x7100
    buffer_load_dwordx4 v39, s[8:11], s48 offen lds
    v_add_u32 v26, 98304, v40
    v_add_u32 v27, 98304, v41
    ds_read_b64_tr_b16 v[128:129], v26 offset:0
    ds_read_b64_tr_b16 v[130:131], v26 offset:256
    ds_read_b64_tr_b16 v[132:133], v26 offset:8192
    ds_read_b64_tr_b16 v[134:135], v26 offset:8448
    ds_read_b64_tr_b16 v[192:193], v27 offset:0
    ds_read_b64_tr_b16 v[194:195], v27 offset:256
    ds_read_b64_tr_b16 v[196:197], v27 offset:8192
    ds_read_b64_tr_b16 v[198:199], v27 offset:8448
    ds_read_b64_tr_b16 v[136:137], v26 offset:16384
    ds_read_b64_tr_b16 v[138:139], v26 offset:16640
    ds_read_b64_tr_b16 v[140:141], v26 offset:24576
    ds_read_b64_tr_b16 v[142:143], v26 offset:24832
    ds_read_b64_tr_b16 v[200:201], v27 offset:16384
    ds_read_b64_tr_b16 v[202:203], v27 offset:16640
    ds_read_b64_tr_b16 v[204:205], v27 offset:24576
    ds_read_b64_tr_b16 v[206:207], v27 offset:24832
    s_waitcnt lgkmcnt(0)
    s_waitcnt vmcnt(16)
    s_barrier
    s_add_u32 m0, s51, 65536
    s_add_u32 s48, s53, 0x200
    buffer_load_dwordx4 v36, s[8:11], s48 offen lds
    s_add_u32 m0, s51, 66560
    s_add_u32 s48, s53, 0x1200
    buffer_load_dwordx4 v37, s[8:11], s48 offen lds
    s_add_u32 m0, s51, 67584
    s_add_u32 s48, s53, 0x2200
    buffer_load_dwordx4 v36, s[8:11], s48 offen lds
    s_add_u32 m0, s51, 68608
    s_add_u32 s48, s53, 0x3200
    buffer_load_dwordx4 v37, s[8:11], s48 offen lds
    s_add_u32 m0, s51, 69632
    s_add_u32 s48, s53, 0x4200
    buffer_load_dwordx4 v38, s[8:11], s48 offen lds
    s_add_u32 m0, s51, 70656
    s_add_u32 s48, s53, 0x5200
    buffer_load_dwordx4 v39, s[8:11], s48 offen lds
    s_add_u32 m0, s51, 71680
    s_add_u32 s48, s53, 0x6200
    buffer_load_dwordx4 v38, s[8:11], s48 offen lds
    s_add_u32 m0, s51, 72704
    s_add_u32 s48, s53, 0x7200
    buffer_load_dwordx4 v39, s[8:11], s48 offen lds
    v_lshrrev_b32 v122, 2, v2
    v_add_u32 v26, 131072, v40
    v_add_u32 v27, 131072, v41
    ds_read_b64_tr_b16 v[144:145], v26 offset:0
    ds_read_b64_tr_b16 v[146:147], v26 offset:256
    ds_read_b64_tr_b16 v[148:149], v26 offset:8192
    ds_read_b64_tr_b16 v[150:151], v26 offset:8448
    ds_read_b64_tr_b16 v[208:209], v27 offset:0
    ds_read_b64_tr_b16 v[210:211], v27 offset:256
    ds_read_b64_tr_b16 v[212:213], v27 offset:8192
    ds_read_b64_tr_b16 v[214:215], v27 offset:8448
    ds_read_b64_tr_b16 v[152:153], v26 offset:16384
    ds_read_b64_tr_b16 v[154:155], v26 offset:16640
    ds_read_b64_tr_b16 v[156:157], v26 offset:24576
    ds_read_b64_tr_b16 v[158:159], v26 offset:24832
    ds_read_b64_tr_b16 v[216:217], v27 offset:16384
    ds_read_b64_tr_b16 v[218:219], v27 offset:16640
    ds_read_b64_tr_b16 v[220:221], v27 offset:24576
    ds_read_b64_tr_b16 v[222:223], v27 offset:24832
    s_waitcnt lgkmcnt(0)
    s_barrier
    s_add_u32 m0, s51, 98304
    s_add_u32 s48, s53, 0x300
    buffer_load_dwordx4 v36, s[8:11], s48 offen lds
    s_add_u32 m0, s51, 99328
    s_add_u32 s48, s53, 0x1300
    buffer_load_dwordx4 v37, s[8:11], s48 offen lds
    s_add_u32 m0, s51, 100352
    s_add_u32 s48, s53, 0x2300
    buffer_load_dwordx4 v36, s[8:11], s48 offen lds
    s_add_u32 m0, s51, 101376
    s_add_u32 s48, s53, 0x3300
    buffer_load_dwordx4 v37, s[8:11], s48 offen lds
    s_add_u32 m0, s51, 102400
    s_add_u32 s48, s53, 0x4300
    buffer_load_dwordx4 v38, s[8:11], s48 offen lds
    s_add_u32 m0, s51, 103424
    s_add_u32 s48, s53, 0x5300
    buffer_load_dwordx4 v39, s[8:11], s48 offen lds
    s_add_u32 m0, s51, 104448
    s_add_u32 s48, s53, 0x6300
    buffer_load_dwordx4 v38, s[8:11], s48 offen lds
    s_add_u32 m0, s51, 105472
    s_add_u32 s48, s53, 0x7300
    buffer_load_dwordx4 v39, s[8:11], s48 offen lds
    s_branch R_wdone
R_wl3:
    s_waitcnt vmcnt(24)
    s_barrier
    v_add_u32 v26, 32768, v40
    v_add_u32 v27, 32768, v41
    ds_read_b64_tr_b16 a[48:49], v26 offset:0
    ds_read_b64_tr_b16 a[50:51], v26 offset:256
    ds_read_b64_tr_b16 a[52:53], v26 offset:8192
    ds_read_b64_tr_b16 a[54:55], v26 offset:8448
    ds_read_b64_tr_b16 a[112:113], v27 offset:0
    ds_read_b64_tr_b16 a[114:115], v27 offset:256
    ds_read_b64_tr_b16 a[116:117], v27 offset:8192
    ds_read_b64_tr_b16 a[118:119], v27 offset:8448
    ds_read_b64_tr_b16 a[56:57], v26 offset:16384
    ds_read_b64_tr_b16 a[58:59], v26 offset:16640
    ds_read_b64_tr_b16 a[60:61], v26 offset:24576
    ds_read_b64_tr_b16 a[62:63], v26 offset:24832
    ds_read_b64_tr_b16 a[120:121], v27 offset:16384
    ds_read_b64_tr_b16 a[122:123], v27 offset:16640
    ds_read_b64_tr_b16 a[124:125], v27 offset:24576
    ds_read_b64_tr_b16 a[126:127], v27 offset:24832
    s_waitcnt lgkmcnt(0)
    s_waitcnt vmcnt(16)
    s_barrier
    s_mov_b32 s8, s38
    s_and_b32 s9, s39, 0xffff
    s_mov_b32 s10, 0x400000
    s_mov_b32 s11, 0x00020000
    s_add_u32 m0, s51, 0
    s_add_u32 s48, s50, 0x0
    buffer_load_dwordx4 v32, s[8:11], s48 offen lds
    s_add_u32 m0, s51, 1024
    s_add_u32 s48, s50, 0x8000
    buffer_load_dwordx4 v33, s[8:11], s48 offen lds
    s_add_u32 m0, s51, 2048
    s_add_u32 s48, s50, 0x10000
    buffer_load_dwordx4 v32, s[8:11], s48 offen lds
    s_add_u32 m0, s51, 3072
    s_add_u32 s48, s50, 0x18000
    buffer_load_dwordx4 v33, s[8:11], s48 offen lds
    s_add_u32 m0, s51, 4096
    s_add_u32 s48, s50, 0x20000
    buffer_load_dwordx4 v34, s[8:11], s48 offen lds
    s_add_u32 m0, s51, 5120
    s_add_u32 s48, s50, 0x28000
    buffer_load_dwordx4 v35, s[8:11], s48 offen lds
    s_add_u32 m0, s51, 6144
    s_add_u32 s48, s50, 0x30000
    buffer_load_dwordx4 v34, s[8:11], s48 offen lds
    s_add_u32 m0, s51, 7168
    s_add_u32 s48, s50, 0x38000
    buffer_load_dwordx4 v35, s[8:11], s48 offen lds
    v_add_u32 v26, 65536, v40
    v_add_u32 v27, 65536, v41
    ds_read_b64_tr_b16 a[32:33], v26 offset:0
    ds_read_b64_tr_b16 a[34:35], v26 offset:256
    ds_read_b64_tr_b16 a[36:37], v26 offset:8192
    ds_read_b64_tr_b16 a[38:39], v26 offset:8448
    ds_read_b64_tr_b16 a[96:97], v27 offset:0
    ds_read_b64_tr_b16 a[98:99], v27 offset:256
    ds_read_b64_tr_b16 a[100:101], v27 offset:8192
    ds_read_b64_tr_b16 a[102:103], v27 offset:8448
    ds_read_b64_tr_b16 a[40:41], v26 offset:16384
    ds_read_b64_tr_b16 a[42:43], v26 offset:16640
    ds_read_b64_tr_b16 a[44:45], v26 offset:24576
    ds_read_b64_tr_b16 a[46:47], v26 offset:24832
    ds_read_b64_tr_b16 a[104:105], v27 offset:16384
    ds_read_b64_tr_b16 a[106:107], v27 offset:16640
    ds_read_b64_tr_b16 a[108:109], v27 offset:24576
    ds_read_b64_tr_b16 a[110:111], v27 offset:24832
    s_waitcnt lgkmcnt(0)
    s_waitcnt vmcnt(16)
    s_barrier
    s_add_u32 m0, s51, 32768
    s_add_u32 s48, s50, 0x100000
    buffer_load_dwordx4 v32, s[8:11], s48 offen lds
    s_add_u32 m0, s51, 33792
    s_add_u32 s48, s50, 0x108000
    buffer_load_dwordx4 v33, s[8:11], s48 offen lds
    s_add_u32 m0, s51, 34816
    s_add_u32 s48, s50, 0x110000
    buffer_load_dwordx4 v32, s[8:11], s48 offen lds
    s_add_u32 m0, s51, 35840
    s_add_u32 s48, s50, 0x118000
    buffer_load_dwordx4 v33, s[8:11], s48 offen lds
    s_add_u32 m0, s51, 36864
    s_add_u32 s48, s50, 0x120000
    buffer_load_dwordx4 v34, s[8:11], s48 offen lds
    s_add_u32 m0, s51, 37888
    s_add_u32 s48, s50, 0x128000
    buffer_load_dwordx4 v35, s[8:11], s48 offen lds
    s_add_u32 m0, s51, 38912
    s_add_u32 s48, s50, 0x130000
    buffer_load_dwordx4 v34, s[8:11], s48 offen lds
    s_add_u32 m0, s51, 39936
    s_add_u32 s48, s50, 0x138000
    buffer_load_dwordx4 v35, s[8:11], s48 offen lds
    v_add_u32 v26, 98304, v40
    v_add_u32 v27, 98304, v41
    ds_read_b64_tr_b16 a[16:17], v26 offset:0
    ds_read_b64_tr_b16 a[18:19], v26 offset:256
    ds_read_b64_tr_b16 a[20:21], v26 offset:8192
    ds_read_b64_tr_b16 a[22:23], v26 offset:8448
    ds_read_b64_tr_b16 a[80:81], v27 offset:0
    ds_read_b64_tr_b16 a[82:83], v27 offset:256
    ds_read_b64_tr_b16 a[84:85], v27 offset:8192
    ds_read_b64_tr_b16 a[86:87], v27 offset:8448
    ds_read_b64_tr_b16 a[24:25], v26 offset:16384
    ds_read_b64_tr_b16 a[26:27], v26 offset:16640
    ds_read_b64_tr_b16 a[28:29], v26 offset:24576
    ds_read_b64_tr_b16 a[30:31], v26 offset:24832
    ds_read_b64_tr_b16 a[88:89], v27 offset:16384
    ds_read_b64_tr_b16 a[90:91], v27 offset:16640
    ds_read_b64_tr_b16 a[92:93], v27 offset:24576
    ds_read_b64_tr_b16 a[94:95], v27 offset:24832
    s_waitcnt lgkmcnt(0)
    s_waitcnt vmcnt(16)
    s_barrier
    s_add_u32 m0, s51, 65536
    s_add_u32 s48, s50, 0x200000
    buffer_load_dwordx4 v32, s[8:11], s48 offen lds
    s_add_u32 m0, s51, 66560
    s_add_u32 s48, s50, 0x208000
    buffer_load_dwordx4 v33, s[8:11], s48 offen lds
    s_add_u32 m0, s51, 67584
    s_add_u32 s48, s50, 0x210000
    buffer_load_dwordx4 v32, s[8:11], s48 offen lds
    s_add_u32 m0, s51, 68608
    s_add_u32 s48, s50, 0x218000
    buffer_load_dwordx4 v33, s[8:11], s48 offen lds
    s_add_u32 m0, s51, 69632
    s_add_u32 s48, s50, 0x220000
    buffer_load_dwordx4 v34, s[8:11], s48 offen lds
    s_add_u32 m0, s51, 70656
    s_add_u32 s48, s50, 0x228000
    buffer_load_dwordx4 v35, s[8:11], s48 offen lds
    s_add_u32 m0, s51, 71680
    s_add_u32 s48, s50, 0x230000
    buffer_load_dwordx4 v34, s[8:11], s48 offen lds
    s_add_u32 m0, s51, 72704
    s_add_u32 s48, s50, 0x238000
    buffer_load_dwordx4 v35, s[8:11], s48 offen lds
    v_add_u32 v26, 131072, v40
    v_add_u32 v27, 131072, v41
    ds_read_b64_tr_b16 a[0:1], v26 offset:0
    ds_read_b64_tr_b16 a[2:3], v26 offset:256
    ds_read_b64_tr_b16 a[4:5], v26 offset:8192
    ds_read_b64_tr_b16 a[6:7], v26 offset:8448
    ds_read_b64_tr_b16 a[64:65], v27 offset:0
    ds_read_b64_tr_b16 a[66:67], v27 offset:256
    ds_read_b64_tr_b16 a[68:69], v27 offset:8192
    ds_read_b64_tr_b16 a[70:71], v27 offset:8448
    ds_read_b64_tr_b16 a[8:9], v26 offset:16384
    ds_read_b64_tr_b16 a[10:11], v26 offset:16640
    ds_read_b64_tr_b16 a[12:13], v26 offset:24576
    ds_read_b64_tr_b16 a[14:15], v26 offset:24832
    ds_read_b64_tr_b16 a[72:73], v27 offset:16384
    ds_read_b64_tr_b16 a[74:75], v27 offset:16640
    ds_read_b64_tr_b16 a[76:77], v27 offset:24576
    ds_read_b64_tr_b16 a[78:79], v27 offset:24832
    s_waitcnt lgkmcnt(0)
    s_waitcnt vmcnt(16)
    s_barrier
    s_add_u32 m0, s51, 98304
    s_add_u32 s48, s50, 0x300000
    buffer_load_dwordx4 v32, s[8:11], s48 offen lds
    s_add_u32 m0, s51, 99328
    s_add_u32 s48, s50, 0x308000
    buffer_load_dwordx4 v33, s[8:11], s48 offen lds
    s_add_u32 m0, s51, 100352
    s_add_u32 s48, s50, 0x310000
    buffer_load_dwordx4 v32, s[8:11], s48 offen lds
    s_add_u32 m0, s51, 101376
    s_add_u32 s48, s50, 0x318000
    buffer_load_dwordx4 v33, s[8:11], s48 offen lds
    s_add_u32 m0, s51, 102400
    s_add_u32 s48, s50, 0x320000
    buffer_load_dwordx4 v34, s[8:11], s48 offen lds
    s_add_u32 m0, s51, 103424
    s_add_u32 s48, s50, 0x328000
    buffer_load_dwordx4 v35, s[8:11], s48 offen lds
    s_add_u32 m0, s51, 104448
    s_add_u32 s48, s50, 0x330000
    buffer_load_dwordx4 v34, s[8:11], s48 offen lds
    s_add_u32 m0, s51, 105472
    s_add_u32 s48, s50, 0x338000
    buffer_load_dwordx4 v35, s[8:11], s48 offen lds
    v_add_u32 v26, 32768, v40
    v_add_u32 v27, 32768, v41
    ds_read_b64_tr_b16 a[176:177], v26 offset:0
    ds_read_b64_tr_b16 a[178:179], v26 offset:256
    ds_read_b64_tr_b16 a[180:181], v26 offset:8192
    ds_read_b64_tr_b16 a[182:183], v26 offset:8448
    ds_read_b64_tr_b16 a[240:241], v27 offset:0
    ds_read_b64_tr_b16 a[242:243], v27 offset:256
    ds_read_b64_tr_b16 a[244:245], v27 offset:8192
    ds_read_b64_tr_b16 a[246:247], v27 offset:8448
    ds_read_b64_tr_b16 a[184:185], v26 offset:16384
    ds_read_b64_tr_b16 a[186:187], v26 offset:16640
    ds_read_b64_tr_b16 a[188:189], v26 offset:24576
    ds_read_b64_tr_b16 a[190:191], v26 offset:24832
    ds_read_b64_tr_b16 a[248:249], v27 offset:16384
    ds_read_b64_tr_b16 a[250:251], v27 offset:16640
    ds_read_b64_tr_b16 a[252:253], v27 offset:24576
    ds_read_b64_tr_b16 a[254:255], v27 offset:24832
    s_waitcnt lgkmcnt(0)
    s_waitcnt vmcnt(16)
    s_barrier
    s_mov_b32 s8, s40
    s_and_b32 s9, s41, 0xffff
    s_mov_b32 s10, 0x400000
    s_mov_b32 s11, 0x00020000
    s_add_u32 m0, s51, 0
    s_add_u32 s48, s50, 0x0
    buffer_load_dwordx4 v32, s[8:11], s48 offen lds
    s_add_u32 m0, s51, 1024
    s_add_u32 s48, s50, 0x8000
    buffer_load_dwordx4 v33, s[8:11], s48 offen lds
    s_add_u32 m0, s51, 2048
    s_add_u32 s48, s50, 0x10000
    buffer_load_dwordx4 v32, s[8:11], s48 offen lds
    s_add_u32 m0, s51, 3072
    s_add_u32 s48, s50, 0x18000
    buffer_load_dwordx4 v33, s[8:11], s48 offen lds
    s_add_u32 m0, s51, 4096
    s_add_u32 s48, s50, 0x20000
    buffer_load_dwordx4 v34, s[8:11], s48 offen lds
    s_add_u32 m0, s51, 5120
    s_add_u32 s48, s50, 0x28000
    buffer_load_dwordx4 v35, s[8:11], s48 offen lds
    s_add_u32 m0, s51, 6144
    s_add_u32 s48, s50, 0x30000
    buffer_load_dwordx4 v34, s[8:11], s48 offen lds
    s_add_u32 m0, s51, 7168
    s_add_u32 s48, s50, 0x38000
    buffer_load_dwordx4 v35, s[8:11], s48 offen lds
    v_add_u32 v26, 65536, v40
    v_add_u32 v27, 65536, v41
    ds_read_b64_tr_b16 a[160:161], v26 offset:0
    ds_read_b64_tr_b16 a[162:163], v26 offset:256
    ds_read_b64_tr_b16 a[164:165], v26 offset:8192
    ds_read_b64_tr_b16 a[166:167], v26 offset:8448
    ds_read_b64_tr_b16 a[224:225], v27 offset:0
    ds_read_b64_tr_b16 a[226:227], v27 offset:256
    ds_read_b64_tr_b16 a[228:229], v27 offset:8192
    ds_read_b64_tr_b16 a[230:231], v27 offset:8448
    ds_read_b64_tr_b16 a[168:169], v26 offset:16384
    ds_read_b64_tr_b16 a[170:171], v26 offset:16640
    ds_read_b64_tr_b16 a[172:173], v26 offset:24576
    ds_read_b64_tr_b16 a[174:175], v26 offset:24832
    ds_read_b64_tr_b16 a[232:233], v27 offset:16384
    ds_read_b64_tr_b16 a[234:235], v27 offset:16640
    ds_read_b64_tr_b16 a[236:237], v27 offset:24576
    ds_read_b64_tr_b16 a[238:239], v27 offset:24832
    s_waitcnt lgkmcnt(0)
    s_waitcnt vmcnt(16)
    s_barrier
    s_add_u32 m0, s51, 32768
    s_add_u32 s48, s50, 0x100000
    buffer_load_dwordx4 v32, s[8:11], s48 offen lds
    s_add_u32 m0, s51, 33792
    s_add_u32 s48, s50, 0x108000
    buffer_load_dwordx4 v33, s[8:11], s48 offen lds
    s_add_u32 m0, s51, 34816
    s_add_u32 s48, s50, 0x110000
    buffer_load_dwordx4 v32, s[8:11], s48 offen lds
    s_add_u32 m0, s51, 35840
    s_add_u32 s48, s50, 0x118000
    buffer_load_dwordx4 v33, s[8:11], s48 offen lds
    s_add_u32 m0, s51, 36864
    s_add_u32 s48, s50, 0x120000
    buffer_load_dwordx4 v34, s[8:11], s48 offen lds
    s_add_u32 m0, s51, 37888
    s_add_u32 s48, s50, 0x128000
    buffer_load_dwordx4 v35, s[8:11], s48 offen lds
    s_add_u32 m0, s51, 38912
    s_add_u32 s48, s50, 0x130000
    buffer_load_dwordx4 v34, s[8:11], s48 offen lds
    s_add_u32 m0, s51, 39936
    s_add_u32 s48, s50, 0x138000
    buffer_load_dwordx4 v35, s[8:11], s48 offen lds
    v_add_u32 v26, 98304, v40
    v_add_u32 v27, 98304, v41
    ds_read_b64_tr_b16 a[144:145], v26 offset:0
    ds_read_b64_tr_b16 a[146:147], v26 offset:256
    ds_read_b64_tr_b16 a[148:149], v26 offset:8192
    ds_read_b64_tr_b16 a[150:151], v26 offset:8448
    ds_read_b64_tr_b16 a[208:209], v27 offset:0
    ds_read_b64_tr_b16 a[210:211], v27 offset:256
    ds_read_b64_tr_b16 a[212:213], v27 offset:8192
    ds_read_b64_tr_b16 a[214:215], v27 offset:8448
    ds_read_b64_tr_b16 a[152:153], v26 offset:16384
    ds_read_b64_tr_b16 a[154:155], v26 offset:16640
    ds_read_b64_tr_b16 a[156:157], v26 offset:24576
    ds_read_b64_tr_b16 a[158:159], v26 offset:24832
    ds_read_b64_tr_b16 a[216:217], v27 offset:16384
    ds_read_b64_tr_b16 a[218:219], v27 offset:16640
    ds_read_b64_tr_b16 a[220:221], v27 offset:24576
    ds_read_b64_tr_b16 a[222:223], v27 offset:24832
    s_waitcnt lgkmcnt(0)
    s_waitcnt vmcnt(16)
    s_barrier
    s_add_u32 m0, s51, 65536
    s_add_u32 s48, s50, 0x200000
    buffer_load_dwordx4 v32, s[8:11], s48 offen lds
    s_add_u32 m0, s51, 66560
    s_add_u32 s48, s50, 0x208000
    buffer_load_dwordx4 v33, s[8:11], s48 offen lds
    s_add_u32 m0, s51, 67584
    s_add_u32 s48, s50, 0x210000
    buffer_load_dwordx4 v32, s[8:11], s48 offen lds
    s_add_u32 m0, s51, 68608
    s_add_u32 s48, s50, 0x218000
    buffer_load_dwordx4 v33, s[8:11], s48 offen lds
    s_add_u32 m0, s51, 69632
    s_add_u32 s48, s50, 0x220000
    buffer_load_dwordx4 v34, s[8:11], s48 offen lds
    s_add_u32 m0, s51, 70656
    s_add_u32 s48, s50, 0x228000
    buffer_load_dwordx4 v35, s[8:11], s48 offen lds
    s_add_u32 m0, s51, 71680
    s_add_u32 s48, s50, 0x230000
    buffer_load_dwordx4 v34, s[8:11], s48 offen lds
    s_add_u32 m0, s51, 72704
    s_add_u32 s48, s50, 0x238000
    buffer_load_dwordx4 v35, s[8:11], s48 offen lds
    v_add_u32 v26, 131072, v40
    v_add_u32 v27, 131072, v41
    ds_read_b64_tr_b16 a[128:129], v26 offset:0
    ds_read_b64_tr_b16 a[130:131], v26 offset:256
    ds_read_b64_tr_b16 a[132:133], v26 offset:8192
    ds_read_b64_tr_b16 a[134:135], v26 offset:8448
    ds_read_b64_tr_b16 a[192:193], v27 offset:0
    ds_read_b64_tr_b16 a[194:195], v27 offset:256
    ds_read_b64_tr_b16 a[196:197], v27 offset:8192
    ds_read_b64_tr_b16 a[198:199], v27 offset:8448
    ds_read_b64_tr_b16 a[136:137], v26 offset:16384
    ds_read_b64_tr_b16 a[138:139], v26 offset:16640
    ds_read_b64_tr_b16 a[140:141], v26 offset:24576
    ds_read_b64_tr_b16 a[142:143], v26 offset:24832
    ds_read_b64_tr_b16 a[200:201], v27 offset:16384
    ds_read_b64_tr_b16 a[202:203], v27 offset:16640
    ds_read_b64_tr_b16 a[204:205], v27 offset:24576
    ds_read_b64_tr_b16 a[206:207], v27 offset:24832
    s_waitcnt lgkmcnt(0)
    s_waitcnt vmcnt(16)
    s_barrier
    s_add_u32 m0, s51, 98304
    s_add_u32 s48, s50, 0x300000
    buffer_load_dwordx4 v32, s[8:11], s48 offen lds
    s_add_u32 m0, s51, 99328
    s_add_u32 s48, s50, 0x308000
    buffer_load_dwordx4 v33, s[8:11], s48 offen lds
    s_add_u32 m0, s51, 100352
    s_add_u32 s48, s50, 0x310000
    buffer_load_dwordx4 v32, s[8:11], s48 offen lds
    s_add_u32 m0, s51, 101376
    s_add_u32 s48, s50, 0x318000
    buffer_load_dwordx4 v33, s[8:11], s48 offen lds
    s_add_u32 m0, s51, 102400
    s_add_u32 s48, s50, 0x320000
    buffer_load_dwordx4 v34, s[8:11], s48 offen lds
    s_add_u32 m0, s51, 103424
    s_add_u32 s48, s50, 0x328000
    buffer_load_dwordx4 v35, s[8:11], s48 offen lds
    s_add_u32 m0, s51, 104448
    s_add_u32 s48, s50, 0x330000
    buffer_load_dwordx4 v34, s[8:11], s48 offen lds
    s_add_u32 m0, s51, 105472
    s_add_u32 s48, s50, 0x338000
    buffer_load_dwordx4 v35, s[8:11], s48 offen lds
    v_add_u32 v26, 32768, v40
    v_add_u32 v27, 32768, v41
    ds_read_b64_tr_b16 v[176:177], v26 offset:0
    ds_read_b64_tr_b16 v[178:179], v26 offset:256
    ds_read_b64_tr_b16 v[180:181], v26 offset:8192
    ds_read_b64_tr_b16 v[182:183], v26 offset:8448
    ds_read_b64_tr_b16 v[240:241], v27 offset:0
    ds_read_b64_tr_b16 v[242:243], v27 offset:256
    ds_read_b64_tr_b16 v[244:245], v27 offset:8192
    ds_read_b64_tr_b16 v[246:247], v27 offset:8448
    ds_read_b64_tr_b16 v[184:185], v26 offset:16384
    ds_read_b64_tr_b16 v[186:187], v26 offset:16640
    ds_read_b64_tr_b16 v[188:189], v26 offset:24576
    ds_read_b64_tr_b16 v[190:191], v26 offset:24832
    ds_read_b64_tr_b16 v[248:249], v27 offset:16384
    ds_read_b64_tr_b16 v[250:251], v27 offset:16640
    ds_read_b64_tr_b16 v[252:253], v27 offset:24576
    ds_read_b64_tr_b16 v[254:255], v27 offset:24832
    s_waitcnt lgkmcnt(0)
    s_waitcnt vmcnt(16)
    s_barrier
    s_mov_b32 s8, s42
    s_and_b32 s9, s43, 0xffff
    s_mov_b32 s10, 0x400000
    s_mov_b32 s11, 0x00020000
    s_add_u32 m0, s51, 0
    s_add_u32 s48, s53, 0x0
    buffer_load_dwordx4 v36, s[8:11], s48 offen lds
    s_add_u32 m0, s51, 1024
    s_add_u32 s48, s53, 0x1000
    buffer_load_dwordx4 v37, s[8:11], s48 offen lds
    s_add_u32 m0, s51, 2048
    s_add_u32 s48, s53, 0x2000
    buffer_load_dwordx4 v36, s[8:11], s48 offen lds
    s_add_u32 m0, s51, 3072
    s_add_u32 s48, s53, 0x3000
    buffer_load_dwordx4 v37, s[8:11], s48 offen lds
    s_add_u32 m0, s51, 4096
    s_add_u32 s48, s53, 0x4000
    buffer_load_dwordx4 v38, s[8:11], s48 offen lds
    s_add_u32 m0, s51, 5120
    s_add_u32 s48, s53, 0x5000
    buffer_load_dwordx4 v39, s[8:11], s48 offen lds
    s_add_u32 m0, s51, 6144
    s_add_u32 s48, s53, 0x6000
    buffer_load_dwordx4 v38, s[8:11], s48 offen lds
    s_add_u32 m0, s51, 7168
    s_add_u32 s48, s53, 0x7000
    buffer_load_dwordx4 v39, s[8:11], s48 offen lds
    v_add_u32 v26, 65536, v40
    v_add_u32 v27, 65536, v41
    ds_read_b64_tr_b16 v[160:161], v26 offset:0
    ds_read_b64_tr_b16 v[162:163], v26 offset:256
    ds_read_b64_tr_b16 v[164:165], v26 offset:8192
    ds_read_b64_tr_b16 v[166:167], v26 offset:8448
    ds_read_b64_tr_b16 v[224:225], v27 offset:0
    ds_read_b64_tr_b16 v[226:227], v27 offset:256
    ds_read_b64_tr_b16 v[228:229], v27 offset:8192
    ds_read_b64_tr_b16 v[230:231], v27 offset:8448
    ds_read_b64_tr_b16 v[168:169], v26 offset:16384
    ds_read_b64_tr_b16 v[170:171], v26 offset:16640
    ds_read_b64_tr_b16 v[172:173], v26 offset:24576
    ds_read_b64_tr_b16 v[174:175], v26 offset:24832
    ds_read_b64_tr_b16 v[232:233], v27 offset:16384
    ds_read_b64_tr_b16 v[234:235], v27 offset:16640
    ds_read_b64_tr_b16 v[236:237], v27 offset:24576
    ds_read_b64_tr_b16 v[238:239], v27 offset:24832
    s_waitcnt lgkmcnt(0)
    s_waitcnt vmcnt(16)
    s_barrier
    s_add_u32 m0, s51, 32768
    s_add_u32 s48, s53, 0x100
    buffer_load_dwordx4 v36, s[8:11], s48 offen lds
    s_add_u32 m0, s51, 33792
    s_add_u32 s48, s53, 0x1100
    buffer_load_dwordx4 v37, s[8:11], s48 offen lds
    s_add_u32 m0, s51, 34816
    s_add_u32 s48, s53, 0x2100
    buffer_load_dwordx4 v36, s[8:11], s48 offen lds
    s_add_u32 m0, s51, 35840
    s_add_u32 s48, s53, 0x3100
    buffer_load_dwordx4 v37, s[8:11], s48 offen lds
    s_add_u32 m0, s51, 36864
    s_add_u32 s48, s53, 0x4100
    buffer_load_dwordx4 v38, s[8:11], s48 offen lds
    s_add_u32 m0, s51, 37888
    s_add_u32 s48, s53, 0x5100
    buffer_load_dwordx4 v39, s[8:11], s48 offen lds
    s_add_u32 m0, s51, 38912
    s_add_u32 s48, s53, 0x6100
    buffer_load_dwordx4 v38, s[8:11], s48 offen lds
    s_add_u32 m0, s51, 39936
    s_add_u32 s48, s53, 0x7100
    buffer_load_dwordx4 v39, s[8:11], s48 offen lds
    v_add_u32 v26, 98304, v40
    v_add_u32 v27, 98304, v41
    ds_read_b64_tr_b16 v[144:145], v26 offset:0
    ds_read_b64_tr_b16 v[146:147], v26 offset:256
    ds_read_b64_tr_b16 v[148:149], v26 offset:8192
    ds_read_b64_tr_b16 v[150:151], v26 offset:8448
    ds_read_b64_tr_b16 v[208:209], v27 offset:0
    ds_read_b64_tr_b16 v[210:211], v27 offset:256
    ds_read_b64_tr_b16 v[212:213], v27 offset:8192
    ds_read_b64_tr_b16 v[214:215], v27 offset:8448
    ds_read_b64_tr_b16 v[152:153], v26 offset:16384
    ds_read_b64_tr_b16 v[154:155], v26 offset:16640
    ds_read_b64_tr_b16 v[156:157], v26 offset:24576
    ds_read_b64_tr_b16 v[158:159], v26 offset:24832
    ds_read_b64_tr_b16 v[216:217], v27 offset:16384
    ds_read_b64_tr_b16 v[218:219], v27 offset:16640
    ds_read_b64_tr_b16 v[220:221], v27 offset:24576
    ds_read_b64_tr_b16 v[222:223], v27 offset:24832
    s_waitcnt lgkmcnt(0)
    s_waitcnt vmcnt(16)
    s_barrier
    s_add_u32 m0, s51, 65536
    s_add_u32 s48, s53, 0x200
    buffer_load_dwordx4 v36, s[8:11], s48 offen lds
    s_add_u32 m0, s51, 66560
    s_add_u32 s48, s53, 0x1200
    buffer_load_dwordx4 v37, s[8:11], s48 offen lds
    s_add_u32 m0, s51, 67584
    s_add_u32 s48, s53, 0x2200
    buffer_load_dwordx4 v36, s[8:11], s48 offen lds
    s_add_u32 m0, s51, 68608
    s_add_u32 s48, s53, 0x3200
    buffer_load_dwordx4 v37, s[8:11], s48 offen lds
    s_add_u32 m0, s51, 69632
    s_add_u32 s48, s53, 0x4200
    buffer_load_dwordx4 v38, s[8:11], s48 offen lds
    s_add_u32 m0, s51, 70656
    s_add_u32 s48, s53, 0x5200
    buffer_load_dwordx4 v39, s[8:11], s48 offen lds
    s_add_u32 m0, s51, 71680
    s_add_u32 s48, s53, 0x6200
    buffer_load_dwordx4 v38, s[8:11], s48 offen lds
    s_add_u32 m0, s51, 72704
    s_add_u32 s48, s53, 0x7200
    buffer_load_dwordx4 v39, s[8:11], s48 offen lds
    v_lshrrev_b32 v122, 2, v2
    v_add_u32 v26, 131072, v40
    v_add_u32 v27, 131072, v41
    ds_read_b64_tr_b16 v[128:129], v26 offset:0
    ds_read_b64_tr_b16 v[130:131], v26 offset:256
    ds_read_b64_tr_b16 v[132:133], v26 offset:8192
    ds_read_b64_tr_b16 v[134:135], v26 offset:8448
    ds_read_b64_tr_b16 v[192:193], v27 offset:0
    ds_read_b64_tr_b16 v[194:195], v27 offset:256
    ds_read_b64_tr_b16 v[196:197], v27 offset:8192
    ds_read_b64_tr_b16 v[198:199], v27 offset:8448
    ds_read_b64_tr_b16 v[136:137], v26 offset:16384
    ds_read_b64_tr_b16 v[138:139], v26 offset:16640
    ds_read_b64_tr_b16 v[140:141], v26 offset:24576
    ds_read_b64_tr_b16 v[142:143], v26 offset:24832
    ds_read_b64_tr_b16 v[200:201], v27 offset:16384
    ds_read_b64_tr_b16 v[202:203], v27 offset:16640
    ds_read_b64_tr_b16 v[204:205], v27 offset:24576
    ds_read_b64_tr_b16 v[206:207], v27 offset:24832
    s_waitcnt lgkmcnt(0)
    s_barrier
    s_add_u32 m0, s51, 98304
    s_add_u32 s48, s53, 0x300
    buffer_load_dwordx4 v36, s[8:11], s48 offen lds
    s_add_u32 m0, s51, 99328
    s_add_u32 s48, s53, 0x1300
    buffer_load_dwordx4 v37, s[8:11], s48 offen lds
    s_add_u32 m0, s51, 100352
    s_add_u32 s48, s53, 0x2300
    buffer_load_dwordx4 v36, s[8:11], s48 offen lds
    s_add_u32 m0, s51, 101376
    s_add_u32 s48, s53, 0x3300
    buffer_load_dwordx4 v37, s[8:11], s48 offen lds
    s_add_u32 m0, s51, 102400
    s_add_u32 s48, s53, 0x4300
    buffer_load_dwordx4 v38, s[8:11], s48 offen lds
    s_add_u32 m0, s51, 103424
    s_add_u32 s48, s53, 0x5300
    buffer_load_dwordx4 v39, s[8:11], s48 offen lds
    s_add_u32 m0, s51, 104448
    s_add_u32 s48, s53, 0x6300
    buffer_load_dwordx4 v38, s[8:11], s48 offen lds
    s_add_u32 m0, s51, 105472
    s_add_u32 s48, s53, 0x7300
    buffer_load_dwordx4 v39, s[8:11], s48 offen lds
R_wdone:
    v_bfe_u32 v31, v0, 4, 1
    v_lshlrev_b32 v24, 12, v31
    v_bfe_u32 v31, v0, 5, 1
    v_lshl_add_u32 v24, v31, 11, v24
    v_bfe_u32 v31, v0, 3, 1
    v_lshl_add_u32 v24, v31, 10, v24
    v_bfe_u32 v31, v0, 2, 1
    v_lshl_add_u32 v24, v31, 8, v24
    v_bfe_u32 v31, v0, 6, 2
    v_lshl_add_u32 v24, v31, 15, v24
    v_bfe_u32 v31, v0, 1, 1
    v_lshl_add_u32 v24, v31, 4, v24
    v_bfe_u32 v31, v0, 0, 1
    v_lshl_add_u32 v24, v31, 3, v24
    v_bfe_u32 v31, v0, 2, 1
    v_lshl_add_u32 v24, v31, 5, v24
    v_bfe_u32 v31, v0, 3, 1
    v_lshl_add_u32 v24, v31, 6, v24
    v_bfe_u32 v31, v0, 4, 1
    v_lshl_add_u32 v24, v31, 7, v24
    v_add_u32 v24, 32768, v24
    s_waitcnt vmcnt(0)
    s_bfe_u32 s56, s14, 0x50000
    s_lshl_b32 s56, s56, 7
    s_add_u32 s56, s56, 0x7210000
    s_barrier
    buffer_load_dword v119, v8, s[4:7], s56 offen sc1
    ds_read_b32 v123, v122 offset:31744
    v_xor_b32 v25, 0, v24
    ds_read_b64_tr_b16 v[32:33], v25 offset:0
    ds_read_b64_tr_b16 v[34:35], v25 offset:512
    ds_read_b64_tr_b16 v[36:37], v25 offset:8192
    ds_read_b64_tr_b16 v[38:39], v25 offset:8704
    v_xor_b32 v25, 32, v24
    ds_read_b64_tr_b16 v[40:41], v25 offset:0
    ds_read_b64_tr_b16 v[42:43], v25 offset:512
    ds_read_b64_tr_b16 v[44:45], v25 offset:8192
    ds_read_b64_tr_b16 v[46:47], v25 offset:8704
    v_xor_b32 v25, 64, v24
    ds_read_b64_tr_b16 v[48:49], v25 offset:0
    ds_read_b64_tr_b16 v[50:51], v25 offset:512
    ds_read_b64_tr_b16 v[52:53], v25 offset:8192
    ds_read_b64_tr_b16 v[54:55], v25 offset:8704
    v_xor_b32 v25, 96, v24
    ds_read_b64_tr_b16 v[56:57], v25 offset:0
    ds_read_b64_tr_b16 v[58:59], v25 offset:512
    ds_read_b64_tr_b16 v[60:61], v25 offset:8192
    ds_read_b64_tr_b16 v[62:63], v25 offset:8704
    v_xor_b32 v25, 128, v24
    ds_read_b64_tr_b16 v[64:65], v25 offset:0
    ds_read_b64_tr_b16 v[66:67], v25 offset:512
    ds_read_b64_tr_b16 v[68:69], v25 offset:8192
    ds_read_b64_tr_b16 v[70:71], v25 offset:8704
    v_xor_b32 v25, 160, v24
    ds_read_b64_tr_b16 v[72:73], v25 offset:0
    ds_read_b64_tr_b16 v[74:75], v25 offset:512
    ds_read_b64_tr_b16 v[76:77], v25 offset:8192
    ds_read_b64_tr_b16 v[78:79], v25 offset:8704
    v_xor_b32 v25, 192, v24
    ds_read_b64_tr_b16 v[80:81], v25 offset:0
    ds_read_b64_tr_b16 v[82:83], v25 offset:512
    ds_read_b64_tr_b16 v[84:85], v25 offset:8192
    ds_read_b64_tr_b16 v[86:87], v25 offset:8704
    v_xor_b32 v25, 224, v24
    ds_read_b64_tr_b16 v[88:89], v25 offset:0
    ds_read_b64_tr_b16 v[90:91], v25 offset:512
    ds_read_b64_tr_b16 v[92:93], v25 offset:8192
    ds_read_b64_tr_b16 v[94:95], v25 offset:8704
    s_waitcnt lgkmcnt(0)
    ds_write_b128 v6, v[32:35] offset:0
    ds_write_b128 v6, v[36:39] offset:1024
    ds_write_b128 v6, v[40:43] offset:2048
    ds_write_b128 v6, v[44:47] offset:3072
    ds_write_b128 v6, v[48:51] offset:4096
    ds_write_b128 v6, v[52:55] offset:5120
    ds_write_b128 v6, v[56:59] offset:6144
    ds_write_b128 v6, v[60:63] offset:7168
    ds_write_b128 v6, v[64:67] offset:8192
    ds_write_b128 v6, v[68:71] offset:9216
    ds_write_b128 v6, v[72:75] offset:10240
    ds_write_b128 v6, v[76:79] offset:11264
    ds_write_b128 v6, v[80:83] offset:12288
    ds_write_b128 v6, v[84:87] offset:13312
    ds_write_b128 v6, v[88:91] offset:14336
    ds_write_b128 v6, v[92:95] offset:15360
    s_waitcnt lgkmcnt(0)
    v_xor_b32 v25, 0, v24
    ds_read_b64_tr_b16 v[32:33], v25 offset:16384
    ds_read_b64_tr_b16 v[34:35], v25 offset:16896
    ds_read_b64_tr_b16 v[36:37], v25 offset:24576
    ds_read_b64_tr_b16 v[38:39], v25 offset:25088
    v_xor_b32 v25, 32, v24
    ds_read_b64_tr_b16 v[40:41], v25 offset:16384
    ds_read_b64_tr_b16 v[42:43], v25 offset:16896
    ds_read_b64_tr_b16 v[44:45], v25 offset:24576
    ds_read_b64_tr_b16 v[46:47], v25 offset:25088
    v_xor_b32 v25, 64, v24
    ds_read_b64_tr_b16 v[48:49], v25 offset:16384
    ds_read_b64_tr_b16 v[50:51], v25 offset:16896
    ds_read_b64_tr_b16 v[52:53], v25 offset:24576
    ds_read_b64_tr_b16 v[54:55], v25 offset:25088
    v_xor_b32 v25, 96, v24
    ds_read_b64_tr_b16 v[56:57], v25 offset:16384
    ds_read_b64_tr_b16 v[58:59], v25 offset:16896
    ds_read_b64_tr_b16 v[60:61], v25 offset:24576
    ds_read_b64_tr_b16 v[62:63], v25 offset:25088
    v_xor_b32 v25, 128, v24
    ds_read_b64_tr_b16 v[64:65], v25 offset:16384
    ds_read_b64_tr_b16 v[66:67], v25 offset:16896
    ds_read_b64_tr_b16 v[68:69], v25 offset:24576
    ds_read_b64_tr_b16 v[70:71], v25 offset:25088
    v_xor_b32 v25, 160, v24
    ds_read_b64_tr_b16 v[72:73], v25 offset:16384
    ds_read_b64_tr_b16 v[74:75], v25 offset:16896
    ds_read_b64_tr_b16 v[76:77], v25 offset:24576
    ds_read_b64_tr_b16 v[78:79], v25 offset:25088
    v_xor_b32 v25, 192, v24
    ds_read_b64_tr_b16 v[80:81], v25 offset:16384
    ds_read_b64_tr_b16 v[82:83], v25 offset:16896
    ds_read_b64_tr_b16 v[84:85], v25 offset:24576
    ds_read_b64_tr_b16 v[86:87], v25 offset:25088
    v_xor_b32 v25, 224, v24
    ds_read_b64_tr_b16 v[88:89], v25 offset:16384
    ds_read_b64_tr_b16 v[90:91], v25 offset:16896
    ds_read_b64_tr_b16 v[92:93], v25 offset:24576
    ds_read_b64_tr_b16 v[94:95], v25 offset:25088
    s_waitcnt lgkmcnt(0)
    ds_write_b128 v6, v[32:35] offset:16384
    ds_write_b128 v6, v[36:39] offset:17408
    ds_write_b128 v6, v[40:43] offset:18432
    ds_write_b128 v6, v[44:47] offset:19456
    ds_write_b128 v6, v[48:51] offset:20480
    ds_write_b128 v6, v[52:55] offset:21504
    ds_write_b128 v6, v[56:59] offset:22528
    ds_write_b128 v6, v[60:63] offset:23552
    ds_write_b128 v6, v[64:67] offset:24576
    ds_write_b128 v6, v[68:71] offset:25600
    ds_write_b128 v6, v[72:75] offset:26624
    ds_write_b128 v6, v[76:79] offset:27648
    ds_write_b128 v6, v[80:83] offset:28672
    ds_write_b128 v6, v[84:87] offset:29696
    ds_write_b128 v6, v[88:91] offset:30720
    ds_write_b128 v6, v[92:95] offset:31744
    s_waitcnt lgkmcnt(0)
    s_cmp_lg_u32 s75, 0
    s_cbranch_scc1 vc_5_done
    v_mov_b32 v125, 32256
    s_cmp_lg_u32 s15, 0
    s_cbranch_scc1 vc_5_w
    s_waitcnt vmcnt(1)
    s_mov_b64 exec, 1
    ds_write_b32 v125, v126
    s_mov_b64 exec, -1
    s_waitcnt lgkmcnt(0)
vc_5_w:
    s_barrier
    ds_read_b32 v124, v125
    s_waitcnt lgkmcnt(0)
    v_readfirstlane_b32 s48, v124
    s_mov_b32 s75, 1
    s_nop 2
    s_bitcmp1_b32 s48, s14
    s_cbranch_scc1 L_overflow
vc_5_done:
    v_readlane_b32 s50, v123, 40
    v_readlane_b32 s51, v123, 0
    s_waitcnt vmcnt(0)
    v_readlane_b32 s55, v119, 0
    v_readlane_b32 s48, v119, 2
    s_nop 1
    s_min_u32 s55, s55, s48
    s_mov_b32 s57, s51
    s_cmp_ge_u32 s50, 32
    s_cbranch_scc1 R_lnok
    s_mov_b32 s55, 0
    s_mov_b32 s30, 0
R_lnw:
    global_load_dword v123, v122, s[12:13] sc1
    s_waitcnt vmcnt(0)
    v_readlane_b32 s50, v123, 40
    s_nop 1
    s_cmp_ge_u32 s50, 32
    s_cbranch_scc1 R_lnok
    s_sleep 32
    s_add_u32 s30, s30, 1
    s_cmp_lt_u32 s30, s29
    s_cbranch_scc1 R_lnw
R_lnok:
    s_cmp_ge_u32 s55, 2
    s_cbranch_scc1 kvw_6_ok
    s_mov_b32 s30, 0
kvw_6:
    buffer_load_dword v119, v8, s[4:7], s56 offen sc1
    s_waitcnt vmcnt(0)
    v_readlane_b32 s55, v119, 0
    v_readlane_b32 s48, v119, 2
    s_nop 1
    s_min_u32 s55, s55, s48
    s_cmp_ge_u32 s55, 2
    s_cbranch_scc1 kvw_6_ok
    s_sleep 2
    s_add_u32 s30, s30, 1
    s_cmp_lt_u32 s30, s29
    s_cbranch_scc1 kvw_6
    s_mov_b32 s29, 1
kvw_6_ok:
    s_cmp_eq_u32 s57, -1
    s_cbranch_scc1 R_fast
    v_mbcnt_lo_u32_b32 v24, -1, 0
    v_and_b32 v24, 31, v24
    v_lshlrev_b32 v24, 2, v24
    s_add_u32 s50, s3, 15
    s_cmp_eq_u32 s3, 0
    s_cselect_b32 s50, 0, s50
    s_mov_b32 s51, 0
md_7:
    global_load_dword v25, v24, s[12:13] sc1
    s_waitcnt vmcnt(0)
    v_readlane_b32 s48, v25, s50
    s_nop 1
    s_cmp_eq_u32 s48, -1
    s_cbranch_scc1 md_7_ok
    v_readlane_b32 s48, v25, 24
    v_readlane_b32 s49, v25, 0
    s_nop 1
    s_bcnt1_i32_b32 s49, s49
    s_add_u32 s48, s48, s49
    v_readlane_b32 s49, v25, 16
    s_nop 1
    s_bcnt1_i32_b32 s49, s49
    s_add_u32 s48, s48, s49
    v_readlane_b32 s49, v25, 17
    s_nop 1
    s_bcnt1_i32_b32 s49, s49
    s_add_u32 s48, s48, s49
    v_readlane_b32 s49, v25, 18
    s_nop 1
    s_bcnt1_i32_b32 s49, s49
    s_add_u32 s48, s48, s49
    v_readlane_b32 s49, v25, 19
    s_nop 1
    s_bcnt1_i32_b32 s49, s49
    s_add_u32 s48, s48, s49
    v_readlane_b32 s49, v25, 20
    s_nop 1
    s_bcnt1_i32_b32 s49, s49
    s_add_u32 s48, s48, s49
    v_readlane_b32 s49, v25, 21
    s_nop 1
    s_bcnt1_i32_b32 s49, s49
    s_add_u32 s48, s48, s49
    v_readlane_b32 s49, v25, 22
    s_nop 1
    s_bcnt1_i32_b32 s49, s49
    s_add_u32 s48, s48, s49
    s_cmp_ge_u32 s48, 256
    s_cbranch_scc1 R_slow
    s_sleep 32
    s_add_u32 s51, s51, 1
    s_cmp_lt_u32 s51, 50000
    s_cbranch_scc1 md_7
    s_branch R_slow
md_7_ok:
R_fast:
    s_bfe_u32 s50, s15, 0x20000
    s_lshl_b32 s50, s50, 11
    s_add_u32 s50, s50, 0x2000
    s_bfe_u32 s51, s15, 0x20000
    s_lshl_b32 s51, s51, 11
    s_add_u32 s51, s51, 0x3800
    s_mov_b32 m0, s50
    s_nop 0
    buffer_load_dwordx4 v2, s[4:7], s25 offen offset:0 sc1 lds
    buffer_load_dwordx4 v2, s[4:7], s25 offen offset:1024 sc1 lds
    s_mov_b32 m0, s51
    s_nop 0
    buffer_load_dwordx4 v2, s[4:7], s25 offen offset:2048 sc1 lds
    buffer_load_dwordx4 v2, s[4:7], s25 offen offset:3072 sc1 lds
    s_add_u32 s25, s25, 16384
    s_mov_b32 m0, s50
    s_sub_u32 s27, s27, 4096
    s_add_u32 s48, s27, 266240
    s_mov_b32 s26, s48
    v_mfma_f32_32x32x8_bf16 v[64:79], v[10:11], v[10:11], 0
    v_mfma_f32_32x32x8_bf16 v[80:95], v[10:11], v[10:11], 0
    v_xor_b32 v28, 2048, v1
    v_xor_b32 v29, 4096, v1
    v_xor_b32 v30, 6144, v1
    s_mov_b32 s30, 0
    s_add_u32 s48, s22, 8192
    buffer_load_dwordx4 v[96:99], v1, s[4:7], s48 offen offset:0 sc1
    buffer_load_dwordx4 v[96:99], v1, s[4:7], s48 offen offset:1024 sc1
    s_add_u32 s48, s22, 16384
    buffer_load_dwordx4 v[96:99], v1, s[4:7], s48 offen offset:0 sc1
    buffer_load_dwordx4 v[96:99], v1, s[4:7], s48 offen offset:1024 sc1
    buffer_load_dwordx4 v[96:99], v2, s[4:7], s19 offen offset:0 sc1
    buffer_load_dwordx4 v[96:99], v2, s[4:7], s19 offen offset:1024 sc1
    buffer_load_dwordx4 v[36:39], v1, s[4:7], s22 offen offset:1024 sc1
    buffer_load_dwordx4 v[32:35], v1, s[4:7], s22 offen offset:0 sc1
    buffer_load_dwordx4 v[32:35], v1, s[4:7], s22 offen offset:0 sc1
    s_branch RF_gA
RF_gf0:
    s_waitcnt vmcnt(0)
RF_gr0:
    v_max3_u32 v16, v32, v33, v34
    v_max_u32 v16, v16, v35
    v_cmp_eq_u32 vcc, -1, v16
    s_add_u32 s30, s30, 1
    s_cbranch_vccz RF_gx0
    buffer_load_dwordx4 v[32:35], v1, s[4:7], s22 offen offset:0 sc1
    s_cmp_lt_u32 s30, s29
    s_waitcnt vmcnt(0)
    s_cbranch_scc1 RF_gr0
    s_mov_b32 s29, 1
RF_gx0:
    ds_write_b128 v1, v[32:35] offset:0
    v_mfma_f32_16x16x16_bf16 v[64:67], v[10:11], v[10:11], 0
    s_nop 5
    v_smfmac_f32_16x16x64_bf16 v[64:67], v[32:35], a[0:7], v9
    s_branch RF_gok0
RF_gf1:
    s_waitcnt vmcnt(0)
RF_gr1:
    v_max3_u32 v16, v36, v37, v38
    v_max_u32 v16, v16, v39
    v_cmp_eq_u32 vcc, -1, v16
    s_add_u32 s30, s30, 1
    s_cbranch_vccz RF_gx1
    buffer_load_dwordx4 v[36:39], v1, s[4:7], s22 offen offset:1024 sc1
    s_cmp_lt_u32 s30, s29
    s_waitcnt vmcnt(0)
    s_cbranch_scc1 RF_gr1
    s_mov_b32 s29, 1
RF_gx1:
    ds_write_b128 v1, v[36:39] offset:1024
    s_branch RF_gok1
.p2align 6
RF_gA:
    s_waitcnt vmcnt(1)
    v_max3_u32 v16, v32, v33, v34
    v_max_u32 v16, v16, v35
    ds_write_b128 v1, v[32:35] offset:0
    v_cmp_eq_u32 vcc, -1, v16
    v_smfmac_f32_16x16x64_bf16 v[64:67], v[32:35], a[0:7], v9
    s_cbranch_vccnz RF_gf0
RF_gok0:
    v_smfmac_f32_16x16x64_bf16 v[72:75], v[32:35], a[128:135], v9
    buffer_load_dwordx4 v[36:39], v1, s[4:7], s22 offen offset:1024 sc1
    v_smfmac_f32_16x16x64_bf16 v[68:71], v[32:35], a[64:71], v9
    v_smfmac_f32_16x16x64_bf16 v[76:79], v[32:35], a[192:199], v9
    v_smfmac_f32_16x16x64_bf16 v[80:83], v[32:35], v[128:135], v9
    s_waitcnt lgkmcnt(0)
    s_barrier
    ds_read_b128 v[40:43], v28 offset:0
    v_smfmac_f32_16x16x64_bf16 v[84:87], v[32:35], v[192:199], v9
    ds_read_b128 v[48:51], v29 offset:0
    ds_read_b128 v[56:59], v30 offset:0
    v_mfma_f32_16x16x16_bf16 v[20:23], v[10:11], v[10:11], 0
    ds_read_b128 v[104:107], v2 offset:9216
    ds_read_b128 v[108:111], v2 offset:13312
    v_mfma_f32_16x16x16_bf16 v[20:23], v[10:11], v[10:11], 0
    s_waitcnt lgkmcnt(4)
    v_smfmac_f32_16x16x64_bf16 v[64:67], v[40:43], a[16:23], v9
    ds_read_b128 v[112:115], v2 offset:10240
    v_smfmac_f32_16x16x64_bf16 v[72:75], v[40:43], a[144:151], v9
    ds_read_b128 v[116:119], v2 offset:14336
    v_smfmac_f32_16x16x64_bf16 v[68:71], v[40:43], a[80:87], v9
    ds_read_b128 v[120:123], v2 offset:11264
    v_smfmac_f32_16x16x64_bf16 v[76:79], v[40:43], a[208:215], v9
    ds_read_b128 v[124:127], v2 offset:15360
    s_waitcnt lgkmcnt(6)
    v_smfmac_f32_16x16x64_bf16 v[64:67], v[48:51], a[32:39], v9
    ds_read_b128 v[24:27], v2 offset:12288
    v_smfmac_f32_16x16x64_bf16 v[72:75], v[48:51], a[160:167], v9
    v_smfmac_f32_16x16x64_bf16 v[68:71], v[48:51], a[96:103], v9
    s_waitcnt vmcnt(0)
    ds_write_b128 v1, v[36:39] offset:1024
    v_smfmac_f32_16x16x64_bf16 v[76:79], v[48:51], a[224:231], v9
    v_cmp_eq_u32 vcc, -1, v36
    v_smfmac_f32_16x16x64_bf16 v[64:67], v[56:59], a[48:55], v9
    s_cbranch_vccnz RF_gf1
RF_gok1:
    ds_read_b128 v[32:35], v2 offset:8192
    v_smfmac_f32_16x16x64_bf16 v[72:75], v[56:59], a[176:183], v9
    s_cmp_eq_u32 s16, 63
    v_smfmac_f32_16x16x64_bf16 v[68:71], v[56:59], a[112:119], v9
    v_smfmac_f32_16x16x64_bf16 v[76:79], v[56:59], a[240:247], v9
    s_waitcnt lgkmcnt(0)
    s_barrier
    v_smfmac_f32_16x16x64_bf16 v[64:67], v[36:39], a[8:15], v9
    ds_read_b128 v[44:47], v28 offset:1024
    ds_read_b128 v[52:55], v29 offset:1024
    v_smfmac_f32_16x16x64_bf16 v[72:75], v[36:39], a[136:143], v9
    ds_read_b128 v[60:63], v30 offset:1024
    s_cbranch_scc1 RF_last
    v_smfmac_f32_16x16x64_bf16 v[68:71], v[36:39], a[72:79], v9
    buffer_load_dwordx4 v2, s[4:7], s25 offen offset:0 sc1 lds
    v_smfmac_f32_16x16x64_bf16 v[76:79], v[36:39], a[200:207], v9
    v_mov_b32 v28, 0x3f803f80
    s_waitcnt lgkmcnt(2)
    v_smfmac_f32_16x16x64_bf16 v[64:67], v[44:47], a[24:31], v9
    v_mov_b32 v31, 0x3f803f80
    s_waitcnt lgkmcnt(0)
    v_mov_b32 v29, 0x3f803f80
    v_smfmac_f32_16x16x64_bf16 v[64:67], v[52:55], a[40:47], v9
    buffer_load_dwordx4 v2, s[4:7], s25 offen offset:1024 sc1 lds
    v_smfmac_f32_16x16x64_bf16 v[64:67], v[60:63], a[56:63], v9
    s_mov_b32 m0, s51
    v_mov_b32 v30, 0x3f803f80
    v_smfmac_f32_16x16x64_bf16 v[72:75], v[44:47], a[152:159], v9
    buffer_store_dwordx4 v[12:15], v2, s[4:7], s26 offen sc1
    v_smfmac_f32_16x16x64_bf16 v[72:75], v[52:55], a[168:175], v9
    s_add_u32 s27, s27, 4096
    v_add_f32 v64, v64, v65
    v_smfmac_f32_16x16x64_bf16 v[72:75], v[60:63], a[184:191], v9
    s_mov_b32 s26, s27
    v_add_f32 v66, v66, v67
    v_smfmac_f32_16x16x64_bf16 v[68:71], v[44:47], a[88:95], v9
    v_cvt_pk_bf16_f32 v12, v64, v66
    v_smfmac_f32_16x16x64_bf16 v[68:71], v[52:55], a[104:111], v9
    ds_read_b128 v[64:67], v1 offset:16384
    v_add_f32 v72, v72, v73
    v_smfmac_f32_16x16x64_bf16 v[68:71], v[60:63], a[120:127], v9
    buffer_load_dword v0, v8, s[4:7], s56 offen sc1
    v_add_f32 v74, v74, v75
    v_smfmac_f32_16x16x64_bf16 v[76:79], v[44:47], a[216:223], v9
    v_cvt_pk_bf16_f32 v13, v72, v74
    v_smfmac_f32_16x16x64_bf16 v[76:79], v[52:55], a[232:239], v9
    ds_read_b128 v[72:75], v1 offset:17408
    v_add_f32 v68, v68, v69
    v_smfmac_f32_16x16x64_bf16 v[76:79], v[60:63], a[248:255], v9
    v_add_f32 v70, v70, v71
    v_smfmac_f32_16x16x64_bf16 v[80:83], v[36:39], v[136:143], v9
    v_cvt_pk_bf16_f32 v14, v68, v70
    v_smfmac_f32_16x16x64_bf16 v[84:87], v[36:39], v[200:207], v9
    v_add_f32 v76, v76, v77
    v_add_f32 v78, v78, v79
    v_cvt_pk_bf16_f32 v15, v76, v78
    v_smfmac_f32_16x16x64_bf16 v[80:83], v[40:43], v[144:151], v9
    ds_write2st64_b64 v3, v[12:13], v[14:15] offset1:1
    v_smfmac_f32_16x16x64_bf16 v[84:87], v[40:43], v[208:215], v9
    s_waitcnt lgkmcnt(1)
    v_mov_b32 v77, 0
    v_smfmac_f32_16x16x64_bf16 v[80:83], v[44:47], v[152:159], v9
    buffer_load_dwordx4 v2, s[4:7], s25 offen offset:2048 sc1 lds
    v_smfmac_f32_16x16x64_bf16 v[84:87], v[44:47], v[216:223], v9
    ds_read_b128 v[40:43], v6 offset:0
    v_smfmac_f32_16x16x64_bf16 v[80:83], v[48:51], v[160:167], v9
    buffer_load_dwordx4 v2, s[4:7], s25 offen offset:3072 sc1 lds
    v_smfmac_f32_16x16x64_bf16 v[84:87], v[48:51], v[224:231], v9
    s_waitcnt lgkmcnt(1)
    s_barrier
    v_smfmac_f32_16x16x64_bf16 v[80:83], v[52:55], v[168:175], v9
    ds_read_b64_tr_b16 v[88:89], v4 offset:0
    ds_read_b64_tr_b16 v[90:91], v4 offset:512
    v_smfmac_f32_16x16x64_bf16 v[84:87], v[52:55], v[232:239], v9
    ds_read_b64_tr_b16 v[92:93], v4 offset:1024
    ds_read_b64_tr_b16 v[94:95], v4 offset:1536
    v_smfmac_f32_16x16x64_bf16 v[80:83], v[56:59], v[176:183], v9
    ds_read_b64_tr_b16 v[96:97], v4 offset:2048
    ds_read_b64_tr_b16 v[98:99], v4 offset:2560
    v_smfmac_f32_16x16x64_bf16 v[84:87], v[56:59], v[240:247], v9
    ds_read_b64_tr_b16 v[100:101], v4 offset:3072
    ds_read_b64_tr_b16 v[102:103], v4 offset:3584
    v_smfmac_f32_16x16x64_bf16 v[80:83], v[60:63], v[184:191], v9
    ds_read_b128 v[44:47], v6 offset:1024
    v_smfmac_f32_16x16x64_bf16 v[84:87], v[60:63], v[248:255], v9
    s_waitcnt lgkmcnt(1)
    v_mfma_f32_16x16x32_bf16 v[16:19], v[32:35], v[88:91], 0
    ds_read_b128 v[48:51], v6 offset:16384
    v_add_f32 v80, v80, v81
    v_mfma_f32_16x16x32_bf16 v[20:23], v[24:27], v[88:91], 0
    ds_read_b128 v[52:55], v6 offset:17408
    v_add_f32 v82, v82, v83
    v_mfma_f32_16x16x32_bf16 v[24:27], v[88:91], v[88:91], 0
    ds_read_b128 v[56:59], v6 offset:2048
    v_cvt_pk_bf16_f32 v12, v80, v82
    v_mfma_f32_16x16x32_bf16 v[16:19], v[104:107], v[92:95], v[16:19]
    ds_read_b128 v[60:63], v6 offset:3072
    v_add_f32 v84, v84, v85
    v_mfma_f32_16x16x32_bf16 v[20:23], v[108:111], v[92:95], v[20:23]
    ds_read_b128 v[32:35], v6 offset:18432
    v_add_f32 v86, v86, v87
    v_mfma_f32_16x16x32_bf16 v[24:27], v[92:95], v[92:95], v[24:27]
    ds_read_b128 v[36:39], v6 offset:19456
    v_cvt_pk_bf16_f32 v14, v84, v86
    v_mfma_f32_16x16x32_bf16 v[16:19], v[112:115], v[96:99], v[16:19]
    s_mov_b32 m0, s50
    v_mfma_f32_16x16x32_bf16 v[16:19], v[120:123], v[100:103], v[16:19]
    ds_read_b128 v[104:107], v6 offset:4096
    v_mfma_f32_16x16x32_bf16 v[20:23], v[116:119], v[96:99], v[20:23]
    ds_read_b128 v[108:111], v6 offset:5120
    v_mfma_f32_16x16x32_bf16 v[20:23], v[124:127], v[100:103], v[20:23]
    ds_read_b128 v[112:115], v6 offset:20480
    v_max3_f32 v80, v16, v17, v18
    v_mfma_f32_16x16x32_bf16 v[24:27], v[96:99], v[96:99], v[24:27]
    ds_read_b128 v[116:119], v6 offset:21504
    s_add_u32 s25, s25, 16384
    v_mfma_f32_16x16x32_bf16 v[24:27], v[100:103], v[100:103], v[24:27]
    ds_read_b128 v[120:123], v6 offset:6144
    ds_read_b128 v[124:127], v6 offset:7168
    s_nop 1
    v_max3_f32 v82, v19, v20, v21
    v_max3_f32 v80, v80, v22, v23
    v_max_f32 v80, v80, v82
    s_nop 0
    v_max3_f32 v80, v80, v26, v27
    v_mov_b32 v82, v80
    ds_read_b128 v[96:99], v6 offset:22528
    ds_read_b128 v[100:103], v6 offset:23552
    v_permlane32_swap_b32 v80, v82
    v_max_f32 v80, v80, v82
    v_mov_b32 v82, v80
    s_nop 1
    v_permlane16_swap_b32 v80, v82
    v_max_f32 v80, v80, v82
    v_mul_f32 v80, s31, v80
    v_pk_fma_f32 v[26:27], v[26:27], s[58:59], v[80:81] op_sel_hi:[1,1,0] neg_lo:[0,0,1] neg_hi:[0,0,1]
    v_pk_fma_f32 v[16:17], v[16:17], s[58:59], v[80:81] op_sel_hi:[1,1,0] neg_lo:[0,0,1] neg_hi:[0,0,1]
    v_pk_fma_f32 v[18:19], v[18:19], s[58:59], v[80:81] op_sel_hi:[1,1,0] neg_lo:[0,0,1] neg_hi:[0,0,1]
    v_pk_fma_f32 v[20:21], v[20:21], s[58:59], v[80:81] op_sel_hi:[1,1,0] neg_lo:[0,0,1] neg_hi:[0,0,1]
    v_pk_fma_f32 v[22:23], v[22:23], s[58:59], v[80:81] op_sel_hi:[1,1,0] neg_lo:[0,0,1] neg_hi:[0,0,1]
    v_exp_f32 v26, v26
    v_exp_f32 v27, v27
    v_exp_f32 v16, v16
    v_cvt_pk_bf16_f32 v76, v26, v27
    v_exp_f32 v17, v17
    s_nop 0
    v_mfma_f32_16x16x16_bf16 v[84:87], v[28:29], v[76:77], 0
    v_exp_f32 v18, v18
    v_cvt_pk_bf16_f32 v68, v16, v17
    v_mfma_f32_16x16x16_bf16 v[88:91], v[12:13], v[76:77], 0
    v_exp_f32 v19, v19
    v_exp_f32 v20, v20
    v_mfma_f32_16x16x16_bf16 v[92:95], v[14:15], v[76:77], 0
    v_exp_f32 v21, v21
    v_cvt_pk_bf16_f32 v69, v18, v19
    v_exp_f32 v22, v22
    v_exp_f32 v23, v23
    v_cvt_pk_bf16_f32 v70, v20, v21
    v_cvt_pk_bf16_f32 v71, v22, v23
    ds_read_b128 v[24:27], v6 offset:8192
    s_nop 0
    v_mfma_f32_16x16x32_bf16 v[84:87], v[28:31], v[68:71], v[84:87]
    ds_read_b128 v[28:31], v6 offset:9216
    v_mfma_f32_16x16x32_bf16 v[88:91], v[64:67], v[68:71], v[88:91]
    v_mfma_f32_16x16x32_bf16 v[92:95], v[72:75], v[68:71], v[92:95]
    v_rcp_f32 v20, v84
    s_nop 2
    v_mul_f32 v88, v20, v88
    v_mul_f32 v89, v20, v89
    v_mul_f32 v90, v20, v90
    v_mul_f32 v91, v20, v91
    v_pk_mul_f32 v[92:93], v[92:93], v[20:21] op_sel_hi:[1,0]
    v_pk_mul_f32 v[94:95], v[94:95], v[20:21] op_sel_hi:[1,0]
    v_cvt_pk_bf16_f32 v16, v88, v89
    v_cvt_pk_bf16_f32 v17, v90, v91
    v_cvt_pk_bf16_f32 v18, v92, v93
    v_cvt_pk_bf16_f32 v19, v94, v95
    s_mov_b64 exec, s[46:47]
    ds_write_b128 v5, v[16:19]
    s_mov_b64 exec, -1
    v_mfma_f32_32x32x8_bf16 v[64:79], v[10:11], v[10:11], 0
    v_mfma_f32_32x32x8_bf16 v[80:95], v[10:11], v[10:11], 0
    s_waitcnt lgkmcnt(0)
    s_barrier
    ds_read_b128 v[16:19], v2 offset:28672
    ds_read_b128 v[20:23], v2 offset:29696
    v_mfma_f32_32x32x8_bf16 v[80:95], v[10:11], v[10:11], 0
    s_waitcnt lgkmcnt(1)
    v_smfmac_f32_16x16x64_bf16 v[64:67], v[16:19], v[40:47], v9
    s_waitcnt lgkmcnt(0)
    ds_read_b128 v[40:43], v6 offset:24576
    ds_read_b128 v[44:47], v6 offset:25600
    v_smfmac_f32_16x16x64_bf16 v[64:67], v[20:23], v[48:55], v9
    ds_read_b128 v[48:51], v6 offset:10240
    ds_read_b128 v[52:55], v6 offset:11264
    v_smfmac_f32_16x16x64_bf16 v[68:71], v[16:19], v[56:63], v9
    ds_read_b128 v[56:59], v6 offset:26624
    ds_read_b128 v[60:63], v6 offset:27648
    v_smfmac_f32_16x16x64_bf16 v[68:71], v[20:23], v[32:39], v9
    ds_read_b128 v[32:35], v6 offset:12288
    v_add_f32 v64, v64, v65
    v_smfmac_f32_16x16x64_bf16 v[72:75], v[16:19], v[104:111], v9
    ds_read_b128 v[36:39], v6 offset:13312
    v_add_f32 v66, v66, v67
    v_smfmac_f32_16x16x64_bf16 v[72:75], v[20:23], v[112:119], v9
    ds_read_b128 v[104:107], v6 offset:28672
    v_add_f32 v68, v68, v69
    v_add_f32 v70, v70, v71
    v_cvt_pk_bf16_f32 v64, v64, v68
    v_cvt_pk_bf16_f32 v65, v66, v70
    v_and_or_b32 v64, v64, -2, s28
    v_smfmac_f32_16x16x64_bf16 v[76:79], v[16:19], v[120:127], v9
    buffer_store_dwordx2 v[64:65], v7, s[4:7], s17 offen offset:0
    v_smfmac_f32_16x16x64_bf16 v[76:79], v[20:23], v[96:103], v9
    ds_read_b128 v[108:111], v6 offset:29696
    v_add_f32 v72, v72, v73
    v_smfmac_f32_16x16x64_bf16 v[80:83], v[16:19], v[24:31], v9
    ds_read_b128 v[112:115], v6 offset:14336
    s_waitcnt lgkmcnt(5)
    v_add_f32 v74, v74, v75
    v_smfmac_f32_16x16x64_bf16 v[80:83], v[20:23], v[40:47], v9
    ds_read_b128 v[116:119], v6 offset:15360
    v_add_f32 v76, v76, v77
    v_add_f32 v78, v78, v79
    v_cvt_pk_bf16_f32 v72, v72, v76
    v_cvt_pk_bf16_f32 v73, v74, v78
    v_and_or_b32 v72, v72, -2, s28
    v_smfmac_f32_16x16x64_bf16 v[84:87], v[16:19], v[48:55], v9
    buffer_store_dwordx2 v[72:73], v7, s[4:7], s17 offen offset:2048
    v_smfmac_f32_16x16x64_bf16 v[84:87], v[20:23], v[56:63], v9
    ds_read_b128 v[120:123], v6 offset:30720
    ds_read_b128 v[124:127], v6 offset:31744
    s_waitcnt lgkmcnt(4)
    v_add_f32 v80, v80, v81
    v_smfmac_f32_16x16x64_bf16 v[88:91], v[16:19], v[32:39], v9
    v_add_f32 v82, v82, v83
    v_smfmac_f32_16x16x64_bf16 v[88:91], v[20:23], v[104:111], v9
    s_waitcnt lgkmcnt(2)
    v_add_f32 v84, v84, v85
    v_add_f32 v86, v86, v87
    v_cvt_pk_bf16_f32 v80, v80, v84
    v_cvt_pk_bf16_f32 v81, v82, v86
    v_and_or_b32 v80, v80, -2, s28
    v_smfmac_f32_16x16x64_bf16 v[92:95], v[16:19], v[112:119], v9
    s_waitcnt lgkmcnt(0)
    buffer_store_dwordx2 v[80:81], v7, s[4:7], s18 offen offset:0
    v_smfmac_f32_16x16x64_bf16 v[92:95], v[20:23], v[120:127], v9
    ds_read_b128 v[96:99], v2 offset:30720
    v_add_f32 v88, v88, v89
    v_add_f32 v90, v90, v91
    v_mov_b32 v117, -1
    s_mov_b32 s30, 0
    s_nop 2
    v_add_f32 v92, v92, v93
    v_add_f32 v94, v94, v95
    v_cvt_pk_bf16_f32 v88, v88, v92
    v_cvt_pk_bf16_f32 v89, v90, v94
    v_and_or_b32 v88, v88, -2, s28
    buffer_store_dwordx2 v[88:89], v7, s[4:7], s18 offen offset:2048
    v_mfma_f32_32x32x8_bf16 v[64:79], v[10:11], v[10:11], 0
    v_xor_b32 v28, 2048, v1
    v_xor_b32 v29, 4096, v1
    v_xor_b32 v30, 6144, v1
    v_mfma_f32_32x32x8_bf16 v[80:95], v[10:11], v[10:11], 0
    s_cmp_eq_u32 s15, 0
    s_cbranch_scc1 RF_re
    s_nop 3
    s_cmp_eq_u32 s15, 1
    s_cbranch_scc1 RF_re
    s_nop 7
    s_nop 7
    s_cmp_eq_u32 s15, 2
    s_cbranch_scc1 RF_re
    s_nop 7
    s_nop 7
RF_re:
    buffer_load_dwordx4 v[104:107], v2, s[4:7], s19 offen offset:0 sc1
    buffer_load_dwordx4 v[108:111], v2, s[4:7], s19 offen offset:1024 sc1
    v_mfma_f32_32x32x8_bf16 v[80:95], v[10:11], v[10:11], 0
    v_mfma_f32_32x32x8_bf16 v[80:95], v[10:11], v[10:11], 0
    v_mfma_f32_32x32x8_bf16 v[80:95], v[10:11], v[10:11], 0
    v_mfma_f32_32x32x8_bf16 v[80:95], v[10:11], v[10:11], 0
    buffer_load_dwordx4 v[112:115], v2, s[4:7], s19 offen offset:0 sc1
    buffer_load_dwordx4 v[120:123], v2, s[4:7], s19 offen offset:1024 sc1
    s_waitcnt lgkmcnt(0)
    v_mfma_f32_32x32x8_bf16 v[80:95], v[10:11], v[10:11], 0
    v_mfma_f32_32x32x8_bf16 v[80:95], v[10:11], v[10:11], 0
RF_rcA:
    s_waitcnt vmcnt(3)
    v_mfma_f32_16x16x32_bf16 v[100:103], v[96:99], v[104:107], 0
    v_and_b32 v118, 1, v104
    v_cmp_ne_u32 s[44:45], s28, v118
    s_waitcnt vmcnt(2)
    v_mfma_f32_16x16x32_bf16 v[16:19], v[96:99], v[108:111], v[100:103]
    v_and_b32 v119, 1, v108
    s_nop 2
    v_cmp_ne_u32 vcc, s28, v119
    s_nop 2
    v_add_f32_dpp v16, v16, v16 row_ror:8 row_mask:0xf bank_mask:0xf
    v_add_f32_dpp v17, v17, v17 row_ror:8 row_mask:0xf bank_mask:0xf
    s_nop 0
    v_add_f32_dpp v16, v16, v16 row_ror:4 row_mask:0xf bank_mask:0xf
    v_add_f32_dpp v17, v17, v17 row_ror:4 row_mask:0xf bank_mask:0xf
    s_or_b64 vcc, vcc, s[44:45]
    v_cvt_pk_bf16_f32 v116, v16, v17
    s_cbranch_vccnz RF_rfA
RF_rok:
    buffer_store_dword v116, v8, s[4:7], s23 offen
    buffer_store_dword v117, v8, s[4:7], s24 offen
    s_mov_b32 s24, s23
    s_sub_u32 s22, s23, s52
    s_cmp_eq_u32 s15, 3
    s_cbranch_scc1 RF_gl
    s_nop 7
    s_nop 7
    s_cmp_eq_u32 s15, 2
    s_cbranch_scc1 RF_gl
    s_nop 7
    s_nop 3
    s_cmp_eq_u32 s15, 1
    s_cbranch_scc1 RF_gl
    s_nop 3
RF_gl:
    s_nop 7
    s_nop 7
    buffer_load_dwordx4 v[32:35], v1, s[4:7], s22 offen offset:0 sc1
    s_add_u32 s23, s23, 8192
    s_cmp_ge_u32 s22, 0x6c84000
    s_cselect_b32 s48, 24576, 0
    s_sub_u32 s23, s23, s48
    s_add_u32 s16, s16, 1
    s_xor_b32 s28, s28, 1
    v_readlane_b32 s55, v0, 0
    v_readlane_b32 s48, v0, 2
    s_add_u32 s49, s16, 2
    s_min_u32 s49, s49, 64
    s_min_u32 s55, s55, s48
    s_cmp_ge_u32 s55, s49
    s_cbranch_scc1 RF_kvw_8_ok
    s_mov_b32 s30, 0
RF_kvw_8:
    buffer_load_dword v119, v8, s[4:7], s56 offen sc1
    s_waitcnt vmcnt(0)
    v_readlane_b32 s55, v119, 0
    v_readlane_b32 s48, v119, 2
    s_nop 1
    s_min_u32 s55, s55, s48
    s_cmp_ge_u32 s55, s49
    s_cbranch_scc1 RF_kvw_8_ok
    s_sleep 2
    s_add_u32 s30, s30, 1
    s_cmp_lt_u32 s30, s29
    s_cbranch_scc1 RF_kvw_8
    s_mov_b32 s29, 1
RF_kvw_8_ok:
    s_mov_b32 s30, 0
    s_nop 7
    s_nop 7
    s_nop 7
    buffer_load_dwordx4 v[32:35], v1, s[4:7], s22 offen offset:0 sc1
    s_branch RF_gA
RF_rfA:
    buffer_load_dwordx4 v[104:107], v2, s[4:7], s19 offen offset:0 sc1
    buffer_load_dwordx4 v[108:111], v2, s[4:7], s19 offen offset:1024 sc1
    s_add_u32 s30, s30, 1
RF_rcB:
    s_waitcnt vmcnt(3)
    v_mfma_f32_16x16x32_bf16 v[100:103], v[96:99], v[112:115], 0
    v_and_b32 v118, 1, v112
    v_cmp_ne_u32 s[44:45], s28, v118
    s_waitcnt vmcnt(2)
    v_mfma_f32_16x16x32_bf16 v[16:19], v[96:99], v[120:123], v[100:103]
    v_and_b32 v119, 1, v120
    s_nop 2
    v_cmp_ne_u32 vcc, s28, v119
    s_nop 2
    v_add_f32_dpp v16, v16, v16 row_ror:8 row_mask:0xf bank_mask:0xf
    v_add_f32_dpp v17, v17, v17 row_ror:8 row_mask:0xf bank_mask:0xf
    s_nop 0
    v_add_f32_dpp v16, v16, v16 row_ror:4 row_mask:0xf bank_mask:0xf
    v_add_f32_dpp v17, v17, v17 row_ror:4 row_mask:0xf bank_mask:0xf
    s_or_b64 vcc, vcc, s[44:45]
    v_cvt_pk_bf16_f32 v116, v16, v17
    s_cbranch_vccnz RF_rfB
    s_branch RF_rok
RF_rfB:
    buffer_load_dwordx4 v[112:115], v2, s[4:7], s19 offen offset:0 sc1
    buffer_load_dwordx4 v[120:123], v2, s[4:7], s19 offen offset:1024 sc1
    s_add_u32 s30, s30, 1
    s_cmp_lt_u32 s30, s29
    s_cbranch_scc1 RF_rcA
    s_mov_b32 s29, 1
    s_branch RF_rok
RF_last:
    buffer_store_dwordx4 v[12:15], v2, s[4:7], s26 offen sc1
    s_add_u32 s27, s27, 4096
    s_mov_b32 s26, s27
    v_smfmac_f32_16x16x64_bf16 v[76:79], v[36:39], a[200:207], v9
    v_smfmac_f32_16x16x64_bf16 v[80:83], v[36:39], v[136:143], v9
    v_smfmac_f32_16x16x64_bf16 v[84:87], v[36:39], v[200:207], v9
    v_smfmac_f32_16x16x64_bf16 v[80:83], v[40:43], v[144:151], v9
    v_smfmac_f32_16x16x64_bf16 v[84:87], v[40:43], v[208:215], v9
    v_smfmac_f32_16x16x64_bf16 v[80:83], v[48:51], v[160:167], v9
    v_smfmac_f32_16x16x64_bf16 v[84:87], v[48:51], v[224:231], v9
    v_smfmac_f32_16x16x64_bf16 v[80:83], v[56:59], v[176:183], v9
    v_smfmac_f32_16x16x64_bf16 v[84:87], v[56:59], v[240:247], v9
    s_waitcnt lgkmcnt(0)
    v_smfmac_f32_16x16x64_bf16 v[72:75], v[44:47], a[152:159], v9
    v_smfmac_f32_16x16x64_bf16 v[72:75], v[52:55], a[168:175], v9
    v_smfmac_f32_16x16x64_bf16 v[72:75], v[60:63], a[184:191], v9
    v_smfmac_f32_16x16x64_bf16 v[76:79], v[44:47], a[216:223], v9
    v_smfmac_f32_16x16x64_bf16 v[76:79], v[52:55], a[232:239], v9
    v_smfmac_f32_16x16x64_bf16 v[76:79], v[60:63], a[248:255], v9
    v_smfmac_f32_16x16x64_bf16 v[80:83], v[44:47], v[152:159], v9
    v_smfmac_f32_16x16x64_bf16 v[84:87], v[44:47], v[216:223], v9
    v_smfmac_f32_16x16x64_bf16 v[80:83], v[52:55], v[168:175], v9
    v_smfmac_f32_16x16x64_bf16 v[84:87], v[52:55], v[232:239], v9
    v_smfmac_f32_16x16x64_bf16 v[80:83], v[60:63], v[184:191], v9
    v_smfmac_f32_16x16x64_bf16 v[84:87], v[60:63], v[248:255], v9
    v_add_f32 v72, v72, v73
    v_add_f32 v74, v74, v75
    v_cvt_pk_bf16_f32 v13, v72, v74
    v_add_f32 v76, v76, v77
    v_add_f32 v78, v78, v79
    v_cvt_pk_bf16_f32 v15, v76, v78
    s_nop 1
    v_add_f32 v80, v80, v81
    v_add_f32 v82, v82, v83
    v_cvt_pk_bf16_f32 v12, v80, v82
    v_add_f32 v84, v84, v85
    v_add_f32 v86, v86, v87
    v_cvt_pk_bf16_f32 v14, v84, v86
RF_end:
    buffer_store_dwordx4 v[12:15], v2, s[4:7], s26 offen sc1
    s_branch L_done
R_slow:
    s_bfe_u32 s50, s15, 0x20000
    s_lshl_b32 s50, s50, 11
    s_add_u32 s50, s50, 0x2000
    s_bfe_u32 s51, s15, 0x20000
    s_lshl_b32 s51, s51, 11
    s_add_u32 s51, s51, 0x3800
    s_mov_b32 m0, s50
    s_nop 0
    buffer_load_dwordx4 v2, s[4:7], s25 offen offset:0 sc1 lds
    buffer_load_dwordx4 v2, s[4:7], s25 offen offset:1024 sc1 lds
    s_mov_b32 m0, s51
    s_nop 0
    buffer_load_dwordx4 v2, s[4:7], s25 offen offset:2048 sc1 lds
    buffer_load_dwordx4 v2, s[4:7], s25 offen offset:3072 sc1 lds
    s_add_u32 s25, s25, 16384
    s_mov_b32 m0, s50
    s_sub_u32 s27, s27, 4096
    s_add_u32 s48, s27, 266240
    s_mov_b32 s26, s48
    v_mfma_f32_32x32x8_bf16 v[64:79], v[10:11], v[10:11], 0
    v_mfma_f32_32x32x8_bf16 v[80:95], v[10:11], v[10:11], 0
    v_xor_b32 v28, 2048, v1
    v_xor_b32 v29, 4096, v1
    v_xor_b32 v30, 6144, v1
    s_mov_b32 s30, 0
    s_add_u32 s48, s22, 8192
    buffer_load_dwordx4 v[96:99], v1, s[4:7], s48 offen offset:0 sc1
    buffer_load_dwordx4 v[96:99], v1, s[4:7], s48 offen offset:1024 sc1
    s_add_u32 s48, s22, 16384
    buffer_load_dwordx4 v[96:99], v1, s[4:7], s48 offen offset:0 sc1
    buffer_load_dwordx4 v[96:99], v1, s[4:7], s48 offen offset:1024 sc1
    buffer_load_dwordx4 v[96:99], v2, s[4:7], s19 offen offset:0 sc1
    buffer_load_dwordx4 v[96:99], v2, s[4:7], s19 offen offset:1024 sc1
    buffer_load_dwordx4 v[36:39], v1, s[4:7], s22 offen offset:1024 sc1
    buffer_load_dwordx4 v[32:35], v1, s[4:7], s22 offen offset:0 sc1
    buffer_load_dwordx4 v[32:35], v1, s[4:7], s22 offen offset:0 sc1
    s_branch RS_gA
RS_gf0:
    s_waitcnt vmcnt(0)
RS_gr0:
    v_max3_u32 v16, v32, v33, v34
    v_max_u32 v16, v16, v35
    v_cmp_eq_u32 vcc, -1, v16
    s_add_u32 s30, s30, 1
    s_cbranch_vccz RS_gx0
    buffer_load_dwordx4 v[32:35], v1, s[4:7], s22 offen offset:0 sc1
    s_cmp_lt_u32 s30, s29
    s_waitcnt vmcnt(0)
    s_cbranch_scc1 RS_gr0
    s_mov_b32 s29, 1
RS_gx0:
    ds_write_b128 v1, v[32:35] offset:0
    v_mfma_f32_16x16x16_bf16 v[64:67], v[10:11], v[10:11], 0
    s_nop 5
    v_smfmac_f32_16x16x64_bf16 v[64:67], v[32:35], a[0:7], v9
    s_branch RS_gok0
RS_gf1:
    s_waitcnt vmcnt(0)
RS_gr1:
    v_max3_u32 v16, v36, v37, v38
    v_max_u32 v16, v16, v39
    v_cmp_eq_u32 vcc, -1, v16
    s_add_u32 s30, s30, 1
    s_cbranch_vccz RS_gx1
    buffer_load_dwordx4 v[36:39], v1, s[4:7], s22 offen offset:1024 sc1
    s_cmp_lt_u32 s30, s29
    s_waitcnt vmcnt(0)
    s_cbranch_scc1 RS_gr1
    s_mov_b32 s29, 1
RS_gx1:
    ds_write_b128 v1, v[36:39] offset:1024
    s_branch RS_gok1
.p2align 6
RS_gA:
    s_waitcnt vmcnt(1)
    v_max3_u32 v16, v32, v33, v34
    v_max_u32 v16, v16, v35
    ds_write_b128 v1, v[32:35] offset:0
    v_cmp_eq_u32 vcc, -1, v16
    v_smfmac_f32_16x16x64_bf16 v[64:67], v[32:35], a[0:7], v9
    s_cbranch_vccnz RS_gf0
RS_gok0:
    v_smfmac_f32_16x16x64_bf16 v[72:75], v[32:35], a[128:135], v9
    buffer_load_dwordx4 v[36:39], v1, s[4:7], s22 offen offset:1024 sc1
    v_smfmac_f32_16x16x64_bf16 v[68:71], v[32:35], a[64:71], v9
    v_smfmac_f32_16x16x64_bf16 v[76:79], v[32:35], a[192:199], v9
    v_smfmac_f32_16x16x64_bf16 v[80:83], v[32:35], v[128:135], v9
    s_waitcnt lgkmcnt(0)
    s_barrier
    ds_read_b128 v[40:43], v28 offset:0
    v_smfmac_f32_16x16x64_bf16 v[84:87], v[32:35], v[192:199], v9
    ds_read_b128 v[48:51], v29 offset:0
    ds_read_b128 v[56:59], v30 offset:0
    v_mfma_f32_16x16x16_bf16 v[20:23], v[10:11], v[10:11], 0
    ds_read_b128 v[104:107], v2 offset:9216
    ds_read_b128 v[108:111], v2 offset:13312
    v_mfma_f32_16x16x16_bf16 v[20:23], v[10:11], v[10:11], 0
    s_waitcnt lgkmcnt(4)
    v_smfmac_f32_16x16x64_bf16 v[64:67], v[40:43], a[16:23], v9
    ds_read_b128 v[112:115], v2 offset:10240
    v_smfmac_f32_16x16x64_bf16 v[72:75], v[40:43], a[144:151], v9
    ds_read_b128 v[116:119], v2 offset:14336
    v_smfmac_f32_16x16x64_bf16 v[68:71], v[40:43], a[80:87], v9
    ds_read_b128 v[120:123], v2 offset:11264
    v_smfmac_f32_16x16x64_bf16 v[76:79], v[40:43], a[208:215], v9
    ds_read_b128 v[124:127], v2 offset:15360
    s_waitcnt lgkmcnt(6)
    v_smfmac_f32_16x16x64_bf16 v[64:67], v[48:51], a[32:39], v9
    ds_read_b128 v[24:27], v2 offset:12288
    v_smfmac_f32_16x16x64_bf16 v[72:75], v[48:51], a[160:167], v9
    v_smfmac_f32_16x16x64_bf16 v[68:71], v[48:51], a[96:103], v9
    s_waitcnt vmcnt(0)
    ds_write_b128 v1, v[36:39] offset:1024
    v_smfmac_f32_16x16x64_bf16 v[76:79], v[48:51], a[224:231], v9
    v_cmp_eq_u32 vcc, -1, v36
    v_smfmac_f32_16x16x64_bf16 v[64:67], v[56:59], a[48:55], v9
    s_cbranch_vccnz RS_gf1
RS_gok1:
    ds_read_b128 v[32:35], v2 offset:8192
    v_smfmac_f32_16x16x64_bf16 v[72:75], v[56:59], a[176:183], v9
    s_cmp_eq_u32 s16, 63
    v_smfmac_f32_16x16x64_bf16 v[68:71], v[56:59], a[112:119], v9
    v_smfmac_f32_16x16x64_bf16 v[76:79], v[56:59], a[240:247], v9
    s_waitcnt lgkmcnt(0)
    s_barrier
    v_smfmac_f32_16x16x64_bf16 v[64:67], v[36:39], a[8:15], v9
    ds_read_b128 v[44:47], v28 offset:1024
    ds_read_b128 v[52:55], v29 offset:1024
    v_smfmac_f32_16x16x64_bf16 v[72:75], v[36:39], a[136:143], v9
    ds_read_b128 v[60:63], v30 offset:1024
    s_cbranch_scc1 RS_last
    v_smfmac_f32_16x16x64_bf16 v[68:71], v[36:39], a[72:79], v9
    buffer_load_dwordx4 v2, s[4:7], s25 offen offset:0 sc1 lds
    v_smfmac_f32_16x16x64_bf16 v[76:79], v[36:39], a[200:207], v9
    v_mov_b32 v28, 0x3f803f80
    s_waitcnt lgkmcnt(2)
    v_smfmac_f32_16x16x64_bf16 v[64:67], v[44:47], a[24:31], v9
    v_mov_b32 v31, 0x3f803f80
    s_waitcnt lgkmcnt(0)
    v_mov_b32 v29, 0x3f803f80
    v_smfmac_f32_16x16x64_bf16 v[64:67], v[52:55], a[40:47], v9
    buffer_load_dwordx4 v2, s[4:7], s25 offen offset:1024 sc1 lds
    v_smfmac_f32_16x16x64_bf16 v[64:67], v[60:63], a[56:63], v9
    s_mov_b32 m0, s51
    v_mov_b32 v30, 0x3f803f80
    v_smfmac_f32_16x16x64_bf16 v[72:75], v[44:47], a[152:159], v9
    buffer_store_dwordx4 v[12:15], v2, s[4:7], s26 offen sc1
    v_smfmac_f32_16x16x64_bf16 v[72:75], v[52:55], a[168:175], v9
    s_add_u32 s27, s27, 4096
    v_add_f32 v64, v64, v65
    v_smfmac_f32_16x16x64_bf16 v[72:75], v[60:63], a[184:191], v9
    s_mov_b32 s26, s27
    v_add_f32 v66, v66, v67
    v_smfmac_f32_16x16x64_bf16 v[68:71], v[44:47], a[88:95], v9
    v_cvt_pk_bf16_f32 v12, v64, v66
    v_smfmac_f32_16x16x64_bf16 v[68:71], v[52:55], a[104:111], v9
    ds_read_b128 v[64:67], v1 offset:16384
    v_add_f32 v72, v72, v73
    v_smfmac_f32_16x16x64_bf16 v[68:71], v[60:63], a[120:127], v9
    buffer_load_dword v0, v8, s[4:7], s56 offen sc1
    v_add_f32 v74, v74, v75
    v_smfmac_f32_16x16x64_bf16 v[76:79], v[44:47], a[216:223], v9
    v_cvt_pk_bf16_f32 v13, v72, v74
    v_smfmac_f32_16x16x64_bf16 v[76:79], v[52:55], a[232:239], v9
    ds_read_b128 v[72:75], v1 offset:17408
    v_add_f32 v68, v68, v69
    v_smfmac_f32_16x16x64_bf16 v[76:79], v[60:63], a[248:255], v9
    v_add_f32 v70, v70, v71
    v_smfmac_f32_16x16x64_bf16 v[80:83], v[36:39], v[136:143], v9
    v_cvt_pk_bf16_f32 v14, v68, v70
    v_smfmac_f32_16x16x64_bf16 v[84:87], v[36:39], v[200:207], v9
    v_add_f32 v76, v76, v77
    v_add_f32 v78, v78, v79
    v_cvt_pk_bf16_f32 v15, v76, v78
    v_smfmac_f32_16x16x64_bf16 v[80:83], v[40:43], v[144:151], v9
    ds_write2st64_b64 v3, v[12:13], v[14:15] offset1:1
    v_smfmac_f32_16x16x64_bf16 v[84:87], v[40:43], v[208:215], v9
    s_waitcnt lgkmcnt(1)
    v_mov_b32 v77, 0
    v_smfmac_f32_16x16x64_bf16 v[80:83], v[44:47], v[152:159], v9
    buffer_load_dwordx4 v2, s[4:7], s25 offen offset:2048 sc1 lds
    v_smfmac_f32_16x16x64_bf16 v[84:87], v[44:47], v[216:223], v9
    ds_read_b128 v[40:43], v6 offset:0
    v_smfmac_f32_16x16x64_bf16 v[80:83], v[48:51], v[160:167], v9
    buffer_load_dwordx4 v2, s[4:7], s25 offen offset:3072 sc1 lds
    v_smfmac_f32_16x16x64_bf16 v[84:87], v[48:51], v[224:231], v9
    s_waitcnt lgkmcnt(1)
    s_barrier
    v_smfmac_f32_16x16x64_bf16 v[80:83], v[52:55], v[168:175], v9
    ds_read_b64_tr_b16 v[88:89], v4 offset:0
    ds_read_b64_tr_b16 v[90:91], v4 offset:512
    v_smfmac_f32_16x16x64_bf16 v[84:87], v[52:55], v[232:239], v9
    ds_read_b64_tr_b16 v[92:93], v4 offset:1024
    ds_read_b64_tr_b16 v[94:95], v4 offset:1536
    v_smfmac_f32_16x16x64_bf16 v[80:83], v[56:59], v[176:183], v9
    ds_read_b64_tr_b16 v[96:97], v4 offset:2048
    ds_read_b64_tr_b16 v[98:99], v4 offset:2560
    v_smfmac_f32_16x16x64_bf16 v[84:87], v[56:59], v[240:247], v9
    ds_read_b64_tr_b16 v[100:101], v4 offset:3072
    ds_read_b64_tr_b16 v[102:103], v4 offset:3584
    v_smfmac_f32_16x16x64_bf16 v[80:83], v[60:63], v[184:191], v9
    ds_read_b128 v[44:47], v6 offset:1024
    v_smfmac_f32_16x16x64_bf16 v[84:87], v[60:63], v[248:255], v9
    s_waitcnt lgkmcnt(1)
    v_mfma_f32_16x16x32_bf16 v[16:19], v[32:35], v[88:91], 0
    ds_read_b128 v[48:51], v6 offset:16384
    v_add_f32 v80, v80, v81
    v_mfma_f32_16x16x32_bf16 v[20:23], v[24:27], v[88:91], 0
    ds_read_b128 v[52:55], v6 offset:17408
    v_add_f32 v82, v82, v83
    v_mfma_f32_16x16x32_bf16 v[24:27], v[88:91], v[88:91], 0
    ds_read_b128 v[56:59], v6 offset:2048
    v_cvt_pk_bf16_f32 v12, v80, v82
    v_mfma_f32_16x16x32_bf16 v[16:19], v[104:107], v[92:95], v[16:19]
    ds_read_b128 v[60:63], v6 offset:3072
    v_add_f32 v84, v84, v85
    v_mfma_f32_16x16x32_bf16 v[20:23], v[108:111], v[92:95], v[20:23]
    ds_read_b128 v[32:35], v6 offset:18432
    v_add_f32 v86, v86, v87
    v_mfma_f32_16x16x32_bf16 v[24:27], v[92:95], v[92:95], v[24:27]
    ds_read_b128 v[36:39], v6 offset:19456
    v_cvt_pk_bf16_f32 v14, v84, v86
    v_mfma_f32_16x16x32_bf16 v[16:19], v[112:115], v[96:99], v[16:19]
    s_mov_b32 m0, s50
    v_mfma_f32_16x16x32_bf16 v[16:19], v[120:123], v[100:103], v[16:19]
    ds_read_b128 v[104:107], v6 offset:4096
    v_mfma_f32_16x16x32_bf16 v[20:23], v[116:119], v[96:99], v[20:23]
    ds_read_b128 v[108:111], v6 offset:5120
    v_mfma_f32_16x16x32_bf16 v[20:23], v[124:127], v[100:103], v[20:23]
    ds_read_b128 v[112:115], v6 offset:20480
    v_max3_f32 v80, v16, v17, v18
    v_mfma_f32_16x16x32_bf16 v[24:27], v[96:99], v[96:99], v[24:27]
    ds_read_b128 v[116:119], v6 offset:21504
    s_add_u32 s25, s25, 16384
    v_mfma_f32_16x16x32_bf16 v[24:27], v[100:103], v[100:103], v[24:27]
    ds_read_b128 v[120:123], v6 offset:6144
    ds_read_b128 v[124:127], v6 offset:7168
    s_nop 1
    v_max3_f32 v82, v19, v20, v21
    v_max3_f32 v80, v80, v22, v23
    v_max_f32 v80, v80, v82
    s_nop 0
    v_max3_f32 v80, v80, v26, v27
    v_mov_b32 v82, v80
    ds_read_b128 v[96:99], v6 offset:22528
    ds_read_b128 v[100:103], v6 offset:23552
    v_permlane32_swap_b32 v80, v82
    v_max_f32 v80, v80, v82
    v_mov_b32 v82, v80
    s_nop 1
    v_permlane16_swap_b32 v80, v82
    v_max_f32 v80, v80, v82
    v_mul_f32 v80, s31, v80
    v_pk_fma_f32 v[26:27], v[26:27], s[58:59], v[80:81] op_sel_hi:[1,1,0] neg_lo:[0,0,1] neg_hi:[0,0,1]
    v_pk_fma_f32 v[16:17], v[16:17], s[58:59], v[80:81] op_sel_hi:[1,1,0] neg_lo:[0,0,1] neg_hi:[0,0,1]
    v_pk_fma_f32 v[18:19], v[18:19], s[58:59], v[80:81] op_sel_hi:[1,1,0] neg_lo:[0,0,1] neg_hi:[0,0,1]
    v_pk_fma_f32 v[20:21], v[20:21], s[58:59], v[80:81] op_sel_hi:[1,1,0] neg_lo:[0,0,1] neg_hi:[0,0,1]
    v_pk_fma_f32 v[22:23], v[22:23], s[58:59], v[80:81] op_sel_hi:[1,1,0] neg_lo:[0,0,1] neg_hi:[0,0,1]
    v_exp_f32 v26, v26
    v_exp_f32 v27, v27
    v_exp_f32 v16, v16
    v_cvt_pk_bf16_f32 v76, v26, v27
    v_exp_f32 v17, v17
    s_nop 0
    v_mfma_f32_16x16x16_bf16 v[84:87], v[28:29], v[76:77], 0
    v_exp_f32 v18, v18
    v_cvt_pk_bf16_f32 v68, v16, v17
    v_mfma_f32_16x16x16_bf16 v[88:91], v[12:13], v[76:77], 0
    v_exp_f32 v19, v19
    v_exp_f32 v20, v20
    v_mfma_f32_16x16x16_bf16 v[92:95], v[14:15], v[76:77], 0
    v_exp_f32 v21, v21
    v_cvt_pk_bf16_f32 v69, v18, v19
    v_exp_f32 v22, v22
    v_exp_f32 v23, v23
    v_cvt_pk_bf16_f32 v70, v20, v21
    v_cvt_pk_bf16_f32 v71, v22, v23
    ds_read_b128 v[24:27], v6 offset:8192
    s_nop 0
    v_mfma_f32_16x16x32_bf16 v[84:87], v[28:31], v[68:71], v[84:87]
    ds_read_b128 v[28:31], v6 offset:9216
    v_mfma_f32_16x16x32_bf16 v[88:91], v[64:67], v[68:71], v[88:91]
    v_mfma_f32_16x16x32_bf16 v[92:95], v[72:75], v[68:71], v[92:95]
    v_rcp_f32 v20, v84
    s_nop 2
    v_mul_f32 v88, v20, v88
    v_mul_f32 v89, v20, v89
    v_mul_f32 v90, v20, v90
    v_mul_f32 v91, v20, v91
    v_pk_mul_f32 v[92:93], v[92:93], v[20:21] op_sel_hi:[1,0]
    v_pk_mul_f32 v[94:95], v[94:95], v[20:21] op_sel_hi:[1,0]
    v_cvt_pk_bf16_f32 v16, v88, v89
    v_cvt_pk_bf16_f32 v17, v90, v91
    v_cvt_pk_bf16_f32 v18, v92, v93
    v_cvt_pk_bf16_f32 v19, v94, v95
    s_mov_b64 exec, s[46:47]
    ds_write_b128 v5, v[16:19]
    s_mov_b64 exec, -1
    v_mfma_f32_32x32x8_bf16 v[64:79], v[10:11], v[10:11], 0
    v_mfma_f32_32x32x8_bf16 v[80:95], v[10:11], v[10:11], 0
    s_waitcnt lgkmcnt(0)
    s_barrier
    ds_read_b128 v[16:19], v2 offset:28672
    ds_read_b128 v[20:23], v2 offset:29696
    v_mfma_f32_32x32x8_bf16 v[80:95], v[10:11], v[10:11], 0
    s_waitcnt lgkmcnt(1)
    v_smfmac_f32_16x16x64_bf16 v[64:67], v[16:19], v[40:47], v9
    s_waitcnt lgkmcnt(0)
    ds_read_b128 v[40:43], v6 offset:24576
    ds_read_b128 v[44:47], v6 offset:25600
    v_smfmac_f32_16x16x64_bf16 v[64:67], v[20:23], v[48:55], v9
    ds_read_b128 v[48:51], v6 offset:10240
    ds_read_b128 v[52:55], v6 offset:11264
    v_smfmac_f32_16x16x64_bf16 v[68:71], v[16:19], v[56:63], v9
    ds_read_b128 v[56:59], v6 offset:26624
    ds_read_b128 v[60:63], v6 offset:27648
    v_smfmac_f32_16x16x64_bf16 v[68:71], v[20:23], v[32:39], v9
    ds_read_b128 v[32:35], v6 offset:12288
    v_add_f32 v64, v64, v65
    v_smfmac_f32_16x16x64_bf16 v[72:75], v[16:19], v[104:111], v9
    ds_read_b128 v[36:39], v6 offset:13312
    v_add_f32 v66, v66, v67
    v_smfmac_f32_16x16x64_bf16 v[72:75], v[20:23], v[112:119], v9
    ds_read_b128 v[104:107], v6 offset:28672
    v_add_f32 v68, v68, v69
    v_add_f32 v70, v70, v71
    v_cvt_pk_bf16_f32 v64, v64, v68
    v_cvt_pk_bf16_f32 v65, v66, v70
    v_and_or_b32 v64, v64, -2, s28
    v_smfmac_f32_16x16x64_bf16 v[76:79], v[16:19], v[120:127], v9
    buffer_store_dwordx2 v[64:65], v7, s[4:7], s17 offen offset:0 sc1
    v_smfmac_f32_16x16x64_bf16 v[76:79], v[20:23], v[96:103], v9
    ds_read_b128 v[108:111], v6 offset:29696
    v_add_f32 v72, v72, v73
    v_smfmac_f32_16x16x64_bf16 v[80:83], v[16:19], v[24:31], v9
    ds_read_b128 v[112:115], v6 offset:14336
    s_waitcnt lgkmcnt(5)
    v_add_f32 v74, v74, v75
    v_smfmac_f32_16x16x64_bf16 v[80:83], v[20:23], v[40:47], v9
    ds_read_b128 v[116:119], v6 offset:15360
    v_add_f32 v76, v76, v77
    v_add_f32 v78, v78, v79
    v_cvt_pk_bf16_f32 v72, v72, v76
    v_cvt_pk_bf16_f32 v73, v74, v78
    v_and_or_b32 v72, v72, -2, s28
    v_smfmac_f32_16x16x64_bf16 v[84:87], v[16:19], v[48:55], v9
    buffer_store_dwordx2 v[72:73], v7, s[4:7], s17 offen offset:2048 sc1
    v_smfmac_f32_16x16x64_bf16 v[84:87], v[20:23], v[56:63], v9
    ds_read_b128 v[120:123], v6 offset:30720
    ds_read_b128 v[124:127], v6 offset:31744
    s_waitcnt lgkmcnt(4)
    v_add_f32 v80, v80, v81
    v_smfmac_f32_16x16x64_bf16 v[88:91], v[16:19], v[32:39], v9
    v_add_f32 v82, v82, v83
    v_smfmac_f32_16x16x64_bf16 v[88:91], v[20:23], v[104:111], v9
    s_waitcnt lgkmcnt(2)
    v_add_f32 v84, v84, v85
    v_add_f32 v86, v86, v87
    v_cvt_pk_bf16_f32 v80, v80, v84
    v_cvt_pk_bf16_f32 v81, v82, v86
    v_and_or_b32 v80, v80, -2, s28
    v_smfmac_f32_16x16x64_bf16 v[92:95], v[16:19], v[112:119], v9
    s_waitcnt lgkmcnt(0)
    buffer_store_dwordx2 v[80:81], v7, s[4:7], s18 offen offset:0 sc1
    v_smfmac_f32_16x16x64_bf16 v[92:95], v[20:23], v[120:127], v9
    ds_read_b128 v[96:99], v2 offset:30720
    v_add_f32 v88, v88, v89
    v_add_f32 v90, v90, v91
    v_mov_b32 v117, -1
    s_mov_b32 s30, 0
    s_nop 2
    v_add_f32 v92, v92, v93
    v_add_f32 v94, v94, v95
    v_cvt_pk_bf16_f32 v88, v88, v92
    v_cvt_pk_bf16_f32 v89, v90, v94
    v_and_or_b32 v88, v88, -2, s28
    buffer_store_dwordx2 v[88:89], v7, s[4:7], s18 offen offset:2048 sc1
    v_mfma_f32_32x32x8_bf16 v[64:79], v[10:11], v[10:11], 0
    v_xor_b32 v28, 2048, v1
    v_xor_b32 v29, 4096, v1
    v_xor_b32 v30, 6144, v1
    v_mfma_f32_32x32x8_bf16 v[80:95], v[10:11], v[10:11], 0
    s_cmp_eq_u32 s15, 0
    s_cbranch_scc1 RS_re
    s_nop 3
    s_cmp_eq_u32 s15, 1
    s_cbranch_scc1 RS_re
    s_nop 7
    s_nop 7
    s_cmp_eq_u32 s15, 2
    s_cbranch_scc1 RS_re
    s_nop 7
    s_nop 7
RS_re:
    buffer_load_dwordx4 v[104:107], v2, s[4:7], s19 offen offset:0 sc1
    buffer_load_dwordx4 v[108:111], v2, s[4:7], s19 offen offset:1024 sc1
    v_mfma_f32_32x32x8_bf16 v[80:95], v[10:11], v[10:11], 0
    v_mfma_f32_32x32x8_bf16 v[80:95], v[10:11], v[10:11], 0
    v_mfma_f32_32x32x8_bf16 v[80:95], v[10:11], v[10:11], 0
    v_mfma_f32_32x32x8_bf16 v[80:95], v[10:11], v[10:11], 0
    buffer_load_dwordx4 v[112:115], v2, s[4:7], s19 offen offset:0 sc1
    buffer_load_dwordx4 v[120:123], v2, s[4:7], s19 offen offset:1024 sc1
    s_waitcnt lgkmcnt(0)
    v_mfma_f32_32x32x8_bf16 v[80:95], v[10:11], v[10:11], 0
    v_mfma_f32_32x32x8_bf16 v[80:95], v[10:11], v[10:11], 0
RS_rcA:
    s_waitcnt vmcnt(3)
    v_mfma_f32_16x16x32_bf16 v[100:103], v[96:99], v[104:107], 0
    v_and_b32 v118, 1, v104
    v_cmp_ne_u32 s[44:45], s28, v118
    s_waitcnt vmcnt(2)
    v_mfma_f32_16x16x32_bf16 v[16:19], v[96:99], v[108:111], v[100:103]
    v_and_b32 v119, 1, v108
    s_nop 2
    v_cmp_ne_u32 vcc, s28, v119
    s_nop 2
    v_add_f32_dpp v16, v16, v16 row_ror:8 row_mask:0xf bank_mask:0xf
    v_add_f32_dpp v17, v17, v17 row_ror:8 row_mask:0xf bank_mask:0xf
    s_nop 0
    v_add_f32_dpp v16, v16, v16 row_ror:4 row_mask:0xf bank_mask:0xf
    v_add_f32_dpp v17, v17, v17 row_ror:4 row_mask:0xf bank_mask:0xf
    s_or_b64 vcc, vcc, s[44:45]
    v_cvt_pk_bf16_f32 v116, v16, v17
    s_cbranch_vccnz RS_rfA
RS_rok:
    buffer_store_dword v116, v8, s[4:7], s23 offen sc1
    buffer_store_dword v117, v8, s[4:7], s24 offen sc1
    s_mov_b32 s24, s23
    s_sub_u32 s22, s23, s52
    s_cmp_eq_u32 s15, 3
    s_cbranch_scc1 RS_gl
    s_nop 7
    s_nop 7
    s_cmp_eq_u32 s15, 2
    s_cbranch_scc1 RS_gl
    s_nop 7
    s_nop 3
    s_cmp_eq_u32 s15, 1
    s_cbranch_scc1 RS_gl
    s_nop 3
RS_gl:
    s_nop 7
    s_nop 7
    buffer_load_dwordx4 v[32:35], v1, s[4:7], s22 offen offset:0 sc1
    s_add_u32 s23, s23, 8192
    s_cmp_ge_u32 s22, 0x6c84000
    s_cselect_b32 s48, 24576, 0
    s_sub_u32 s23, s23, s48
    s_add_u32 s16, s16, 1
    s_xor_b32 s28, s28, 1
    v_readlane_b32 s55, v0, 0
    v_readlane_b32 s48, v0, 2
    s_add_u32 s49, s16, 2
    s_min_u32 s49, s49, 64
    s_min_u32 s55, s55, s48
    s_cmp_ge_u32 s55, s49
    s_cbranch_scc1 RS_kvw_9_ok
    s_mov_b32 s30, 0
RS_kvw_9:
    buffer_load_dword v119, v8, s[4:7], s56 offen sc1
    s_waitcnt vmcnt(0)
    v_readlane_b32 s55, v119, 0
    v_readlane_b32 s48, v119, 2
    s_nop 1
    s_min_u32 s55, s55, s48
    s_cmp_ge_u32 s55, s49
    s_cbranch_scc1 RS_kvw_9_ok
    s_sleep 2
    s_add_u32 s30, s30, 1
    s_cmp_lt_u32 s30, s29
    s_cbranch_scc1 RS_kvw_9
    s_mov_b32 s29, 1
RS_kvw_9_ok:
    s_mov_b32 s30, 0
    s_nop 7
    s_nop 7
    s_nop 7
    buffer_load_dwordx4 v[32:35], v1, s[4:7], s22 offen offset:0 sc1
    s_branch RS_gA
RS_rfA:
    buffer_load_dwordx4 v[104:107], v2, s[4:7], s19 offen offset:0 sc1
    buffer_load_dwordx4 v[108:111], v2, s[4:7], s19 offen offset:1024 sc1
    s_add_u32 s30, s30, 1
RS_rcB:
    s_waitcnt vmcnt(3)
    v_mfma_f32_16x16x32_bf16 v[100:103], v[96:99], v[112:115], 0
    v_and_b32 v118, 1, v112
    v_cmp_ne_u32 s[44:45], s28, v118
    s_waitcnt vmcnt(2)
    v_mfma_f32_16x16x32_bf16 v[16:19], v[96:99], v[120:123], v[100:103]
    v_and_b32 v119, 1, v120
    s_nop 2
    v_cmp_ne_u32 vcc, s28, v119
    s_nop 2
    v_add_f32_dpp v16, v16, v16 row_ror:8 row_mask:0xf bank_mask:0xf
    v_add_f32_dpp v17, v17, v17 row_ror:8 row_mask:0xf bank_mask:0xf
    s_nop 0
    v_add_f32_dpp v16, v16, v16 row_ror:4 row_mask:0xf bank_mask:0xf
    v_add_f32_dpp v17, v17, v17 row_ror:4 row_mask:0xf bank_mask:0xf
    s_or_b64 vcc, vcc, s[44:45]
    v_cvt_pk_bf16_f32 v116, v16, v17
    s_cbranch_vccnz RS_rfB
    s_branch RS_rok
RS_rfB:
    buffer_load_dwordx4 v[112:115], v2, s[4:7], s19 offen offset:0 sc1
    buffer_load_dwordx4 v[120:123], v2, s[4:7], s19 offen offset:1024 sc1
    s_add_u32 s30, s30, 1
    s_cmp_lt_u32 s30, s29
    s_cbranch_scc1 RS_rcA
    s_mov_b32 s29, 1
    s_branch RS_rok
RS_last:
    buffer_store_dwordx4 v[12:15], v2, s[4:7], s26 offen sc1
    s_add_u32 s27, s27, 4096
    s_mov_b32 s26, s27
    v_smfmac_f32_16x16x64_bf16 v[76:79], v[36:39], a[200:207], v9
    v_smfmac_f32_16x16x64_bf16 v[80:83], v[36:39], v[136:143], v9
    v_smfmac_f32_16x16x64_bf16 v[84:87], v[36:39], v[200:207], v9
    v_smfmac_f32_16x16x64_bf16 v[80:83], v[40:43], v[144:151], v9
    v_smfmac_f32_16x16x64_bf16 v[84:87], v[40:43], v[208:215], v9
    v_smfmac_f32_16x16x64_bf16 v[80:83], v[48:51], v[160:167], v9
    v_smfmac_f32_16x16x64_bf16 v[84:87], v[48:51], v[224:231], v9
    v_smfmac_f32_16x16x64_bf16 v[80:83], v[56:59], v[176:183], v9
    v_smfmac_f32_16x16x64_bf16 v[84:87], v[56:59], v[240:247], v9
    s_waitcnt lgkmcnt(0)
    v_smfmac_f32_16x16x64_bf16 v[72:75], v[44:47], a[152:159], v9
    v_smfmac_f32_16x16x64_bf16 v[72:75], v[52:55], a[168:175], v9
    v_smfmac_f32_16x16x64_bf16 v[72:75], v[60:63], a[184:191], v9
    v_smfmac_f32_16x16x64_bf16 v[76:79], v[44:47], a[216:223], v9
    v_smfmac_f32_16x16x64_bf16 v[76:79], v[52:55], a[232:239], v9
    v_smfmac_f32_16x16x64_bf16 v[76:79], v[60:63], a[248:255], v9
    v_smfmac_f32_16x16x64_bf16 v[80:83], v[44:47], v[152:159], v9
    v_smfmac_f32_16x16x64_bf16 v[84:87], v[44:47], v[216:223], v9
    v_smfmac_f32_16x16x64_bf16 v[80:83], v[52:55], v[168:175], v9
    v_smfmac_f32_16x16x64_bf16 v[84:87], v[52:55], v[232:239], v9
    v_smfmac_f32_16x16x64_bf16 v[80:83], v[60:63], v[184:191], v9
    v_smfmac_f32_16x16x64_bf16 v[84:87], v[60:63], v[248:255], v9
    v_add_f32 v72, v72, v73
    v_add_f32 v74, v74, v75
    v_cvt_pk_bf16_f32 v13, v72, v74
    v_add_f32 v76, v76, v77
    v_add_f32 v78, v78, v79
    v_cvt_pk_bf16_f32 v15, v76, v78
    s_nop 1
    v_add_f32 v80, v80, v81
    v_add_f32 v82, v82, v83
    v_cvt_pk_bf16_f32 v12, v80, v82
    v_add_f32 v84, v84, v85
    v_add_f32 v86, v86, v87
    v_cvt_pk_bf16_f32 v14, v84, v86
RS_end:
    buffer_store_dwordx4 v[12:15], v2, s[4:7], s26 offen sc1
    s_branch L_done
L_G:
    s_load_dwordx4 s[32:35], s[0:1], 24
    s_load_dwordx2 s[36:37], s[0:1], 16
    v_bfe_u32 v31, v0, 4, 2
    v_lshlrev_b32 v28, 5, v31
    v_bfe_u32 v31, v0, 0, 4
    v_lshlrev_b32 v29, 4, v31
    v_xor_b32 v28, v28, v29
    v_bfe_u32 v31, v0, 4, 2
    v_lshlrev_b32 v30, 13, v31
    v_add_u32 v5, v28, v30
    v_xor_b32 v6, 128, v5
    s_bfe_u32 s50, s14, 0x50000
    s_lshl_b32 s50, s50, 8
    s_bfe_u32 s49, s15, 0x20000
    s_lshl_b32 s49, s49, 20
    s_add_u32 s50, s50, s49
    s_bfe_u32 s51, s15, 0x20000
    s_lshl_b32 s51, s51, 15
    s_waitcnt lgkmcnt(0)
    s_cmp_eq_u32 s3, 3
    s_cselect_b32 s32, s34, s32
    s_cselect_b32 s33, s35, s33
    s_mov_b32 s8, s32
    s_and_b32 s9, s33, 0xffff
    s_mov_b32 s10, 0x400000
    s_mov_b32 s11, 0x00020000
    s_mov_b32 m0, s51
    s_mov_b32 s48, s50
    s_movk_i32 s16, 0x400
    s_mov_b32 s28, 0x8000
    s_mov_b32 s29, 8
gs_10:
    buffer_load_dwordx4 v5, s[8:11], s48 offen lds
    s_add_u32 m0, m0, s16
    s_add_u32 s48, s48, s28
    buffer_load_dwordx4 v5, s[8:11], s48 offen lds
    s_add_u32 m0, m0, s16
    s_add_u32 s48, s48, s28
    buffer_load_dwordx4 v6, s[8:11], s48 offen lds
    s_add_u32 m0, m0, s16
    s_add_u32 s48, s48, s28
    buffer_load_dwordx4 v6, s[8:11], s48 offen lds
    s_add_u32 m0, m0, s16
    s_add_u32 s48, s48, s28
    s_sub_u32 s29, s29, 1
    s_cmp_lg_u32 s29, 0
    s_cbranch_scc1 gs_10
    s_bfe_u32 s23, s14, 0x50000
    s_lshl_b32 s23, s23, 7
    s_bfe_u32 s49, s3, 0x10000
    s_lshl_b32 s49, s49, 4
    s_add_u32 s23, s23, s49
    s_add_u32 s23, s23, 0x7210000
    v_and_b32 v4, 63, v0
    v_cmp_eq_u32 vcc, 0, v4
    v_mov_b32 v3, 0x40000000
    s_nop 0
    v_cndmask_b32 v3, v3, 0, vcc
    v_bfe_u32 v31, v0, 4, 2
    v_lshlrev_b32 v28, 11, v31
    v_bfe_u32 v31, v0, 2, 2
    v_lshl_add_u32 v28, v31, 8, v28
    v_bfe_u32 v31, v0, 0, 1
    v_lshl_add_u32 v28, v31, 3, v28
    v_bfe_u32 v31, v0, 6, 2
    v_lshlrev_b32 v29, 6, v31
    v_bfe_u32 v31, v0, 1, 1
    v_lshl_add_u32 v29, v31, 4, v29
    v_bfe_u32 v31, v0, 2, 2
    v_lshlrev_b32 v30, 5, v31
    v_bfe_u32 v31, v0, 4, 1
    v_lshl_add_u32 v30, v31, 7, v30
    v_xor_b32 v29, v29, v30
    v_add_u32 v8, v28, v29
    v_xor_b32 v9, 32, v8
    v_add_u32 v10, 0x10000, v8
    v_add_u32 v11, 0x10000, v9
    s_waitcnt vmcnt(0)
    s_barrier
    ds_read_b64_tr_b16 a[0:1], v8 offset:0
    ds_read_b64_tr_b16 a[2:3], v8 offset:1024
    ds_read_b64_tr_b16 a[64:65], v9 offset:0
    ds_read_b64_tr_b16 a[66:67], v9 offset:1024
    ds_read_b64_tr_b16 a[4:5], v8 offset:8192
    ds_read_b64_tr_b16 a[6:7], v8 offset:9216
    ds_read_b64_tr_b16 a[68:69], v9 offset:8192
    ds_read_b64_tr_b16 a[70:71], v9 offset:9216
    ds_read_b64_tr_b16 a[8:9], v8 offset:16384
    ds_read_b64_tr_b16 a[10:11], v8 offset:17408
    ds_read_b64_tr_b16 a[72:73], v9 offset:16384
    ds_read_b64_tr_b16 a[74:75], v9 offset:17408
    ds_read_b64_tr_b16 a[12:13], v8 offset:24576
    ds_read_b64_tr_b16 a[14:15], v8 offset:25600
    ds_read_b64_tr_b16 a[76:77], v9 offset:24576
    ds_read_b64_tr_b16 a[78:79], v9 offset:25600
    ds_read_b64_tr_b16 a[16:17], v8 offset:32768
    ds_read_b64_tr_b16 a[18:19], v8 offset:33792
    ds_read_b64_tr_b16 a[80:81], v9 offset:32768
    ds_read_b64_tr_b16 a[82:83], v9 offset:33792
    ds_read_b64_tr_b16 a[20:21], v8 offset:40960
    ds_read_b64_tr_b16 a[22:23], v8 offset:41984
    ds_read_b64_tr_b16 a[84:85], v9 offset:40960
    ds_read_b64_tr_b16 a[86:87], v9 offset:41984
    ds_read_b64_tr_b16 a[24:25], v8 offset:49152
    ds_read_b64_tr_b16 a[26:27], v8 offset:50176
    ds_read_b64_tr_b16 a[88:89], v9 offset:49152
    ds_read_b64_tr_b16 a[90:91], v9 offset:50176
    ds_read_b64_tr_b16 a[28:29], v8 offset:57344
    ds_read_b64_tr_b16 a[30:31], v8 offset:58368
    ds_read_b64_tr_b16 a[92:93], v9 offset:57344
    ds_read_b64_tr_b16 a[94:95], v9 offset:58368
    ds_read_b64_tr_b16 a[32:33], v10 offset:0
    ds_read_b64_tr_b16 a[34:35], v10 offset:1024
    ds_read_b64_tr_b16 a[96:97], v11 offset:0
    ds_read_b64_tr_b16 a[98:99], v11 offset:1024
    ds_read_b64_tr_b16 a[36:37], v10 offset:8192
    ds_read_b64_tr_b16 a[38:39], v10 offset:9216
    ds_read_b64_tr_b16 a[100:101], v11 offset:8192
    ds_read_b64_tr_b16 a[102:103], v11 offset:9216
    ds_read_b64_tr_b16 a[40:41], v10 offset:16384
    ds_read_b64_tr_b16 a[42:43], v10 offset:17408
    ds_read_b64_tr_b16 a[104:105], v11 offset:16384
    ds_read_b64_tr_b16 a[106:107], v11 offset:17408
    ds_read_b64_tr_b16 a[44:45], v10 offset:24576
    ds_read_b64_tr_b16 a[46:47], v10 offset:25600
    ds_read_b64_tr_b16 a[108:109], v11 offset:24576
    ds_read_b64_tr_b16 a[110:111], v11 offset:25600
    ds_read_b64_tr_b16 a[48:49], v10 offset:32768
    ds_read_b64_tr_b16 a[50:51], v10 offset:33792
    ds_read_b64_tr_b16 a[112:113], v11 offset:32768
    ds_read_b64_tr_b16 a[114:115], v11 offset:33792
    ds_read_b64_tr_b16 a[52:53], v10 offset:40960
    ds_read_b64_tr_b16 a[54:55], v10 offset:41984
    ds_read_b64_tr_b16 a[116:117], v11 offset:40960
    ds_read_b64_tr_b16 a[118:119], v11 offset:41984
    ds_read_b64_tr_b16 a[56:57], v10 offset:49152
    ds_read_b64_tr_b16 a[58:59], v10 offset:50176
    ds_read_b64_tr_b16 a[120:121], v11 offset:49152
    ds_read_b64_tr_b16 a[122:123], v11 offset:50176
    ds_read_b64_tr_b16 a[60:61], v10 offset:57344
    ds_read_b64_tr_b16 a[62:63], v10 offset:58368
    ds_read_b64_tr_b16 a[124:125], v11 offset:57344
    ds_read_b64_tr_b16 a[126:127], v11 offset:58368
    s_waitcnt lgkmcnt(0)
    s_barrier
    s_mov_b32 s8, s36
    s_and_b32 s9, s37, 0xffff
    s_mov_b32 s10, 0x400000
    s_mov_b32 s11, 0x00020000
    s_mov_b32 m0, s51
    s_mov_b32 s48, s50
    s_movk_i32 s16, 0x400
    s_mov_b32 s28, 0x8000
    s_mov_b32 s29, 8
gs_11:
    buffer_load_dwordx4 v5, s[8:11], s48 offen lds
    s_add_u32 m0, m0, s16
    s_add_u32 s48, s48, s28
    buffer_load_dwordx4 v5, s[8:11], s48 offen lds
    s_add_u32 m0, m0, s16
    s_add_u32 s48, s48, s28
    buffer_load_dwordx4 v6, s[8:11], s48 offen lds
    s_add_u32 m0, m0, s16
    s_add_u32 s48, s48, s28
    buffer_load_dwordx4 v6, s[8:11], s48 offen lds
    s_add_u32 m0, m0, s16
    s_add_u32 s48, s48, s28
    s_sub_u32 s29, s29, 1
    s_cmp_lg_u32 s29, 0
    s_cbranch_scc1 gs_11
    s_or_b32 s48, s75, s15
    s_cbranch_scc1 cl_12
    s_lshl_b32 s48, s3, 2
    s_add_u32 s48, s48, 60
    s_cmp_eq_u32 s3, 0
    s_cselect_b32 s48, 0, s48
    s_lshl_b32 s49, 1, s14
    v_mov_b32 v124, s48
    v_mov_b32 v125, s49
    s_mov_b64 exec, 1
    global_atomic_or v126, v124, v125, s[12:13] sc0
    s_mov_b64 exec, -1
cl_12:
    s_mul_i32 s17, s14, 1064960
    s_mul_i32 s19, s14, 532480
    s_bfe_u32 s48, s15, 0x20000
    s_lshl_b32 s48, s48, 10
    s_bfe_u32 s49, s3, 0x10000
    s_lshl_b32 s49, s49, 12
    s_add_u32 s48, s48, s49
    s_add_u32 s48, s48, 0x4000000
    s_add_u32 s19, s19, s48
    s_mul_i32 s26, s14, 266240
    s_bfe_u32 s48, s15, 0x20000
    s_lshl_b32 s48, s48, 10
    s_add_u32 s48, s48, 0x6000000
    s_add_u32 s26, s26, s48
    v_mov_b32 v12, -1
    v_mov_b32 v13, -1
    v_mov_b32 v14, -1
    v_mov_b32 v15, -1
    s_cmp_eq_u32 s3, 3
    s_cbranch_scc1 G_isv
    s_bfe_u32 s48, s15, 0x10001
    s_lshl_b32 s48, s48, 12
    s_bfe_u32 s49, s15, 0x10000
    s_lshl_b32 s49, s49, 10
    s_add_u32 s48, s48, s49
    s_add_u32 s17, s17, s48
    s_add_u32 s18, s17, 8192
    s_branch G_addr
G_isv:
    s_bfe_u32 s48, s15, 0x20000
    s_lshl_b32 s48, s48, 12
    s_add_u32 s48, s48, 0x800
    s_add_u32 s17, s17, s48
    s_add_u32 s18, s17, 1024
G_addr:
    s_sub_u32 s17, s17, 16384
    s_sub_u32 s18, s18, 16384
    s_sub_u32 s19, s19, 8192
    s_sub_u32 s26, s26, 4096
    s_waitcnt vmcnt(0)
    s_barrier
    ds_read_b64_tr_b16 a[128:129], v8 offset:0
    ds_read_b64_tr_b16 a[130:131], v8 offset:1024
    ds_read_b64_tr_b16 a[192:193], v9 offset:0
    ds_read_b64_tr_b16 a[194:195], v9 offset:1024
    ds_read_b64_tr_b16 a[132:133], v8 offset:8192
    ds_read_b64_tr_b16 a[134:135], v8 offset:9216
    ds_read_b64_tr_b16 a[196:197], v9 offset:8192
    ds_read_b64_tr_b16 a[198:199], v9 offset:9216
    ds_read_b64_tr_b16 a[136:137], v8 offset:16384
    ds_read_b64_tr_b16 a[138:139], v8 offset:17408
    ds_read_b64_tr_b16 a[200:201], v9 offset:16384
    ds_read_b64_tr_b16 a[202:203], v9 offset:17408
    ds_read_b64_tr_b16 a[140:141], v8 offset:24576
    ds_read_b64_tr_b16 a[142:143], v8 offset:25600
    ds_read_b64_tr_b16 a[204:205], v9 offset:24576
    ds_read_b64_tr_b16 a[206:207], v9 offset:25600
    ds_read_b64_tr_b16 a[144:145], v8 offset:32768
    ds_read_b64_tr_b16 a[146:147], v8 offset:33792
    ds_read_b64_tr_b16 a[208:209], v9 offset:32768
    ds_read_b64_tr_b16 a[210:211], v9 offset:33792
    ds_read_b64_tr_b16 a[148:149], v8 offset:40960
    ds_read_b64_tr_b16 a[150:151], v8 offset:41984
    ds_read_b64_tr_b16 a[212:213], v9 offset:40960
    ds_read_b64_tr_b16 a[214:215], v9 offset:41984
    ds_read_b64_tr_b16 a[152:153], v8 offset:49152
    ds_read_b64_tr_b16 a[154:155], v8 offset:50176
    ds_read_b64_tr_b16 a[216:217], v9 offset:49152
    ds_read_b64_tr_b16 a[218:219], v9 offset:50176
    ds_read_b64_tr_b16 a[156:157], v8 offset:57344
    ds_read_b64_tr_b16 a[158:159], v8 offset:58368
    ds_read_b64_tr_b16 a[220:221], v9 offset:57344
    ds_read_b64_tr_b16 a[222:223], v9 offset:58368
    ds_read_b64_tr_b16 a[160:161], v10 offset:0
    ds_read_b64_tr_b16 a[162:163], v10 offset:1024
    ds_read_b64_tr_b16 a[224:225], v11 offset:0
    ds_read_b64_tr_b16 a[226:227], v11 offset:1024
    ds_read_b64_tr_b16 a[164:165], v10 offset:8192
    ds_read_b64_tr_b16 a[166:167], v10 offset:9216
    ds_read_b64_tr_b16 a[228:229], v11 offset:8192
    ds_read_b64_tr_b16 a[230:231], v11 offset:9216
    ds_read_b64_tr_b16 a[168:169], v10 offset:16384
    ds_read_b64_tr_b16 a[170:171], v10 offset:17408
    ds_read_b64_tr_b16 a[232:233], v11 offset:16384
    ds_read_b64_tr_b16 a[234:235], v11 offset:17408
    ds_read_b64_tr_b16 a[172:173], v10 offset:24576
    ds_read_b64_tr_b16 a[174:175], v10 offset:25600
    ds_read_b64_tr_b16 a[236:237], v11 offset:24576
    ds_read_b64_tr_b16 a[238:239], v11 offset:25600
    ds_read_b64_tr_b16 a[176:177], v10 offset:32768
    ds_read_b64_tr_b16 a[178:179], v10 offset:33792
    ds_read_b64_tr_b16 a[240:241], v11 offset:32768
    ds_read_b64_tr_b16 a[242:243], v11 offset:33792
    ds_read_b64_tr_b16 a[180:181], v10 offset:40960
    ds_read_b64_tr_b16 a[182:183], v10 offset:41984
    ds_read_b64_tr_b16 a[244:245], v11 offset:40960
    ds_read_b64_tr_b16 a[246:247], v11 offset:41984
    ds_read_b64_tr_b16 a[184:185], v10 offset:49152
    ds_read_b64_tr_b16 a[186:187], v10 offset:50176
    ds_read_b64_tr_b16 a[248:249], v11 offset:49152
    ds_read_b64_tr_b16 a[250:251], v11 offset:50176
    ds_read_b64_tr_b16 a[188:189], v10 offset:57344
    ds_read_b64_tr_b16 a[190:191], v10 offset:58368
    ds_read_b64_tr_b16 a[252:253], v11 offset:57344
    ds_read_b64_tr_b16 a[254:255], v11 offset:58368
    s_waitcnt lgkmcnt(0)
    v_bfe_u32 v31, v0, 0, 6
    v_lshlrev_b32 v1, 4, v31
    s_bfe_u32 s20, s15, 0x20000
    s_lshl_b32 s20, s20, 13
    s_add_u32 s20, s20, 0x7000000
    s_bfe_u32 s21, s15, 0x20000
    s_lshl_b32 s21, s21, 13
    s_cmp_lg_u32 s75, 0
    s_cbranch_scc1 vc_13_done
    v_mov_b32 v125, 163776
    s_cmp_lg_u32 s15, 0
    s_cbranch_scc1 vc_13_w
    s_waitcnt vmcnt(0)
    s_mov_b64 exec, 1
    ds_write_b32 v125, v126
    s_mov_b64 exec, -1
    s_waitcnt lgkmcnt(0)
vc_13_w:
    s_barrier
    ds_read_b32 v124, v125
    s_waitcnt lgkmcnt(0)
    v_readfirstlane_b32 s48, v124
    s_mov_b32 s75, 1
    s_nop 2
    s_bitcmp1_b32 s48, s14
    s_cbranch_scc1 L_overflow
vc_13_done:
    s_cmp_lg_u32 s15, 0
    s_cbranch_scc1 dw_14_ok
    v_mov_b32 v24, 0
    s_mov_b32 s49, 0
    s_mov_b64 exec, 1
dw_14:
    global_load_dword v25, v24, s[12:13] offset:160 sc1
    s_waitcnt vmcnt(0)
    v_readfirstlane_b32 s48, v25
    s_cmp_ge_u32 s48, 32
    s_cbranch_scc1 dw_14_x
    s_sleep 16
    s_add_u32 s49, s49, 1
    s_cmp_lt_u32 s49, 100000
    s_cbranch_scc1 dw_14
dw_14_x:
    s_mov_b64 exec, -1
dw_14_ok:
    s_barrier
    s_add_u32 m0, s21, 0
    s_add_u32 s24, s20, 0
    buffer_load_dwordx4 v1, s[4:7], s24 offen offset:0 sc1 lds
    buffer_load_dwordx4 v1, s[4:7], s24 offen offset:1024 sc1 lds
    buffer_load_dwordx4 v1, s[4:7], s24 offen offset:2048 sc1 lds
    buffer_load_dwordx4 v1, s[4:7], s24 offen offset:3072 sc1 lds
    s_add_u32 m0, s21, 4096
    s_add_u32 s24, s20, 4096
    buffer_load_dwordx4 v1, s[4:7], s24 offen offset:0 sc1 lds
    buffer_load_dwordx4 v1, s[4:7], s24 offen offset:1024 sc1 lds
    buffer_load_dwordx4 v1, s[4:7], s24 offen offset:2048 sc1 lds
    buffer_load_dwordx4 v1, s[4:7], s24 offen offset:3072 sc1 lds
    s_add_u32 s20, s20, 32768
    s_add_u32 s21, s21, 32768
    s_and_b32 s21, s21, 0x1ffff
    s_add_u32 m0, s21, 0
    s_add_u32 s24, s20, 0
    buffer_load_dwordx4 v1, s[4:7], s24 offen offset:0 sc1 lds
    buffer_load_dwordx4 v1, s[4:7], s24 offen offset:1024 sc1 lds
    buffer_load_dwordx4 v1, s[4:7], s24 offen offset:2048 sc1 lds
    buffer_load_dwordx4 v1, s[4:7], s24 offen offset:3072 sc1 lds
    s_add_u32 m0, s21, 4096
    s_add_u32 s24, s20, 4096
    buffer_load_dwordx4 v1, s[4:7], s24 offen offset:0 sc1 lds
    buffer_load_dwordx4 v1, s[4:7], s24 offen offset:1024 sc1 lds
    buffer_load_dwordx4 v1, s[4:7], s24 offen offset:2048 sc1 lds
    buffer_load_dwordx4 v1, s[4:7], s24 offen offset:3072 sc1 lds
    s_add_u32 s20, s20, 32768
    s_add_u32 s21, s21, 32768
    s_and_b32 s21, s21, 0x1ffff
    s_add_u32 m0, s21, 0
    s_add_u32 s24, s20, 0
    buffer_load_dwordx4 v1, s[4:7], s24 offen offset:0 sc1 lds
    buffer_load_dwordx4 v1, s[4:7], s24 offen offset:1024 sc1 lds
    buffer_load_dwordx4 v1, s[4:7], s24 offen offset:2048 sc1 lds
    buffer_load_dwordx4 v1, s[4:7], s24 offen offset:3072 sc1 lds
    s_add_u32 m0, s21, 4096
    s_add_u32 s24, s20, 4096
    buffer_load_dwordx4 v1, s[4:7], s24 offen offset:0 sc1 lds
    buffer_load_dwordx4 v1, s[4:7], s24 offen offset:1024 sc1 lds
    buffer_load_dwordx4 v1, s[4:7], s24 offen offset:2048 sc1 lds
    buffer_load_dwordx4 v1, s[4:7], s24 offen offset:3072 sc1 lds
    s_add_u32 s20, s20, 32768
    s_add_u32 s21, s21, 32768
    s_and_b32 s21, s21, 0x1ffff
    s_mov_b32 s22, 0
    s_mov_b32 s25, 0
    v_mov_b32 v2, v1
    v_add_u32 v16, 0x8000, v1
    v_mov_b32 v7, 0x40000000
    s_cmp_eq_u32 s15, 0
    s_cselect_b32 s48, 0, 0x40000000
    v_or_b32 v17, s48, v3
    s_waitcnt vmcnt(8)
    s_barrier
    ds_read_b128 v[32:35], v2 offset:0
    ds_read_b128 v[36:39], v2 offset:16384
    ds_read_b128 v[40:43], v2 offset:1024
    ds_read_b128 v[44:47], v2 offset:17408
    ds_read_b128 v[48:51], v2 offset:2048
    ds_read_b128 v[52:55], v2 offset:18432
    s_cmp_eq_u32 s3, 3
    s_cbranch_scc1 G_loopV
.p2align 6
G_loopK:
    s_waitcnt lgkmcnt(4)
    v_mfma_f32_16x16x32_bf16 v[80:83], a[0:3], v[32:35], 0
    ds_read_b128 v[56:59], v2 offset:3072
    ds_read_b128 v[60:63], v2 offset:19456
    v_mfma_f32_16x16x32_bf16 v[84:87], a[64:67], v[32:35], 0
    s_barrier
    v_mov_b32 v4, s25
    v_mfma_f32_16x16x32_bf16 v[88:91], a[0:3], v[36:39], 0
    v_mfma_f32_16x16x32_bf16 v[92:95], a[64:67], v[36:39], 0
    buffer_store_dword v4, v17, s[4:7], s23 offen sc1
    v_mfma_f32_16x16x32_bf16 v[96:99], a[128:131], v[32:35], 0
    v_mfma_f32_16x16x32_bf16 v[100:103], a[192:195], v[32:35], 0
    s_waitcnt lgkmcnt(4)
    v_mfma_f32_16x16x32_bf16 v[80:83], a[4:7], v[40:43], v[80:83]
    ds_read_b128 v[32:35], v2 offset:4096
    ds_read_b128 v[36:39], v2 offset:20480
    v_mfma_f32_16x16x32_bf16 v[84:87], a[68:71], v[40:43], v[84:87]
    v_mfma_f32_16x16x32_bf16 v[88:91], a[4:7], v[44:47], v[88:91]
    v_mfma_f32_16x16x32_bf16 v[92:95], a[68:71], v[44:47], v[92:95]
    buffer_store_dwordx4 v[64:67], v7, s[4:7], s17 offen sc1
    v_mfma_f32_16x16x32_bf16 v[96:99], a[132:135], v[40:43], v[96:99]
    v_mfma_f32_16x16x32_bf16 v[100:103], a[196:199], v[40:43], v[100:103]
    s_waitcnt lgkmcnt(4)
    v_mfma_f32_16x16x32_bf16 v[80:83], a[8:11], v[48:51], v[80:83]
    ds_read_b128 v[40:43], v2 offset:5120
    ds_read_b128 v[44:47], v2 offset:21504
    v_mfma_f32_16x16x32_bf16 v[84:87], a[72:75], v[48:51], v[84:87]
    v_mfma_f32_16x16x32_bf16 v[88:91], a[8:11], v[52:55], v[88:91]
    v_mfma_f32_16x16x32_bf16 v[92:95], a[72:75], v[52:55], v[92:95]
    buffer_store_dwordx4 v[68:71], v7, s[4:7], s18 offen sc1
    v_mfma_f32_16x16x32_bf16 v[96:99], a[136:139], v[48:51], v[96:99]
    v_mfma_f32_16x16x32_bf16 v[100:103], a[200:203], v[48:51], v[100:103]
    s_waitcnt lgkmcnt(4)
    v_mfma_f32_16x16x32_bf16 v[80:83], a[12:15], v[56:59], v[80:83]
    ds_read_b128 v[48:51], v2 offset:6144
    ds_read_b128 v[52:55], v2 offset:22528
    v_mfma_f32_16x16x32_bf16 v[84:87], a[76:79], v[56:59], v[84:87]
    v_mfma_f32_16x16x32_bf16 v[88:91], a[12:15], v[60:63], v[88:91]
    v_mfma_f32_16x16x32_bf16 v[92:95], a[76:79], v[60:63], v[92:95]
    buffer_store_dwordx4 v[72:75], v7, s[4:7], s19 offen sc1
    v_mfma_f32_16x16x32_bf16 v[96:99], a[140:143], v[56:59], v[96:99]
    v_mfma_f32_16x16x32_bf16 v[100:103], a[204:207], v[56:59], v[100:103]
    s_waitcnt lgkmcnt(4)
    v_mfma_f32_16x16x32_bf16 v[80:83], a[16:19], v[32:35], v[80:83]
    ds_read_b128 v[56:59], v2 offset:7168
    ds_read_b128 v[60:63], v2 offset:23552
    v_mfma_f32_16x16x32_bf16 v[84:87], a[80:83], v[32:35], v[84:87]
    v_mfma_f32_16x16x32_bf16 v[88:91], a[16:19], v[36:39], v[88:91]
    v_mfma_f32_16x16x32_bf16 v[92:95], a[80:83], v[36:39], v[92:95]
    buffer_store_dwordx4 v[12:15], v7, s[4:7], s26 offen sc1
    v_mfma_f32_16x16x32_bf16 v[96:99], a[144:147], v[32:35], v[96:99]
    v_mfma_f32_16x16x32_bf16 v[100:103], a[208:211], v[32:35], v[100:103]
    s_waitcnt lgkmcnt(4)
    v_mfma_f32_16x16x32_bf16 v[80:83], a[20:23], v[40:43], v[80:83]
    ds_read_b128 v[32:35], v2 offset:8192
    ds_read_b128 v[36:39], v2 offset:24576
    v_mfma_f32_16x16x32_bf16 v[84:87], a[84:87], v[40:43], v[84:87]
    v_mfma_f32_16x16x32_bf16 v[88:91], a[20:23], v[44:47], v[88:91]
    v_mfma_f32_16x16x32_bf16 v[92:95], a[84:87], v[44:47], v[92:95]
    s_add_u32 m0, s21, 0
    s_add_u32 s24, s20, 0
    buffer_load_dwordx4 v1, s[4:7], s24 offen offset:0 sc1 lds
    v_mfma_f32_16x16x32_bf16 v[96:99], a[148:151], v[40:43], v[96:99]
    v_mfma_f32_16x16x32_bf16 v[100:103], a[212:215], v[40:43], v[100:103]
    s_waitcnt lgkmcnt(4)
    v_mfma_f32_16x16x32_bf16 v[80:83], a[24:27], v[48:51], v[80:83]
    ds_read_b128 v[40:43], v2 offset:9216
    ds_read_b128 v[44:47], v2 offset:25600
    v_mfma_f32_16x16x32_bf16 v[84:87], a[88:91], v[48:51], v[84:87]
    v_mfma_f32_16x16x32_bf16 v[88:91], a[24:27], v[52:55], v[88:91]
    v_mfma_f32_16x16x32_bf16 v[92:95], a[88:91], v[52:55], v[92:95]
    buffer_load_dwordx4 v1, s[4:7], s24 offen offset:1024 sc1 lds
    v_mfma_f32_16x16x32_bf16 v[96:99], a[152:155], v[48:51], v[96:99]
    v_mfma_f32_16x16x32_bf16 v[100:103], a[216:219], v[48:51], v[100:103]
    s_waitcnt lgkmcnt(4)
    v_mfma_f32_16x16x32_bf16 v[80:83], a[28:31], v[56:59], v[80:83]
    ds_read_b128 v[48:51], v2 offset:10240
    ds_read_b128 v[52:55], v2 offset:26624
    v_mfma_f32_16x16x32_bf16 v[84:87], a[92:95], v[56:59], v[84:87]
    v_mfma_f32_16x16x32_bf16 v[88:91], a[28:31], v[60:63], v[88:91]
    v_mfma_f32_16x16x32_bf16 v[92:95], a[92:95], v[60:63], v[92:95]
    buffer_load_dwordx4 v1, s[4:7], s24 offen offset:2048 sc1 lds
    v_mfma_f32_16x16x32_bf16 v[96:99], a[156:159], v[56:59], v[96:99]
    v_mfma_f32_16x16x32_bf16 v[100:103], a[220:223], v[56:59], v[100:103]
    s_waitcnt lgkmcnt(4)
    v_mfma_f32_16x16x32_bf16 v[80:83], a[32:35], v[32:35], v[80:83]
    ds_read_b128 v[56:59], v2 offset:11264
    ds_read_b128 v[60:63], v2 offset:27648
    v_mfma_f32_16x16x32_bf16 v[84:87], a[96:99], v[32:35], v[84:87]
    v_mfma_f32_16x16x32_bf16 v[88:91], a[32:35], v[36:39], v[88:91]
    v_mfma_f32_16x16x32_bf16 v[92:95], a[96:99], v[36:39], v[92:95]
    buffer_load_dwordx4 v1, s[4:7], s24 offen offset:3072 sc1 lds
    v_mfma_f32_16x16x32_bf16 v[96:99], a[160:163], v[32:35], v[96:99]
    v_mfma_f32_16x16x32_bf16 v[100:103], a[224:227], v[32:35], v[100:103]
    s_waitcnt lgkmcnt(4)
    v_mfma_f32_16x16x32_bf16 v[80:83], a[36:39], v[40:43], v[80:83]
    ds_read_b128 v[32:35], v2 offset:12288
    ds_read_b128 v[36:39], v2 offset:28672
    v_mfma_f32_16x16x32_bf16 v[84:87], a[100:103], v[40:43], v[84:87]
    v_mfma_f32_16x16x32_bf16 v[88:91], a[36:39], v[44:47], v[88:91]
    v_mfma_f32_16x16x32_bf16 v[92:95], a[100:103], v[44:47], v[92:95]
    s_add_u32 m0, s21, 4096
    s_add_u32 s24, s20, 4096
    buffer_load_dwordx4 v1, s[4:7], s24 offen offset:0 sc1 lds
    v_mfma_f32_16x16x32_bf16 v[96:99], a[164:167], v[40:43], v[96:99]
    v_mfma_f32_16x16x32_bf16 v[100:103], a[228:231], v[40:43], v[100:103]
    s_waitcnt lgkmcnt(4)
    v_mfma_f32_16x16x32_bf16 v[80:83], a[40:43], v[48:51], v[80:83]
    ds_read_b128 v[40:43], v2 offset:13312
    ds_read_b128 v[44:47], v2 offset:29696
    v_mfma_f32_16x16x32_bf16 v[84:87], a[104:107], v[48:51], v[84:87]
    v_mfma_f32_16x16x32_bf16 v[88:91], a[40:43], v[52:55], v[88:91]
    v_mfma_f32_16x16x32_bf16 v[92:95], a[104:107], v[52:55], v[92:95]
    buffer_load_dwordx4 v1, s[4:7], s24 offen offset:1024 sc1 lds
    v_mfma_f32_16x16x32_bf16 v[96:99], a[168:171], v[48:51], v[96:99]
    v_mfma_f32_16x16x32_bf16 v[100:103], a[232:235], v[48:51], v[100:103]
    s_waitcnt lgkmcnt(4)
    v_mfma_f32_16x16x32_bf16 v[80:83], a[44:47], v[56:59], v[80:83]
    ds_read_b128 v[48:51], v2 offset:14336
    ds_read_b128 v[52:55], v2 offset:30720
    v_mfma_f32_16x16x32_bf16 v[84:87], a[108:111], v[56:59], v[84:87]
    v_mfma_f32_16x16x32_bf16 v[88:91], a[44:47], v[60:63], v[88:91]
    v_mfma_f32_16x16x32_bf16 v[92:95], a[108:111], v[60:63], v[92:95]
    buffer_load_dwordx4 v1, s[4:7], s24 offen offset:2048 sc1 lds
    v_mfma_f32_16x16x32_bf16 v[96:99], a[172:175], v[56:59], v[96:99]
    v_mfma_f32_16x16x32_bf16 v[100:103], a[236:239], v[56:59], v[100:103]
    s_waitcnt lgkmcnt(4)
    v_mfma_f32_16x16x32_bf16 v[80:83], a[48:51], v[32:35], v[80:83]
    ds_read_b128 v[56:59], v2 offset:15360
    ds_read_b128 v[60:63], v2 offset:31744
    v_mfma_f32_16x16x32_bf16 v[84:87], a[112:115], v[32:35], v[84:87]
    v_mfma_f32_16x16x32_bf16 v[88:91], a[48:51], v[36:39], v[88:91]
    v_mfma_f32_16x16x32_bf16 v[92:95], a[112:115], v[36:39], v[92:95]
    buffer_load_dwordx4 v1, s[4:7], s24 offen offset:3072 sc1 lds
    s_add_u32 s20, s20, 32768
    s_add_u32 s21, s21, 32768
    s_and_b32 s21, s21, 0x1ffff
    v_mfma_f32_16x16x32_bf16 v[96:99], a[176:179], v[32:35], v[96:99]
    v_mfma_f32_16x16x32_bf16 v[100:103], a[240:243], v[32:35], v[100:103]
    s_waitcnt lgkmcnt(4)
    v_mfma_f32_16x16x32_bf16 v[80:83], a[52:55], v[40:43], v[80:83]
    ds_read_b128 v[32:35], v16 offset:0
    ds_read_b128 v[36:39], v16 offset:16384
    v_mfma_f32_16x16x32_bf16 v[84:87], a[116:119], v[40:43], v[84:87]
    v_mfma_f32_16x16x32_bf16 v[88:91], a[52:55], v[44:47], v[88:91]
    v_mfma_f32_16x16x32_bf16 v[92:95], a[116:119], v[44:47], v[92:95]
    v_mfma_f32_16x16x32_bf16 v[96:99], a[180:183], v[40:43], v[96:99]
    v_mfma_f32_16x16x32_bf16 v[100:103], a[244:247], v[40:43], v[100:103]
    s_waitcnt lgkmcnt(4)
    v_mfma_f32_16x16x32_bf16 v[80:83], a[56:59], v[48:51], v[80:83]
    ds_read_b128 v[40:43], v16 offset:1024
    ds_read_b128 v[44:47], v16 offset:17408
    v_mfma_f32_16x16x32_bf16 v[84:87], a[120:123], v[48:51], v[84:87]
    v_mfma_f32_16x16x32_bf16 v[88:91], a[56:59], v[52:55], v[88:91]
    v_mfma_f32_16x16x32_bf16 v[92:95], a[120:123], v[52:55], v[92:95]
    v_mfma_f32_16x16x32_bf16 v[96:99], a[184:187], v[48:51], v[96:99]
    v_mfma_f32_16x16x32_bf16 v[100:103], a[248:251], v[48:51], v[100:103]
    s_waitcnt lgkmcnt(4)
    v_mfma_f32_16x16x32_bf16 v[80:83], a[60:63], v[56:59], v[80:83]
    ds_read_b128 v[48:51], v16 offset:2048
    ds_read_b128 v[52:55], v16 offset:18432
    v_mfma_f32_16x16x32_bf16 v[84:87], a[124:127], v[56:59], v[84:87]
    v_mfma_f32_16x16x32_bf16 v[88:91], a[60:63], v[60:63], v[88:91]
    v_mfma_f32_16x16x32_bf16 v[92:95], a[124:127], v[60:63], v[92:95]
    v_mfma_f32_16x16x32_bf16 v[96:99], a[188:191], v[56:59], v[96:99]
    v_mfma_f32_16x16x32_bf16 v[100:103], a[252:255], v[56:59], v[100:103]
    v_mov_b32 v2, v16
    v_add_u32 v16, 0x8000, v16
    v_and_b32 v16, 0x1ffff, v16
    v_mov_b32 v7, v1
    s_add_u32 s17, s17, 16384
    s_add_u32 s18, s18, 16384
    s_add_u32 s19, s19, 8192
    s_add_u32 s26, s26, 4096
    v_cvt_pk_bf16_f32 v64, v80, v81
    v_cvt_pk_bf16_f32 v65, v82, v83
    v_cvt_pk_bf16_f32 v66, v84, v85
    v_cvt_pk_bf16_f32 v67, v86, v87
    v_cvt_pk_bf16_f32 v68, v88, v89
    v_cvt_pk_bf16_f32 v69, v90, v91
    v_cvt_pk_bf16_f32 v70, v92, v93
    v_cvt_pk_bf16_f32 v71, v94, v95
    v_cvt_pk_bf16_f32 v72, v96, v97
    v_cvt_pk_bf16_f32 v73, v98, v99
    v_cvt_pk_bf16_f32 v74, v100, v101
    v_cvt_pk_bf16_f32 v75, v102, v103
    s_max_u32 s25, s25, s22
    s_add_u32 s22, s22, 1
    s_waitcnt vmcnt(8)
    s_cmp_eq_u32 s22, 13
    s_cbranch_scc1 G_firstK
    s_cmp_eq_u32 s22, 2
    s_cbranch_scc1 G_secondK
    s_cmp_lt_u32 s22, 64
    s_cbranch_scc1 G_loopK
    buffer_store_dwordx4 v[64:67], v1, s[4:7], s17 offen sc1
    buffer_store_dwordx4 v[68:71], v1, s[4:7], s18 offen sc1
    buffer_store_dwordx4 v[72:75], v1, s[4:7], s19 offen sc1
    buffer_store_dwordx4 v[12:15], v1, s[4:7], s26 offen sc1
    s_branch G_fin
G_firstK:
    s_cmp_lg_u32 s15, 0
    s_cbranch_scc1 dw_15_ok
    v_mov_b32 v24, 0
    s_mov_b32 s49, 0
    s_mov_b64 exec, 1
dw_15:
    global_load_dword v25, v24, s[12:13] offset:224 sc1
    s_waitcnt vmcnt(0)
    v_readfirstlane_b32 s48, v25
    s_cmp_ge_u32 s48, 32
    s_cbranch_scc1 dw_15_x
    s_sleep 32
    s_add_u32 s49, s49, 1
    s_cmp_lt_u32 s49, 100000
    s_cbranch_scc1 dw_15
dw_15_x:
    s_mov_b64 exec, -1
dw_15_ok:
    s_barrier
    s_branch G_loopK
G_secondK:
    buffer_store_dwordx4 v[64:67], v1, s[4:7], s17 offen sc1
    buffer_store_dwordx4 v[68:71], v1, s[4:7], s18 offen sc1
    buffer_store_dwordx4 v[72:75], v1, s[4:7], s19 offen sc1
    buffer_store_dwordx4 v[12:15], v1, s[4:7], s26 offen sc1
    v_mov_b32 v7, 0x40000000
    s_waitcnt vmcnt(0)
    s_mov_b32 s25, 2
    s_branch G_loopK
.p2align 6
G_loopV:
    s_waitcnt lgkmcnt(4)
    v_mfma_f32_16x16x32_bf16 v[80:83], v[32:35], a[0:3], 0
    ds_read_b128 v[56:59], v2 offset:3072
    ds_read_b128 v[60:63], v2 offset:19456
    v_mfma_f32_16x16x32_bf16 v[88:91], v[32:35], a[64:67], 0
    s_barrier
    v_mov_b32 v4, s25
    v_mfma_f32_16x16x32_bf16 v[84:87], v[36:39], a[0:3], 0
    v_mfma_f32_16x16x32_bf16 v[92:95], v[36:39], a[64:67], 0
    buffer_store_dword v4, v17, s[4:7], s23 offen sc1
    v_mfma_f32_16x16x32_bf16 v[96:99], a[128:131], v[36:39], 0
    v_mfma_f32_16x16x32_bf16 v[100:103], a[192:195], v[36:39], 0
    s_waitcnt lgkmcnt(4)
    v_mfma_f32_16x16x32_bf16 v[80:83], v[40:43], a[4:7], v[80:83]
    ds_read_b128 v[32:35], v2 offset:4096
    ds_read_b128 v[36:39], v2 offset:20480
    v_mfma_f32_16x16x32_bf16 v[88:91], v[40:43], a[68:71], v[88:91]
    v_mfma_f32_16x16x32_bf16 v[84:87], v[44:47], a[4:7], v[84:87]
    v_mfma_f32_16x16x32_bf16 v[92:95], v[44:47], a[68:71], v[92:95]
    buffer_store_dwordx4 v[64:67], v7, s[4:7], s17 offen sc1
    v_mfma_f32_16x16x32_bf16 v[96:99], a[132:135], v[44:47], v[96:99]
    v_mfma_f32_16x16x32_bf16 v[100:103], a[196:199], v[44:47], v[100:103]
    s_waitcnt lgkmcnt(4)
    v_mfma_f32_16x16x32_bf16 v[80:83], v[48:51], a[8:11], v[80:83]
    ds_read_b128 v[40:43], v2 offset:5120
    ds_read_b128 v[44:47], v2 offset:21504
    v_mfma_f32_16x16x32_bf16 v[88:91], v[48:51], a[72:75], v[88:91]
    v_mfma_f32_16x16x32_bf16 v[84:87], v[52:55], a[8:11], v[84:87]
    v_mfma_f32_16x16x32_bf16 v[92:95], v[52:55], a[72:75], v[92:95]
    buffer_store_dwordx4 v[68:71], v7, s[4:7], s18 offen sc1
    v_mfma_f32_16x16x32_bf16 v[96:99], a[136:139], v[52:55], v[96:99]
    v_mfma_f32_16x16x32_bf16 v[100:103], a[200:203], v[52:55], v[100:103]
    s_waitcnt lgkmcnt(4)
    v_mfma_f32_16x16x32_bf16 v[80:83], v[56:59], a[12:15], v[80:83]
    ds_read_b128 v[48:51], v2 offset:6144
    ds_read_b128 v[52:55], v2 offset:22528
    v_mfma_f32_16x16x32_bf16 v[88:91], v[56:59], a[76:79], v[88:91]
    v_mfma_f32_16x16x32_bf16 v[84:87], v[60:63], a[12:15], v[84:87]
    v_mfma_f32_16x16x32_bf16 v[92:95], v[60:63], a[76:79], v[92:95]
    buffer_store_dwordx4 v[72:75], v7, s[4:7], s19 offen sc1
    v_mfma_f32_16x16x32_bf16 v[96:99], a[140:143], v[60:63], v[96:99]
    v_mfma_f32_16x16x32_bf16 v[100:103], a[204:207], v[60:63], v[100:103]
    s_waitcnt lgkmcnt(4)
    v_mfma_f32_16x16x32_bf16 v[80:83], v[32:35], a[16:19], v[80:83]
    ds_read_b128 v[56:59], v2 offset:7168
    ds_read_b128 v[60:63], v2 offset:23552
    v_mfma_f32_16x16x32_bf16 v[88:91], v[32:35], a[80:83], v[88:91]
    v_mfma_f32_16x16x32_bf16 v[84:87], v[36:39], a[16:19], v[84:87]
    v_mfma_f32_16x16x32_bf16 v[92:95], v[36:39], a[80:83], v[92:95]
    s_add_u32 m0, s21, 0
    s_add_u32 s24, s20, 0
    buffer_load_dwordx4 v1, s[4:7], s24 offen offset:0 sc1 lds
    v_mfma_f32_16x16x32_bf16 v[96:99], a[144:147], v[36:39], v[96:99]
    v_mfma_f32_16x16x32_bf16 v[100:103], a[208:211], v[36:39], v[100:103]
    s_waitcnt lgkmcnt(4)
    v_mfma_f32_16x16x32_bf16 v[80:83], v[40:43], a[20:23], v[80:83]
    ds_read_b128 v[32:35], v2 offset:8192
    ds_read_b128 v[36:39], v2 offset:24576
    v_mfma_f32_16x16x32_bf16 v[88:91], v[40:43], a[84:87], v[88:91]
    v_mfma_f32_16x16x32_bf16 v[84:87], v[44:47], a[20:23], v[84:87]
    v_mfma_f32_16x16x32_bf16 v[92:95], v[44:47], a[84:87], v[92:95]
    buffer_load_dwordx4 v1, s[4:7], s24 offen offset:1024 sc1 lds
    v_mfma_f32_16x16x32_bf16 v[96:99], a[148:151], v[44:47], v[96:99]
    v_mfma_f32_16x16x32_bf16 v[100:103], a[212:215], v[44:47], v[100:103]
    s_waitcnt lgkmcnt(4)
    v_mfma_f32_16x16x32_bf16 v[80:83], v[48:51], a[24:27], v[80:83]
    ds_read_b128 v[40:43], v2 offset:9216
    ds_read_b128 v[44:47], v2 offset:25600
    v_mfma_f32_16x16x32_bf16 v[88:91], v[48:51], a[88:91], v[88:91]
    v_mfma_f32_16x16x32_bf16 v[84:87], v[52:55], a[24:27], v[84:87]
    v_mfma_f32_16x16x32_bf16 v[92:95], v[52:55], a[88:91], v[92:95]
    buffer_load_dwordx4 v1, s[4:7], s24 offen offset:2048 sc1 lds
    v_mfma_f32_16x16x32_bf16 v[96:99], a[152:155], v[52:55], v[96:99]
    v_mfma_f32_16x16x32_bf16 v[100:103], a[216:219], v[52:55], v[100:103]
    s_waitcnt lgkmcnt(4)
    v_mfma_f32_16x16x32_bf16 v[80:83], v[56:59], a[28:31], v[80:83]
    ds_read_b128 v[48:51], v2 offset:10240
    ds_read_b128 v[52:55], v2 offset:26624
    v_mfma_f32_16x16x32_bf16 v[88:91], v[56:59], a[92:95], v[88:91]
    v_mfma_f32_16x16x32_bf16 v[84:87], v[60:63], a[28:31], v[84:87]
    v_mfma_f32_16x16x32_bf16 v[92:95], v[60:63], a[92:95], v[92:95]
    buffer_load_dwordx4 v1, s[4:7], s24 offen offset:3072 sc1 lds
    v_mfma_f32_16x16x32_bf16 v[96:99], a[156:159], v[60:63], v[96:99]
    v_mfma_f32_16x16x32_bf16 v[100:103], a[220:223], v[60:63], v[100:103]
    s_waitcnt lgkmcnt(4)
    v_mfma_f32_16x16x32_bf16 v[80:83], v[32:35], a[32:35], v[80:83]
    ds_read_b128 v[56:59], v2 offset:11264
    ds_read_b128 v[60:63], v2 offset:27648
    v_mfma_f32_16x16x32_bf16 v[88:91], v[32:35], a[96:99], v[88:91]
    v_mfma_f32_16x16x32_bf16 v[84:87], v[36:39], a[32:35], v[84:87]
    v_mfma_f32_16x16x32_bf16 v[92:95], v[36:39], a[96:99], v[92:95]
    s_add_u32 m0, s21, 4096
    s_add_u32 s24, s20, 4096
    buffer_load_dwordx4 v1, s[4:7], s24 offen offset:0 sc1 lds
    v_mfma_f32_16x16x32_bf16 v[96:99], a[160:163], v[36:39], v[96:99]
    v_mfma_f32_16x16x32_bf16 v[100:103], a[224:227], v[36:39], v[100:103]
    s_waitcnt lgkmcnt(4)
    v_mfma_f32_16x16x32_bf16 v[80:83], v[40:43], a[36:39], v[80:83]
    ds_read_b128 v[32:35], v2 offset:12288
    ds_read_b128 v[36:39], v2 offset:28672
    v_mfma_f32_16x16x32_bf16 v[88:91], v[40:43], a[100:103], v[88:91]
    v_mfma_f32_16x16x32_bf16 v[84:87], v[44:47], a[36:39], v[84:87]
    v_mfma_f32_16x16x32_bf16 v[92:95], v[44:47], a[100:103], v[92:95]
    buffer_load_dwordx4 v1, s[4:7], s24 offen offset:1024 sc1 lds
    v_mfma_f32_16x16x32_bf16 v[96:99], a[164:167], v[44:47], v[96:99]
    v_mfma_f32_16x16x32_bf16 v[100:103], a[228:231], v[44:47], v[100:103]
    s_waitcnt lgkmcnt(4)
    v_mfma_f32_16x16x32_bf16 v[80:83], v[48:51], a[40:43], v[80:83]
    ds_read_b128 v[40:43], v2 offset:13312
    ds_read_b128 v[44:47], v2 offset:29696
    v_mfma_f32_16x16x32_bf16 v[88:91], v[48:51], a[104:107], v[88:91]
    v_mfma_f32_16x16x32_bf16 v[84:87], v[52:55], a[40:43], v[84:87]
    v_mfma_f32_16x16x32_bf16 v[92:95], v[52:55], a[104:107], v[92:95]
    buffer_load_dwordx4 v1, s[4:7], s24 offen offset:2048 sc1 lds
    v_mfma_f32_16x16x32_bf16 v[96:99], a[168:171], v[52:55], v[96:99]
    v_mfma_f32_16x16x32_bf16 v[100:103], a[232:235], v[52:55], v[100:103]
    s_waitcnt lgkmcnt(4)
    v_mfma_f32_16x16x32_bf16 v[80:83], v[56:59], a[44:47], v[80:83]
    ds_read_b128 v[48:51], v2 offset:14336
    ds_read_b128 v[52:55], v2 offset:30720
    v_mfma_f32_16x16x32_bf16 v[88:91], v[56:59], a[108:111], v[88:91]
    v_mfma_f32_16x16x32_bf16 v[84:87], v[60:63], a[44:47], v[84:87]
    v_mfma_f32_16x16x32_bf16 v[92:95], v[60:63], a[108:111], v[92:95]
    buffer_load_dwordx4 v1, s[4:7], s24 offen offset:3072 sc1 lds
    s_add_u32 s20, s20, 32768
    s_add_u32 s21, s21, 32768
    s_and_b32 s21, s21, 0x1ffff
    v_mfma_f32_16x16x32_bf16 v[96:99], a[172:175], v[60:63], v[96:99]
    v_mfma_f32_16x16x32_bf16 v[100:103], a[236:239], v[60:63], v[100:103]
    s_waitcnt lgkmcnt(4)
    v_mfma_f32_16x16x32_bf16 v[80:83], v[32:35], a[48:51], v[80:83]
    ds_read_b128 v[56:59], v2 offset:15360
    ds_read_b128 v[60:63], v2 offset:31744
    v_mfma_f32_16x16x32_bf16 v[88:91], v[32:35], a[112:115], v[88:91]
    v_mfma_f32_16x16x32_bf16 v[84:87], v[36:39], a[48:51], v[84:87]
    v_mfma_f32_16x16x32_bf16 v[92:95], v[36:39], a[112:115], v[92:95]
    v_mfma_f32_16x16x32_bf16 v[96:99], a[176:179], v[36:39], v[96:99]
    v_mfma_f32_16x16x32_bf16 v[100:103], a[240:243], v[36:39], v[100:103]
    s_waitcnt lgkmcnt(4)
    v_mfma_f32_16x16x32_bf16 v[80:83], v[40:43], a[52:55], v[80:83]
    ds_read_b128 v[32:35], v16 offset:0
    ds_read_b128 v[36:39], v16 offset:16384
    v_mfma_f32_16x16x32_bf16 v[88:91], v[40:43], a[116:119], v[88:91]
    v_mfma_f32_16x16x32_bf16 v[84:87], v[44:47], a[52:55], v[84:87]
    v_mfma_f32_16x16x32_bf16 v[92:95], v[44:47], a[116:119], v[92:95]
    v_mfma_f32_16x16x32_bf16 v[96:99], a[180:183], v[44:47], v[96:99]
    v_mfma_f32_16x16x32_bf16 v[100:103], a[244:247], v[44:47], v[100:103]
    s_waitcnt lgkmcnt(4)
    v_mfma_f32_16x16x32_bf16 v[80:83], v[48:51], a[56:59], v[80:83]
    ds_read_b128 v[40:43], v16 offset:1024
    ds_read_b128 v[44:47], v16 offset:17408
    v_mfma_f32_16x16x32_bf16 v[88:91], v[48:51], a[120:123], v[88:91]
    v_mfma_f32_16x16x32_bf16 v[84:87], v[52:55], a[56:59], v[84:87]
    v_mfma_f32_16x16x32_bf16 v[92:95], v[52:55], a[120:123], v[92:95]
    v_mfma_f32_16x16x32_bf16 v[96:99], a[184:187], v[52:55], v[96:99]
    v_mfma_f32_16x16x32_bf16 v[100:103], a[248:251], v[52:55], v[100:103]
    s_waitcnt lgkmcnt(4)
    v_mfma_f32_16x16x32_bf16 v[80:83], v[56:59], a[60:63], v[80:83]
    ds_read_b128 v[48:51], v16 offset:2048
    ds_read_b128 v[52:55], v16 offset:18432
    v_mfma_f32_16x16x32_bf16 v[88:91], v[56:59], a[124:127], v[88:91]
    v_mfma_f32_16x16x32_bf16 v[84:87], v[60:63], a[60:63], v[84:87]
    v_mfma_f32_16x16x32_bf16 v[92:95], v[60:63], a[124:127], v[92:95]
    v_mfma_f32_16x16x32_bf16 v[96:99], a[188:191], v[60:63], v[96:99]
    v_mfma_f32_16x16x32_bf16 v[100:103], a[252:255], v[60:63], v[100:103]
    v_mov_b32 v2, v16
    v_add_u32 v16, 0x8000, v16
    v_and_b32 v16, 0x1ffff, v16
    v_mov_b32 v7, v1
    s_add_u32 s17, s17, 16384
    s_add_u32 s18, s18, 16384
    s_add_u32 s19, s19, 8192
    s_add_u32 s26, s26, 4096
    v_cvt_pk_bf16_f32 v64, v80, v81
    v_cvt_pk_bf16_f32 v65, v82, v83
    v_cvt_pk_bf16_f32 v66, v84, v85
    v_cvt_pk_bf16_f32 v67, v86, v87
    v_cvt_pk_bf16_f32 v68, v88, v89
    v_cvt_pk_bf16_f32 v69, v90, v91
    v_cvt_pk_bf16_f32 v70, v92, v93
    v_cvt_pk_bf16_f32 v71, v94, v95
    v_cvt_pk_bf16_f32 v72, v96, v97
    v_cvt_pk_bf16_f32 v73, v98, v99
    v_cvt_pk_bf16_f32 v74, v100, v101
    v_cvt_pk_bf16_f32 v75, v102, v103
    s_max_u32 s25, s25, s22
    s_add_u32 s22, s22, 1
    s_waitcnt vmcnt(8)
    s_cmp_eq_u32 s22, 13
    s_cbranch_scc1 G_firstV
    s_cmp_eq_u32 s22, 2
    s_cbranch_scc1 G_secondV
    s_cmp_lt_u32 s22, 64
    s_cbranch_scc1 G_loopV
    buffer_store_dwordx4 v[64:67], v1, s[4:7], s17 offen sc1
    buffer_store_dwordx4 v[68:71], v1, s[4:7], s18 offen sc1
    buffer_store_dwordx4 v[72:75], v1, s[4:7], s19 offen sc1
    s_branch G_fin
G_firstV:
    s_cmp_lg_u32 s15, 0
    s_cbranch_scc1 dw_16_ok
    v_mov_b32 v24, 0
    s_mov_b32 s49, 0
    s_mov_b64 exec, 1
dw_16:
    global_load_dword v25, v24, s[12:13] offset:224 sc1
    s_waitcnt vmcnt(0)
    v_readfirstlane_b32 s48, v25
    s_cmp_ge_u32 s48, 32
    s_cbranch_scc1 dw_16_x
    s_sleep 32
    s_add_u32 s49, s49, 1
    s_cmp_lt_u32 s49, 100000
    s_cbranch_scc1 dw_16
dw_16_x:
    s_mov_b64 exec, -1
dw_16_ok:
    s_barrier
    s_branch G_loopV
G_secondV:
    buffer_store_dwordx4 v[64:67], v1, s[4:7], s17 offen sc1
    buffer_store_dwordx4 v[68:71], v1, s[4:7], s18 offen sc1
    buffer_store_dwordx4 v[72:75], v1, s[4:7], s19 offen sc1
    v_mov_b32 v7, 0x40000000
    s_waitcnt vmcnt(0)
    s_mov_b32 s25, 2
    s_branch G_loopV
G_fin:
    s_waitcnt vmcnt(0) lgkmcnt(0)
    s_barrier
    v_mov_b32 v4, 64
    buffer_store_dword v4, v3, s[4:7], s23 offen sc1
    s_waitcnt vmcnt(0)
    s_barrier
    s_branch L_T
L_overflow:
    s_waitcnt vmcnt(0) lgkmcnt(0)
    s_barrier
    v_mov_b32 v2, 0
    v_mov_b32 v3, 1
    v_mov_b32 v5, 0
    s_cmp_lg_u32 s15, 0
    s_cbranch_scc1 L_ovw
    s_mov_b64 exec, 1
    global_atomic_add v4, v2, v3, s[12:13] offset:96 sc0
    s_waitcnt vmcnt(0)
    ds_write_b32 v5, v4
    s_waitcnt lgkmcnt(0)
    s_mov_b64 exec, -1
L_ovw:
    s_barrier
    ds_read_b32 v4, v5
    s_waitcnt lgkmcnt(0)
    v_readfirstlane_b32 s18, v4
    s_barrier
    v_and_b32 v24, 31, v0
    v_lshlrev_b32 v24, 2, v24
    s_mov_b32 s17, 0
L_ov:
    global_load_dword v25, v24, s[12:13] sc1
    s_waitcnt vmcnt(0)
    v_readlane_b32 s19, v25, 24
    v_readlane_b32 s20, v25, 0
    s_nop 1
    s_bcnt1_i32_b32 s20, s20
    s_add_u32 s19, s19, s20
    v_readlane_b32 s20, v25, 16
    s_nop 1
    s_bcnt1_i32_b32 s20, s20
    s_add_u32 s19, s19, s20
    v_readlane_b32 s20, v25, 17
    s_nop 1
    s_bcnt1_i32_b32 s20, s20
    s_add_u32 s19, s19, s20
    v_readlane_b32 s20, v25, 18
    s_nop 1
    s_bcnt1_i32_b32 s20, s20
    s_add_u32 s19, s19, s20
    v_readlane_b32 s20, v25, 19
    s_nop 1
    s_bcnt1_i32_b32 s20, s20
    s_add_u32 s19, s19, s20
    v_readlane_b32 s20, v25, 20
    s_nop 1
    s_bcnt1_i32_b32 s20, s20
    s_add_u32 s19, s19, s20
    v_readlane_b32 s20, v25, 21
    s_nop 1
    s_bcnt1_i32_b32 s20, s20
    s_add_u32 s19, s19, s20
    v_readlane_b32 s20, v25, 22
    s_nop 1
    s_bcnt1_i32_b32 s20, s20
    s_add_u32 s19, s19, s20
    s_cmp_ge_u32 s19, 256
    s_cbranch_scc1 L_ovok
    s_sleep 32
    s_add_u32 s17, s17, 1
    s_cmp_lt_u32 s17, 50000
    s_cbranch_scc1 L_ov
    s_branch L_exit
L_ovok:
    v_readlane_b32 s20, v25, 0
    s_mov_b32 s3, 0
    s_nop 1
    s_bcnt0_i32_b32 s19, s20
    s_cmp_lt_u32 s18, s19
    s_cbranch_scc1 L_ovf
    s_sub_u32 s18, s18, s19
    v_readlane_b32 s20, v25, 16
    s_mov_b32 s3, 1
    s_nop 1
    s_bcnt0_i32_b32 s19, s20
    s_cmp_lt_u32 s18, s19
    s_cbranch_scc1 L_ovf
    s_sub_u32 s18, s18, s19
    v_readlane_b32 s20, v25, 17
    s_mov_b32 s3, 2
    s_nop 1
    s_bcnt0_i32_b32 s19, s20
    s_cmp_lt_u32 s18, s19
    s_cbranch_scc1 L_ovf
    s_sub_u32 s18, s18, s19
    v_readlane_b32 s20, v25, 18
    s_mov_b32 s3, 3
    s_nop 1
    s_bcnt0_i32_b32 s19, s20
    s_cmp_lt_u32 s18, s19
    s_cbranch_scc1 L_ovf
    s_sub_u32 s18, s18, s19
    v_readlane_b32 s20, v25, 19
    s_mov_b32 s3, 4
    s_nop 1
    s_bcnt0_i32_b32 s19, s20
    s_cmp_lt_u32 s18, s19
    s_cbranch_scc1 L_ovf
    s_sub_u32 s18, s18, s19
    v_readlane_b32 s20, v25, 20
    s_mov_b32 s3, 5
    s_nop 1
    s_bcnt0_i32_b32 s19, s20
    s_cmp_lt_u32 s18, s19
    s_cbranch_scc1 L_ovf
    s_sub_u32 s18, s18, s19
    v_readlane_b32 s20, v25, 21
    s_mov_b32 s3, 6
    s_nop 1
    s_bcnt0_i32_b32 s19, s20
    s_cmp_lt_u32 s18, s19
    s_cbranch_scc1 L_ovf
    s_sub_u32 s18, s18, s19
    v_readlane_b32 s20, v25, 22
    s_mov_b32 s3, 7
    s_nop 1
    s_bcnt0_i32_b32 s19, s20
    s_cmp_lt_u32 s18, s19
    s_cbranch_scc1 L_ovf
    s_sub_u32 s18, s18, s19
    s_branch L_exit
L_ovf:
    s_cmp_eq_u32 s18, 0
    s_cbranch_scc1 L_ovg
    s_add_u32 s19, s20, 1
    s_or_b32 s20, s20, s19
    s_sub_u32 s18, s18, 1
    s_branch L_ovf
L_ovg:
    s_ff0_i32_b32 s14, s20
    s_and_b32 s14, s14, 31
    s_branch L_role
L_T:
    s_mov_b32 s17, 0xffff0000
    s_load_dwordx2 s[34:35], s[0:1], 40
    s_load_dwordx4 s[36:39], s[0:1], 64
    s_load_dwordx2 s[40:41], s[0:1], 80
    v_bfe_u32 v47, v0, 0, 6
    v_lshlrev_b32 v1, 4, v47
    v_bfe_u32 v47, v0, 6, 2
    v_lshlrev_b32 v2, 8, v47
    v_bfe_u32 v47, v0, 2, 2
    v_lshl_add_u32 v2, v47, 6, v2
    v_bfe_u32 v47, v0, 5, 1
    v_lshl_add_u32 v2, v47, 5, v2
    v_bfe_u32 v47, v0, 0, 2
    v_lshl_add_u32 v2, v47, 3, v2
    v_bfe_u32 v47, v0, 4, 1
    v_lshl_add_u32 v2, v47, 2, v2
    v_bfe_u32 v47, v0, 0, 4
    v_lshlrev_b32 v3, 14, v47
    v_bfe_u32 v47, v0, 4, 2
    v_lshl_add_u32 v3, v47, 4, v3
    v_bfe_u32 v47, v0, 6, 2
    v_lshlrev_b32 v4, 12, v47
    v_bfe_u32 v47, v0, 0, 4
    v_lshl_add_u32 v4, v47, 5, v4
    v_bfe_u32 v47, v0, 4, 2
    v_lshl_add_u32 v4, v47, 3, v4
    v_add_u32 v4, 81920, v4
    v_bfe_u32 v47, v0, 2, 2
    v_lshlrev_b32 v48, 3, v47
    v_xor_b32 v4, v4, v48
    v_bfe_u32 v47, v0, 6, 2
    v_lshlrev_b32 v5, 12, v47
    v_bfe_u32 v47, v0, 0, 6
    v_lshl_add_u32 v5, v47, 3, v5
    v_add_u32 v5, 81920, v5
    v_bfe_u32 v47, v0, 4, 2
    v_lshlrev_b32 v48, 3, v47
    v_xor_b32 v5, v5, v48
    v_bfe_u32 v47, v0, 4, 2
    v_lshlrev_b32 v6, 11, v47
    v_bfe_u32 v47, v0, 6, 2
    v_lshl_add_u32 v6, v47, 8, v6
    v_bfe_u32 v47, v0, 0, 4
    v_lshl_add_u32 v6, v47, 4, v6
    v_bfe_u32 v47, v0, 6, 2
    v_lshlrev_b32 v48, 2, v47
    v_bfe_u32 v47, v0, 2, 2
    v_lshl_add_u32 v48, v47, 0, v48
    v_mul_u32_u24 v7, 1088, v48
    v_and_b32 v48, 3, v0
    v_mul_u32_u24 v48, 272, v48
    v_add_u32 v7, v7, v48
    v_bfe_u32 v47, v0, 4, 2
    v_lshlrev_b32 v48, 4, v47
    v_add_u32 v48, 98304, v48
    v_add_u32 v7, v7, v48
    v_bfe_u32 v48, v0, 4, 2
    v_mul_u32_u24 v8, 272, v48
    v_bfe_u32 v47, v0, 0, 4
    v_lshlrev_b32 v48, 4, v47
    v_add_u32 v48, 98304, v48
    v_add_u32 v8, v8, v48
    v_bfe_u32 v47, v0, 6, 1
    v_lshlrev_b32 v9, 13, v47
    v_bfe_u32 v47, v0, 7, 1
    v_lshl_add_u32 v9, v47, 12, v9
    v_bfe_u32 v47, v0, 0, 6
    v_lshl_add_u32 v9, v47, 4, v9
    v_mov_b32 v10, 0
    v_bfe_u32 v47, v0, 6, 2
    v_lshlrev_b32 v11, 12, v47
    v_bfe_u32 v47, v0, 0, 6
    v_lshl_add_u32 v11, v47, 4, v11
    v_add_u32 v11, 65536, v11
    v_bfe_u32 v47, v0, 7, 1
    v_lshlrev_b32 v12, 14, v47
    v_bfe_u32 v47, v0, 0, 6
    v_lshl_add_u32 v12, v47, 4, v12
    v_add_u32 v12, 32768, v12
    v_bfe_u32 v47, v0, 6, 2
    v_lshlrev_b32 v13, 11, v47
    v_bfe_u32 v47, v0, 0, 6
    v_lshl_add_u32 v13, v47, 4, v13
    v_add_u32 v13, 20480, v13
    v_bfe_u32 v47, v0, 3, 1
    v_lshlrev_b32 v14, 10, v47
    v_bfe_u32 v47, v0, 1, 2
    v_lshl_add_u32 v14, v47, 8, v14
    v_bfe_u32 v47, v0, 4, 4
    v_lshl_add_u32 v14, v47, 4, v14
    v_bfe_u32 v47, v0, 0, 1
    v_lshl_add_u32 v14, v47, 3, v14
    v_add_u32 v14, 20480, v14
    v_bfe_u32 v47, v0, 4, 4
    v_lshlrev_b32 v15, 10, v47
    v_bfe_u32 v47, v0, 0, 4
    v_lshl_add_u32 v15, v47, 2, v15
    v_bfe_u32 v47, v0, 4, 4
    v_lshlrev_b32 v36, 11, v47
    v_bfe_u32 v47, v0, 0, 4
    v_lshl_add_u32 v36, v47, 2, v36
    s_sub_u32 s50, s3, 4
    s_bfe_u32 s52, s50, 0x30000
    s_lshl_b32 s52, s52, 20
    s_bfe_u32 s49, s14, 0x10000
    s_lshl_b32 s49, s49, 13
    s_add_u32 s52, s52, s49
    s_bfe_u32 s49, s15, 0x10001
    s_lshl_b32 s49, s49, 12
    s_add_u32 s52, s52, s49
    s_bfe_u32 s49, s14, 0x40001
    s_lshl_b32 s49, s49, 8
    s_add_u32 s52, s52, s49
    s_bfe_u32 s49, s15, 0x10000
    s_lshl_b32 s49, s49, 7
    s_add_u32 s52, s52, s49
    s_add_u32 s52, s52, 0x8000000
    s_add_u32 s54, s52, 262144
    s_bfe_u32 s53, s50, 0x30000
    s_lshl_b32 s53, s53, 20
    s_bfe_u32 s49, s14, 0x50000
    s_lshl_b32 s49, s49, 14
    s_add_u32 s53, s53, s49
    s_bfe_u32 s49, s15, 0x20000
    s_lshl_b32 s49, s49, 12
    s_add_u32 s53, s53, s49
    s_add_u32 s53, s53, 0x8000000
    s_bfe_u32 s57, s50, 0x30000
    s_lshl_b32 s57, s57, 18
    s_add_u32 s57, s57, 0x7c00000
    s_bfe_u32 s58, s50, 0x30000
    s_lshl_b32 s58, s58, 18
    s_bfe_u32 s49, s14, 0x50000
    s_lshl_b32 s49, s49, 11
    s_add_u32 s58, s58, s49
    s_add_u32 s58, s58, 0x7c00000
    s_bfe_u32 s69, s50, 0x30000
    s_lshl_b32 s69, s69, 18
    s_bfe_u32 s49, s14, 0x10000
    s_lshl_b32 s49, s49, 15
    s_add_u32 s69, s69, s49
    s_bfe_u32 s49, s14, 0x40001
    s_lshl_b32 s49, s49, 6
    s_add_u32 s69, s69, s49
    s_add_u32 s69, s69, 0x7c00400
    s_bfe_u32 s59, s50, 0x30000
    s_lshl_b32 s59, s59, 19
    s_bfe_u32 s49, s14, 0x50000
    s_lshl_b32 s49, s49, 11
    s_add_u32 s59, s59, s49
    s_bfe_u32 s49, s15, 0x10001
    s_lshl_b32 s49, s49, 10
    s_add_u32 s59, s59, s49
    s_bfe_u32 s49, s15, 0x10000
    s_lshl_b32 s49, s49, 3
    s_add_u32 s59, s59, s49
    s_add_u32 s59, s59, 0x7800000
    s_and_b32 s48, s14, 1
    s_mul_i32 s48, s48, 57344
    s_mul_i32 s51, s15, 14336
    s_add_u32 s48, s48, s51
    s_bfe_u32 s60, s50, 0x30000
    s_lshl_b32 s60, s60, 19
    s_add_u32 s60, s60, 0x7800000
    s_add_u32 s60, s60, s48
    v_bfe_u32 v47, v0, 3, 3
    v_lshlrev_b32 v60, 10, v47
    v_bfe_u32 v47, v0, 0, 3
    v_lshlrev_b32 v61, 4, v47
    v_bfe_u32 v47, v0, 4, 2
    v_lshlrev_b32 v62, 5, v47
    v_xor_b32 v62, v61, v62
    v_add_u32 v66, v60, v62
    v_bfe_u32 v47, v0, 6, 2
    v_lshlrev_b32 v67, 15, v47
    v_bfe_u32 v47, v0, 2, 4
    v_lshl_add_u32 v67, v47, 7, v67
    v_bfe_u32 v47, v0, 1, 1
    v_lshl_add_u32 v67, v47, 4, v67
    v_bfe_u32 v47, v0, 3, 2
    v_lshl_add_u32 v67, v47, 5, v67
    v_bfe_u32 v47, v0, 0, 1
    v_lshl_add_u32 v67, v47, 3, v67
    v_bfe_u32 v47, v0, 2, 4
    v_lshlrev_b32 v60, 10, v47
    v_bfe_u32 v47, v0, 0, 2
    v_lshlrev_b32 v62, 4, v47
    v_bfe_u32 v47, v0, 4, 1
    v_lshlrev_b32 v63, 5, v47
    v_xor_b32 v62, v62, v63
    v_add_u32 v68, v60, v62
    v_bfe_u32 v47, v0, 6, 2
    v_lshlrev_b32 v69, 15, v47
    v_bfe_u32 v47, v0, 2, 4
    v_lshl_add_u32 v69, v47, 6, v69
    v_bfe_u32 v47, v0, 1, 1
    v_lshl_add_u32 v69, v47, 4, v69
    v_bfe_u32 v47, v0, 4, 1
    v_lshl_add_u32 v69, v47, 5, v69
    v_bfe_u32 v47, v0, 0, 1
    v_lshl_add_u32 v69, v47, 3, v69
    v_xor_b32 v70, 32, v69
    v_bfe_u32 v60, v0, 3, 3
    v_mul_u32_u24 v60, 3584, v60
    v_xor_b32 v62, v61, v63
    v_add_u32 v71, v60, v62
    v_xor_b32 v62, 64, v62
    v_add_u32 v72, v60, v62
    v_bfe_u32 v47, v0, 4, 2
    v_lshlrev_b32 v60, 10, v47
    v_bfe_u32 v47, v0, 2, 2
    v_lshl_add_u32 v60, v47, 7, v60
    v_bfe_u32 v47, v0, 0, 1
    v_lshl_add_u32 v60, v47, 3, v60
    v_bfe_u32 v47, v0, 6, 2
    v_lshlrev_b32 v62, 5, v47
    v_bfe_u32 v47, v0, 1, 1
    v_lshl_add_u32 v62, v47, 4, v62
    v_bfe_u32 v47, v0, 3, 1
    v_lshlrev_b32 v63, 5, v47
    v_bfe_u32 v47, v0, 4, 1
    v_lshl_add_u32 v63, v47, 6, v63
    v_xor_b32 v62, v62, v63
    v_add_u32 v73, v60, v62
    v_add_u32 v74, 0x10000, v73
    s_bfe_u32 s76, s15, 0x20000
    s_lshl_b32 s76, s76, 15
    s_bfe_u32 s77, s14, 0x40001
    s_lshl_b32 s77, s77, 18
    s_bfe_u32 s49, s14, 0x10000
    s_lshl_b32 s49, s49, 9
    s_add_u32 s77, s77, s49
    s_bfe_u32 s49, s15, 0x20000
    s_lshl_b32 s49, s49, 7
    s_add_u32 s77, s77, s49
    s_mul_i32 s78, s15, 458752
    s_bfe_u32 s48, s14, 0x40001
    s_lshl_b32 s48, s48, 6
    s_add_u32 s78, s78, s48
    s_mul_i32 s79, s15, 458752
    s_min_u32 s48, s14, 27
    s_lshl_b32 s48, s48, 7
    s_add_u32 s79, s79, s48
    s_cmp_lg_u32 s75, 0
    s_cbranch_scc1 T_nw
    s_sleep 64
    s_sleep 64
    s_or_b32 s48, s75, s15
    s_cbranch_scc1 cl_17
    s_lshl_b32 s48, s3, 2
    s_add_u32 s48, s48, 60
    s_cmp_eq_u32 s3, 0
    s_cselect_b32 s48, 0, s48
    s_lshl_b32 s49, 1, s14
    v_mov_b32 v124, s48
    v_mov_b32 v125, s49
    s_mov_b64 exec, 1
    global_atomic_or v126, v124, v125, s[12:13] sc0
    s_mov_b64 exec, -1
cl_17:
    s_cmp_lg_u32 s75, 0
    s_cbranch_scc1 vc_18_done
    v_mov_b32 v125, 163776
    s_cmp_lg_u32 s15, 0
    s_cbranch_scc1 vc_18_w
    s_waitcnt vmcnt(0)
    s_mov_b64 exec, 1
    ds_write_b32 v125, v126
    s_mov_b64 exec, -1
    s_waitcnt lgkmcnt(0)
vc_18_w:
    s_barrier
    ds_read_b32 v124, v125
    s_waitcnt lgkmcnt(0)
    v_readfirstlane_b32 s48, v124
    s_mov_b32 s75, 1
    s_nop 2
    s_bitcmp1_b32 s48, s14
    s_cbranch_scc1 L_overflow
vc_18_done:
    s_cmp_ge_u32 s3, 8
    s_cselect_b32 s50, 40, 32
    s_lshl_b32 s50, s50, 2
    s_cmp_lg_u32 s15, 0
    s_cbranch_scc1 dw_19_ok
    v_mov_b32 v44, s50
    s_mov_b32 s49, 0
    s_mov_b64 exec, 1
dw_19:
    global_load_dword v45, v44, s[12:13] offset:0 sc1
    s_waitcnt vmcnt(0)
    v_readfirstlane_b32 s48, v45
    s_cmp_ge_u32 s48, 32
    s_cbranch_scc1 dw_19_x
    s_sleep 40
    s_add_u32 s49, s49, 1
    s_cmp_lt_u32 s49, 10
    s_cbranch_scc1 dw_19
dw_19_x:
    s_mov_b64 exec, -1
dw_19_ok:
    s_barrier
T_nw:
    s_waitcnt lgkmcnt(0)
    s_mov_b32 s8, s34
    s_and_b32 s9, s35, 0xffff
    s_mov_b32 s10, 0x400000
    s_mov_b32 s11, 0x00020000
    s_add_u32 m0, s76, 0
    s_add_u32 s48, s77, 0
    buffer_load_dwordx4 v66, s[8:11], s48 offen lds
    s_waitcnt vmcnt(5)
    s_add_u32 m0, s76, 1024
    s_add_u32 s48, s77, 8192
    buffer_load_dwordx4 v66, s[8:11], s48 offen lds
    s_waitcnt vmcnt(5)
    s_add_u32 m0, s76, 2048
    s_add_u32 s48, s77, 16384
    buffer_load_dwordx4 v66, s[8:11], s48 offen lds
    s_waitcnt vmcnt(5)
    s_add_u32 m0, s76, 3072
    s_add_u32 s48, s77, 24576
    buffer_load_dwordx4 v66, s[8:11], s48 offen lds
    s_waitcnt vmcnt(5)
    s_add_u32 m0, s76, 4096
    s_add_u32 s48, s77, 32768
    buffer_load_dwordx4 v66, s[8:11], s48 offen lds
    s_waitcnt vmcnt(5)
    s_add_u32 m0, s76, 5120
    s_add_u32 s48, s77, 40960
    buffer_load_dwordx4 v66, s[8:11], s48 offen lds
    s_waitcnt vmcnt(5)
    s_add_u32 m0, s76, 6144
    s_add_u32 s48, s77, 49152
    buffer_load_dwordx4 v66, s[8:11], s48 offen lds
    s_waitcnt vmcnt(5)
    s_add_u32 m0, s76, 7168
    s_add_u32 s48, s77, 57344
    buffer_load_dwordx4 v66, s[8:11], s48 offen lds
    s_waitcnt vmcnt(5)
    s_add_u32 m0, s76, 8192
    s_add_u32 s48, s77, 65536
    buffer_load_dwordx4 v66, s[8:11], s48 offen lds
    s_waitcnt vmcnt(5)
    s_add_u32 m0, s76, 9216
    s_add_u32 s48, s77, 73728
    buffer_load_dwordx4 v66, s[8:11], s48 offen lds
    s_waitcnt vmcnt(5)
    s_add_u32 m0, s76, 10240
    s_add_u32 s48, s77, 81920
    buffer_load_dwordx4 v66, s[8:11], s48 offen lds
    s_waitcnt vmcnt(5)
    s_add_u32 m0, s76, 11264
    s_add_u32 s48, s77, 90112
    buffer_load_dwordx4 v66, s[8:11], s48 offen lds
    s_waitcnt vmcnt(5)
    s_add_u32 m0, s76, 12288
    s_add_u32 s48, s77, 98304
    buffer_load_dwordx4 v66, s[8:11], s48 offen lds
    s_waitcnt vmcnt(5)
    s_add_u32 m0, s76, 13312
    s_add_u32 s48, s77, 106496
    buffer_load_dwordx4 v66, s[8:11], s48 offen lds
    s_waitcnt vmcnt(5)
    s_add_u32 m0, s76, 14336
    s_add_u32 s48, s77, 114688
    buffer_load_dwordx4 v66, s[8:11], s48 offen lds
    s_waitcnt vmcnt(5)
    s_add_u32 m0, s76, 15360
    s_add_u32 s48, s77, 122880
    buffer_load_dwordx4 v66, s[8:11], s48 offen lds
    s_waitcnt vmcnt(5)
    s_mov_b32 s8, s34
    s_and_b32 s9, s35, 0xffff
    s_mov_b32 s10, 0x400000
    s_mov_b32 s11, 0x00020000
    s_add_u32 m0, s76, 16384
    s_add_u32 s48, s77, 131072
    buffer_load_dwordx4 v66, s[8:11], s48 offen lds
    s_waitcnt vmcnt(5)
    s_add_u32 m0, s76, 17408
    s_add_u32 s48, s77, 139264
    buffer_load_dwordx4 v66, s[8:11], s48 offen lds
    s_waitcnt vmcnt(5)
    s_add_u32 m0, s76, 18432
    s_add_u32 s48, s77, 147456
    buffer_load_dwordx4 v66, s[8:11], s48 offen lds
    s_waitcnt vmcnt(5)
    s_add_u32 m0, s76, 19456
    s_add_u32 s48, s77, 155648
    buffer_load_dwordx4 v66, s[8:11], s48 offen lds
    s_waitcnt vmcnt(5)
    s_add_u32 m0, s76, 20480
    s_add_u32 s48, s77, 163840
    buffer_load_dwordx4 v66, s[8:11], s48 offen lds
    s_waitcnt vmcnt(5)
    s_add_u32 m0, s76, 21504
    s_add_u32 s48, s77, 172032
    buffer_load_dwordx4 v66, s[8:11], s48 offen lds
    s_waitcnt vmcnt(5)
    s_add_u32 m0, s76, 22528
    s_add_u32 s48, s77, 180224
    buffer_load_dwordx4 v66, s[8:11], s48 offen lds
    s_waitcnt vmcnt(5)
    s_add_u32 m0, s76, 23552
    s_add_u32 s48, s77, 188416
    buffer_load_dwordx4 v66, s[8:11], s48 offen lds
    s_waitcnt vmcnt(5)
    s_add_u32 m0, s76, 24576
    s_add_u32 s48, s77, 196608
    buffer_load_dwordx4 v66, s[8:11], s48 offen lds
    s_waitcnt vmcnt(5)
    s_add_u32 m0, s76, 25600
    s_add_u32 s48, s77, 204800
    buffer_load_dwordx4 v66, s[8:11], s48 offen lds
    s_waitcnt vmcnt(5)
    s_add_u32 m0, s76, 26624
    s_add_u32 s48, s77, 212992
    buffer_load_dwordx4 v66, s[8:11], s48 offen lds
    s_waitcnt vmcnt(5)
    s_add_u32 m0, s76, 27648
    s_add_u32 s48, s77, 221184
    buffer_load_dwordx4 v66, s[8:11], s48 offen lds
    s_waitcnt vmcnt(5)
    s_add_u32 m0, s76, 28672
    s_add_u32 s48, s77, 229376
    buffer_load_dwordx4 v66, s[8:11], s48 offen lds
    s_waitcnt vmcnt(5)
    s_add_u32 m0, s76, 29696
    s_add_u32 s48, s77, 237568
    buffer_load_dwordx4 v66, s[8:11], s48 offen lds
    s_waitcnt vmcnt(5)
    s_add_u32 m0, s76, 30720
    s_add_u32 s48, s77, 245760
    buffer_load_dwordx4 v66, s[8:11], s48 offen lds
    s_waitcnt vmcnt(5)
    s_add_u32 m0, s76, 31744
    s_add_u32 s48, s77, 253952
    buffer_load_dwordx4 v66, s[8:11], s48 offen lds
    s_waitcnt vmcnt(5)
    s_waitcnt vmcnt(16)
    v_xor_b32 v65, 0, v67
    ds_read_b64_tr_b16 a[0:1], v65 offset:0
    ds_read_b64_tr_b16 a[2:3], v65 offset:2048
    ds_read_b64_tr_b16 a[4:5], v65 offset:4096
    ds_read_b64_tr_b16 a[6:7], v65 offset:6144
    ds_read_b64_tr_b16 a[8:9], v65 offset:8192
    ds_read_b64_tr_b16 a[10:11], v65 offset:10240
    ds_read_b64_tr_b16 a[12:13], v65 offset:12288
    ds_read_b64_tr_b16 a[14:15], v65 offset:14336
    v_xor_b32 v65, 32, v67
    ds_read_b64_tr_b16 a[32:33], v65 offset:0
    ds_read_b64_tr_b16 a[34:35], v65 offset:2048
    ds_read_b64_tr_b16 a[36:37], v65 offset:4096
    ds_read_b64_tr_b16 a[38:39], v65 offset:6144
    ds_read_b64_tr_b16 a[40:41], v65 offset:8192
    ds_read_b64_tr_b16 a[42:43], v65 offset:10240
    ds_read_b64_tr_b16 a[44:45], v65 offset:12288
    ds_read_b64_tr_b16 a[46:47], v65 offset:14336
    v_xor_b32 v65, 64, v67
    ds_read_b64_tr_b16 a[64:65], v65 offset:0
    ds_read_b64_tr_b16 a[66:67], v65 offset:2048
    ds_read_b64_tr_b16 a[68:69], v65 offset:4096
    ds_read_b64_tr_b16 a[70:71], v65 offset:6144
    ds_read_b64_tr_b16 a[72:73], v65 offset:8192
    ds_read_b64_tr_b16 a[74:75], v65 offset:10240
    ds_read_b64_tr_b16 a[76:77], v65 offset:12288
    ds_read_b64_tr_b16 a[78:79], v65 offset:14336
    v_xor_b32 v65, 96, v67
    ds_read_b64_tr_b16 a[96:97], v65 offset:0
    ds_read_b64_tr_b16 a[98:99], v65 offset:2048
    ds_read_b64_tr_b16 a[100:101], v65 offset:4096
    ds_read_b64_tr_b16 a[102:103], v65 offset:6144
    ds_read_b64_tr_b16 a[104:105], v65 offset:8192
    ds_read_b64_tr_b16 a[106:107], v65 offset:10240
    ds_read_b64_tr_b16 a[108:109], v65 offset:12288
    ds_read_b64_tr_b16 a[110:111], v65 offset:14336
    s_waitcnt lgkmcnt(0)
    s_mov_b32 s8, s40
    s_and_b32 s9, s41, 0xffff
    s_mov_b32 s10, 0x1c0000
    s_mov_b32 s11, 0x00020000
    s_add_u32 m0, s76, 0
    s_add_u32 s48, s78, 0
    buffer_load_dwordx4 v68, s[8:11], s48 offen lds
    s_waitcnt vmcnt(5)
    s_add_u32 m0, s76, 1024
    s_add_u32 s48, s78, 16384
    buffer_load_dwordx4 v68, s[8:11], s48 offen lds
    s_waitcnt vmcnt(5)
    s_add_u32 m0, s76, 2048
    s_add_u32 s48, s78, 32768
    buffer_load_dwordx4 v68, s[8:11], s48 offen lds
    s_waitcnt vmcnt(5)
    s_add_u32 m0, s76, 3072
    s_add_u32 s48, s78, 49152
    buffer_load_dwordx4 v68, s[8:11], s48 offen lds
    s_waitcnt vmcnt(5)
    s_add_u32 m0, s76, 4096
    s_add_u32 s48, s78, 65536
    buffer_load_dwordx4 v68, s[8:11], s48 offen lds
    s_waitcnt vmcnt(5)
    s_add_u32 m0, s76, 5120
    s_add_u32 s48, s78, 81920
    buffer_load_dwordx4 v68, s[8:11], s48 offen lds
    s_waitcnt vmcnt(5)
    s_add_u32 m0, s76, 6144
    s_add_u32 s48, s78, 98304
    buffer_load_dwordx4 v68, s[8:11], s48 offen lds
    s_waitcnt vmcnt(5)
    s_add_u32 m0, s76, 7168
    s_add_u32 s48, s78, 114688
    buffer_load_dwordx4 v68, s[8:11], s48 offen lds
    s_waitcnt vmcnt(5)
    s_add_u32 m0, s76, 8192
    s_add_u32 s48, s78, 131072
    buffer_load_dwordx4 v68, s[8:11], s48 offen lds
    s_waitcnt vmcnt(5)
    s_add_u32 m0, s76, 9216
    s_add_u32 s48, s78, 147456
    buffer_load_dwordx4 v68, s[8:11], s48 offen lds
    s_waitcnt vmcnt(5)
    s_add_u32 m0, s76, 10240
    s_add_u32 s48, s78, 163840
    buffer_load_dwordx4 v68, s[8:11], s48 offen lds
    s_waitcnt vmcnt(5)
    s_add_u32 m0, s76, 11264
    s_add_u32 s48, s78, 180224
    buffer_load_dwordx4 v68, s[8:11], s48 offen lds
    s_waitcnt vmcnt(5)
    s_add_u32 m0, s76, 12288
    s_add_u32 s48, s78, 196608
    buffer_load_dwordx4 v68, s[8:11], s48 offen lds
    s_waitcnt vmcnt(5)
    s_add_u32 m0, s76, 13312
    s_add_u32 s48, s78, 212992
    buffer_load_dwordx4 v68, s[8:11], s48 offen lds
    s_waitcnt vmcnt(5)
    s_add_u32 m0, s76, 14336
    s_add_u32 s48, s78, 229376
    buffer_load_dwordx4 v68, s[8:11], s48 offen lds
    s_waitcnt vmcnt(5)
    s_add_u32 m0, s76, 15360
    s_add_u32 s48, s78, 245760
    buffer_load_dwordx4 v68, s[8:11], s48 offen lds
    s_waitcnt vmcnt(5)
    s_waitcnt vmcnt(16)
    v_xor_b32 v65, 0, v67
    ds_read_b64_tr_b16 a[16:17], v65 offset:16384
    ds_read_b64_tr_b16 a[18:19], v65 offset:18432
    ds_read_b64_tr_b16 a[20:21], v65 offset:20480
    ds_read_b64_tr_b16 a[22:23], v65 offset:22528
    ds_read_b64_tr_b16 a[24:25], v65 offset:24576
    ds_read_b64_tr_b16 a[26:27], v65 offset:26624
    ds_read_b64_tr_b16 a[28:29], v65 offset:28672
    ds_read_b64_tr_b16 a[30:31], v65 offset:30720
    v_xor_b32 v65, 32, v67
    ds_read_b64_tr_b16 a[48:49], v65 offset:16384
    ds_read_b64_tr_b16 a[50:51], v65 offset:18432
    ds_read_b64_tr_b16 a[52:53], v65 offset:20480
    ds_read_b64_tr_b16 a[54:55], v65 offset:22528
    ds_read_b64_tr_b16 a[56:57], v65 offset:24576
    ds_read_b64_tr_b16 a[58:59], v65 offset:26624
    ds_read_b64_tr_b16 a[60:61], v65 offset:28672
    ds_read_b64_tr_b16 a[62:63], v65 offset:30720
    v_xor_b32 v65, 64, v67
    ds_read_b64_tr_b16 a[80:81], v65 offset:16384
    ds_read_b64_tr_b16 a[82:83], v65 offset:18432
    ds_read_b64_tr_b16 a[84:85], v65 offset:20480
    ds_read_b64_tr_b16 a[86:87], v65 offset:22528
    ds_read_b64_tr_b16 a[88:89], v65 offset:24576
    ds_read_b64_tr_b16 a[90:91], v65 offset:26624
    ds_read_b64_tr_b16 a[92:93], v65 offset:28672
    ds_read_b64_tr_b16 a[94:95], v65 offset:30720
    v_xor_b32 v65, 96, v67
    ds_read_b64_tr_b16 a[112:113], v65 offset:16384
    ds_read_b64_tr_b16 a[114:115], v65 offset:18432
    ds_read_b64_tr_b16 a[116:117], v65 offset:20480
    ds_read_b64_tr_b16 a[118:119], v65 offset:22528
    ds_read_b64_tr_b16 a[120:121], v65 offset:24576
    ds_read_b64_tr_b16 a[122:123], v65 offset:26624
    ds_read_b64_tr_b16 a[124:125], v65 offset:28672
    ds_read_b64_tr_b16 a[126:127], v65 offset:30720
    s_waitcnt lgkmcnt(0)
    s_mov_b32 s8, s40
    s_and_b32 s9, s41, 0xffff
    s_mov_b32 s10, 0x1c0000
    s_mov_b32 s11, 0x00020000
    s_add_u32 m0, s76, 16384
    s_add_u32 s48, s78, 262144
    buffer_load_dwordx4 v68, s[8:11], s48 offen lds
    s_waitcnt vmcnt(5)
    s_add_u32 m0, s76, 17408
    s_add_u32 s48, s78, 278528
    buffer_load_dwordx4 v68, s[8:11], s48 offen lds
    s_waitcnt vmcnt(5)
    s_add_u32 m0, s76, 18432
    s_add_u32 s48, s78, 294912
    buffer_load_dwordx4 v68, s[8:11], s48 offen lds
    s_waitcnt vmcnt(5)
    s_add_u32 m0, s76, 19456
    s_add_u32 s48, s78, 311296
    buffer_load_dwordx4 v68, s[8:11], s48 offen lds
    s_waitcnt vmcnt(5)
    s_add_u32 m0, s76, 20480
    s_add_u32 s48, s78, 327680
    buffer_load_dwordx4 v68, s[8:11], s48 offen lds
    s_waitcnt vmcnt(5)
    s_add_u32 m0, s76, 21504
    s_add_u32 s48, s78, 344064
    buffer_load_dwordx4 v68, s[8:11], s48 offen lds
    s_waitcnt vmcnt(5)
    s_add_u32 m0, s76, 22528
    s_add_u32 s48, s78, 360448
    buffer_load_dwordx4 v68, s[8:11], s48 offen lds
    s_waitcnt vmcnt(5)
    s_add_u32 m0, s76, 23552
    s_add_u32 s48, s78, 376832
    buffer_load_dwordx4 v68, s[8:11], s48 offen lds
    s_waitcnt vmcnt(5)
    s_add_u32 m0, s76, 24576
    s_add_u32 s48, s78, 393216
    buffer_load_dwordx4 v68, s[8:11], s48 offen lds
    s_waitcnt vmcnt(5)
    s_add_u32 m0, s76, 25600
    s_add_u32 s48, s78, 409600
    buffer_load_dwordx4 v68, s[8:11], s48 offen lds
    s_waitcnt vmcnt(5)
    s_add_u32 m0, s76, 26624
    s_add_u32 s48, s78, 425984
    buffer_load_dwordx4 v68, s[8:11], s48 offen lds
    s_waitcnt vmcnt(5)
    s_add_u32 m0, s76, 27648
    s_add_u32 s48, s78, 442368
    buffer_load_dwordx4 v68, s[8:11], s48 offen lds
    s_waitcnt vmcnt(5)
    s_waitcnt vmcnt(12)
    ds_read_b64_tr_b16 v[144:145], v69 offset:0
    ds_read_b64_tr_b16 v[146:147], v69 offset:1024
    ds_read_b64_tr_b16 v[148:149], v69 offset:2048
    ds_read_b64_tr_b16 v[150:151], v69 offset:3072
    ds_read_b64_tr_b16 v[152:153], v69 offset:4096
    ds_read_b64_tr_b16 v[154:155], v69 offset:5120
    ds_read_b64_tr_b16 v[156:157], v69 offset:6144
    ds_read_b64_tr_b16 v[158:159], v69 offset:7168
    ds_read_b64_tr_b16 v[160:161], v69 offset:8192
    ds_read_b64_tr_b16 v[162:163], v69 offset:9216
    ds_read_b64_tr_b16 v[164:165], v69 offset:10240
    ds_read_b64_tr_b16 v[166:167], v69 offset:11264
    ds_read_b64_tr_b16 v[168:169], v69 offset:12288
    ds_read_b64_tr_b16 v[170:171], v69 offset:13312
    ds_read_b64_tr_b16 v[172:173], v69 offset:14336
    ds_read_b64_tr_b16 v[174:175], v69 offset:15360
    ds_read_b64_tr_b16 v[200:201], v70 offset:0
    ds_read_b64_tr_b16 v[202:203], v70 offset:1024
    ds_read_b64_tr_b16 v[204:205], v70 offset:2048
    ds_read_b64_tr_b16 v[206:207], v70 offset:3072
    ds_read_b64_tr_b16 v[208:209], v70 offset:4096
    ds_read_b64_tr_b16 v[210:211], v70 offset:5120
    ds_read_b64_tr_b16 v[212:213], v70 offset:6144
    ds_read_b64_tr_b16 v[214:215], v70 offset:7168
    ds_read_b64_tr_b16 v[216:217], v70 offset:8192
    ds_read_b64_tr_b16 v[218:219], v70 offset:9216
    ds_read_b64_tr_b16 v[220:221], v70 offset:10240
    ds_read_b64_tr_b16 v[222:223], v70 offset:11264
    ds_read_b64_tr_b16 v[224:225], v70 offset:12288
    ds_read_b64_tr_b16 v[226:227], v70 offset:13312
    ds_read_b64_tr_b16 v[228:229], v70 offset:14336
    ds_read_b64_tr_b16 v[230:231], v70 offset:15360
    s_waitcnt lgkmcnt(0)
    s_mov_b32 s8, s36
    s_and_b32 s9, s37, 0xffff
    s_mov_b32 s10, 0x1c0000
    s_mov_b32 s11, 0x00020000
    s_add_u32 m0, s76, 0
    s_add_u32 s48, s79, 0
    buffer_load_dwordx4 v71, s[8:11], s48 offen lds
    s_waitcnt vmcnt(5)
    s_add_u32 m0, s76, 1024
    s_add_u32 s48, s79, 28672
    buffer_load_dwordx4 v72, s[8:11], s48 offen lds
    s_waitcnt vmcnt(5)
    s_add_u32 m0, s76, 2048
    s_add_u32 s48, s79, 57344
    buffer_load_dwordx4 v71, s[8:11], s48 offen lds
    s_waitcnt vmcnt(5)
    s_add_u32 m0, s76, 3072
    s_add_u32 s48, s79, 86016
    buffer_load_dwordx4 v72, s[8:11], s48 offen lds
    s_waitcnt vmcnt(5)
    s_add_u32 m0, s76, 4096
    s_add_u32 s48, s79, 114688
    buffer_load_dwordx4 v71, s[8:11], s48 offen lds
    s_waitcnt vmcnt(5)
    s_add_u32 m0, s76, 5120
    s_add_u32 s48, s79, 143360
    buffer_load_dwordx4 v72, s[8:11], s48 offen lds
    s_waitcnt vmcnt(5)
    s_add_u32 m0, s76, 6144
    s_add_u32 s48, s79, 172032
    buffer_load_dwordx4 v71, s[8:11], s48 offen lds
    s_waitcnt vmcnt(5)
    s_add_u32 m0, s76, 7168
    s_add_u32 s48, s79, 200704
    buffer_load_dwordx4 v72, s[8:11], s48 offen lds
    s_waitcnt vmcnt(5)
    s_add_u32 m0, s76, 8192
    s_add_u32 s48, s79, 229376
    buffer_load_dwordx4 v71, s[8:11], s48 offen lds
    s_waitcnt vmcnt(5)
    s_add_u32 m0, s76, 9216
    s_add_u32 s48, s79, 258048
    buffer_load_dwordx4 v72, s[8:11], s48 offen lds
    s_waitcnt vmcnt(5)
    s_add_u32 m0, s76, 10240
    s_add_u32 s48, s79, 286720
    buffer_load_dwordx4 v71, s[8:11], s48 offen lds
    s_waitcnt vmcnt(5)
    s_add_u32 m0, s76, 11264
    s_add_u32 s48, s79, 315392
    buffer_load_dwordx4 v72, s[8:11], s48 offen lds
    s_waitcnt vmcnt(5)
    s_add_u32 m0, s76, 12288
    s_add_u32 s48, s79, 344064
    buffer_load_dwordx4 v71, s[8:11], s48 offen lds
    s_waitcnt vmcnt(5)
    s_add_u32 m0, s76, 13312
    s_add_u32 s48, s79, 372736
    buffer_load_dwordx4 v72, s[8:11], s48 offen lds
    s_waitcnt vmcnt(5)
    s_add_u32 m0, s76, 14336
    s_add_u32 s48, s79, 401408
    buffer_load_dwordx4 v71, s[8:11], s48 offen lds
    s_waitcnt vmcnt(5)
    s_add_u32 m0, s76, 15360
    s_add_u32 s48, s79, 430080
    buffer_load_dwordx4 v72, s[8:11], s48 offen lds
    s_waitcnt vmcnt(5)
    s_waitcnt vmcnt(16)
    ds_read_b64_tr_b16 v[176:177], v69 offset:16384
    ds_read_b64_tr_b16 v[178:179], v69 offset:17408
    ds_read_b64_tr_b16 v[180:181], v69 offset:18432
    ds_read_b64_tr_b16 v[182:183], v69 offset:19456
    ds_read_b64_tr_b16 v[184:185], v69 offset:20480
    ds_read_b64_tr_b16 v[186:187], v69 offset:21504
    ds_read_b64_tr_b16 v[188:189], v69 offset:22528
    ds_read_b64_tr_b16 v[190:191], v69 offset:23552
    ds_read_b64_tr_b16 v[192:193], v69 offset:24576
    ds_read_b64_tr_b16 v[194:195], v69 offset:25600
    ds_read_b64_tr_b16 v[196:197], v69 offset:26624
    ds_read_b64_tr_b16 v[198:199], v69 offset:27648
    ds_read_b64_tr_b16 v[232:233], v70 offset:16384
    ds_read_b64_tr_b16 v[234:235], v70 offset:17408
    ds_read_b64_tr_b16 v[236:237], v70 offset:18432
    ds_read_b64_tr_b16 v[238:239], v70 offset:19456
    ds_read_b64_tr_b16 v[240:241], v70 offset:20480
    ds_read_b64_tr_b16 v[242:243], v70 offset:21504
    ds_read_b64_tr_b16 v[244:245], v70 offset:22528
    ds_read_b64_tr_b16 v[246:247], v70 offset:23552
    ds_read_b64_tr_b16 v[248:249], v70 offset:24576
    ds_read_b64_tr_b16 v[250:251], v70 offset:25600
    ds_read_b64_tr_b16 v[252:253], v70 offset:26624
    ds_read_b64_tr_b16 v[254:255], v70 offset:27648
    s_waitcnt lgkmcnt(0)
    s_mov_b32 s8, s38
    s_and_b32 s9, s39, 0xffff
    s_mov_b32 s10, 0x1c0000
    s_mov_b32 s11, 0x00020000
    s_add_u32 m0, s76, 16384
    s_add_u32 s48, s79, 0
    buffer_load_dwordx4 v71, s[8:11], s48 offen lds
    s_waitcnt vmcnt(5)
    s_add_u32 m0, s76, 17408
    s_add_u32 s48, s79, 28672
    buffer_load_dwordx4 v72, s[8:11], s48 offen lds
    s_waitcnt vmcnt(5)
    s_add_u32 m0, s76, 18432
    s_add_u32 s48, s79, 57344
    buffer_load_dwordx4 v71, s[8:11], s48 offen lds
    s_waitcnt vmcnt(5)
    s_add_u32 m0, s76, 19456
    s_add_u32 s48, s79, 86016
    buffer_load_dwordx4 v72, s[8:11], s48 offen lds
    s_waitcnt vmcnt(5)
    s_add_u32 m0, s76, 20480
    s_add_u32 s48, s79, 114688
    buffer_load_dwordx4 v71, s[8:11], s48 offen lds
    s_waitcnt vmcnt(5)
    s_add_u32 m0, s76, 21504
    s_add_u32 s48, s79, 143360
    buffer_load_dwordx4 v72, s[8:11], s48 offen lds
    s_waitcnt vmcnt(5)
    s_add_u32 m0, s76, 22528
    s_add_u32 s48, s79, 172032
    buffer_load_dwordx4 v71, s[8:11], s48 offen lds
    s_waitcnt vmcnt(5)
    s_add_u32 m0, s76, 23552
    s_add_u32 s48, s79, 200704
    buffer_load_dwordx4 v72, s[8:11], s48 offen lds
    s_waitcnt vmcnt(5)
    s_add_u32 m0, s76, 24576
    s_add_u32 s48, s79, 229376
    buffer_load_dwordx4 v71, s[8:11], s48 offen lds
    s_waitcnt vmcnt(5)
    s_add_u32 m0, s76, 25600
    s_add_u32 s48, s79, 258048
    buffer_load_dwordx4 v72, s[8:11], s48 offen lds
    s_waitcnt vmcnt(5)
    s_add_u32 m0, s76, 26624
    s_add_u32 s48, s79, 286720
    buffer_load_dwordx4 v71, s[8:11], s48 offen lds
    s_waitcnt vmcnt(5)
    s_add_u32 m0, s76, 27648
    s_add_u32 s48, s79, 315392
    buffer_load_dwordx4 v72, s[8:11], s48 offen lds
    s_waitcnt vmcnt(5)
    s_add_u32 m0, s76, 28672
    s_add_u32 s48, s79, 344064
    buffer_load_dwordx4 v71, s[8:11], s48 offen lds
    s_waitcnt vmcnt(5)
    s_add_u32 m0, s76, 29696
    s_add_u32 s48, s79, 372736
    buffer_load_dwordx4 v72, s[8:11], s48 offen lds
    s_waitcnt vmcnt(5)
    s_add_u32 m0, s76, 30720
    s_add_u32 s48, s79, 401408
    buffer_load_dwordx4 v71, s[8:11], s48 offen lds
    s_waitcnt vmcnt(5)
    s_add_u32 m0, s76, 31744
    s_add_u32 s48, s79, 430080
    buffer_load_dwordx4 v72, s[8:11], s48 offen lds
    s_waitcnt vmcnt(5)
    v_mov_b32 v46, 163808
    s_cmp_lg_u32 s15, 0
    s_cbranch_scc1 T_mdw
    s_mov_b32 s74, 1
    v_mbcnt_lo_u32_b32 v44, -1, 0
    v_and_b32 v44, 31, v44
    v_lshlrev_b32 v44, 2, v44
    s_add_u32 s50, s3, 15
    s_cmp_eq_u32 s3, 0
    s_cselect_b32 s50, 0, s50
    s_mov_b32 s51, 0
md_20:
    global_load_dword v45, v44, s[12:13] sc1
    s_waitcnt vmcnt(0)
    v_readlane_b32 s48, v45, s50
    s_nop 1
    s_cmp_eq_u32 s48, -1
    s_cbranch_scc1 md_20_ok
    v_readlane_b32 s48, v45, 24
    v_readlane_b32 s49, v45, 0
    s_nop 1
    s_bcnt1_i32_b32 s49, s49
    s_add_u32 s48, s48, s49
    v_readlane_b32 s49, v45, 16
    s_nop 1
    s_bcnt1_i32_b32 s49, s49
    s_add_u32 s48, s48, s49
    v_readlane_b32 s49, v45, 17
    s_nop 1
    s_bcnt1_i32_b32 s49, s49
    s_add_u32 s48, s48, s49
    v_readlane_b32 s49, v45, 18
    s_nop 1
    s_bcnt1_i32_b32 s49, s49
    s_add_u32 s48, s48, s49
    v_readlane_b32 s49, v45, 19
    s_nop 1
    s_bcnt1_i32_b32 s49, s49
    s_add_u32 s48, s48, s49
    v_readlane_b32 s49, v45, 20
    s_nop 1
    s_bcnt1_i32_b32 s49, s49
    s_add_u32 s48, s48, s49
    v_readlane_b32 s49, v45, 21
    s_nop 1
    s_bcnt1_i32_b32 s49, s49
    s_add_u32 s48, s48, s49
    v_readlane_b32 s49, v45, 22
    s_nop 1
    s_bcnt1_i32_b32 s49, s49
    s_add_u32 s48, s48, s49
    s_cmp_ge_u32 s48, 256
    s_cbranch_scc1 T_md1
    s_sleep 32
    s_add_u32 s51, s51, 1
    s_cmp_lt_u32 s51, 50000
    s_cbranch_scc1 md_20
    s_branch T_md1
md_20_ok:
    s_mov_b32 s74, 0
T_md1:
    v_mov_b32 v45, s74
    ds_write_b32 v46, v45
T_mdw:
    s_waitcnt vmcnt(0) lgkmcnt(0)
    s_barrier
    ds_read_b32 v45, v46
    s_waitcnt lgkmcnt(0)
    v_readfirstlane_b32 s74, v45
    s_nop 3
    s_cmp_lg_u32 s74, 0
    s_cbranch_scc1 T_init1
T_init0:
    v_mov_b32 v48, -1
    v_mov_b32 v49, -1
    v_mov_b32 v52, 0
    v_mov_b32 v53, 0
    v_mov_b32 v54, 0
    v_mov_b32 v55, 0
    buffer_store_dwordx4 v[52:55], v1, s[4:7], s53 offen offset:0
    buffer_store_dwordx4 v[52:55], v1, s[4:7], s53 offen offset:1024
    buffer_store_dwordx4 v[52:55], v1, s[4:7], s53 offen offset:2048
    buffer_store_dwordx4 v[52:55], v1, s[4:7], s53 offen offset:3072
    s_add_u32 s48, s58, 0
    buffer_store_dword v48, v2, s[4:7], s48 offen
    buffer_store_dword v48, v2, s[4:7], s48 offen offset:1024
    s_add_u32 s48, s58, 65536
    buffer_store_dword v48, v2, s[4:7], s48 offen
    buffer_store_dword v48, v2, s[4:7], s48 offen offset:1024
    s_add_u32 s48, s58, 131072
    buffer_store_dword v48, v2, s[4:7], s48 offen
    buffer_store_dword v48, v2, s[4:7], s48 offen offset:1024
    s_cmp_ge_u32 s14, 28
    s_cbranch_scc1 T_nopa0
    s_add_u32 s48, s59, 0
    buffer_store_dwordx2 v[48:49], v1, s[4:7], s48 offen
    s_add_u32 s48, s59, 57344
    buffer_store_dwordx2 v[48:49], v1, s[4:7], s48 offen
    s_add_u32 s48, s59, 131072
    buffer_store_dwordx2 v[48:49], v1, s[4:7], s48 offen
    s_add_u32 s48, s59, 188416
    buffer_store_dwordx2 v[48:49], v1, s[4:7], s48 offen
    s_add_u32 s48, s59, 262144
    buffer_store_dwordx2 v[48:49], v1, s[4:7], s48 offen
    s_add_u32 s48, s59, 319488
    buffer_store_dwordx2 v[48:49], v1, s[4:7], s48 offen
T_nopa0:
    s_branch T_initd
T_init1:
    v_mov_b32 v48, -1
    v_mov_b32 v49, -1
    v_mov_b32 v52, 0
    v_mov_b32 v53, 0
    v_mov_b32 v54, 0
    v_mov_b32 v55, 0
    buffer_store_dwordx4 v[52:55], v1, s[4:7], s53 offen offset:0 sc1
    buffer_store_dwordx4 v[52:55], v1, s[4:7], s53 offen offset:1024 sc1
    buffer_store_dwordx4 v[52:55], v1, s[4:7], s53 offen offset:2048 sc1
    buffer_store_dwordx4 v[52:55], v1, s[4:7], s53 offen offset:3072 sc1
    s_add_u32 s48, s58, 0
    buffer_store_dword v48, v2, s[4:7], s48 offen sc1
    buffer_store_dword v48, v2, s[4:7], s48 offen offset:1024 sc1
    s_add_u32 s48, s58, 65536
    buffer_store_dword v48, v2, s[4:7], s48 offen sc1
    buffer_store_dword v48, v2, s[4:7], s48 offen offset:1024 sc1
    s_add_u32 s48, s58, 131072
    buffer_store_dword v48, v2, s[4:7], s48 offen sc1
    buffer_store_dword v48, v2, s[4:7], s48 offen offset:1024 sc1
    s_cmp_ge_u32 s14, 28
    s_cbranch_scc1 T_nopa1
    s_add_u32 s48, s59, 0
    buffer_store_dwordx2 v[48:49], v1, s[4:7], s48 offen sc1
    s_add_u32 s48, s59, 57344
    buffer_store_dwordx2 v[48:49], v1, s[4:7], s48 offen sc1
    s_add_u32 s48, s59, 131072
    buffer_store_dwordx2 v[48:49], v1, s[4:7], s48 offen sc1
    s_add_u32 s48, s59, 188416
    buffer_store_dwordx2 v[48:49], v1, s[4:7], s48 offen sc1
    s_add_u32 s48, s59, 262144
    buffer_store_dwordx2 v[48:49], v1, s[4:7], s48 offen sc1
    s_add_u32 s48, s59, 319488
    buffer_store_dwordx2 v[48:49], v1, s[4:7], s48 offen sc1
T_nopa1:
T_initd:
    ds_read_b64_tr_b16 a[128:129], v73 offset:0
    ds_read_b64_tr_b16 a[130:131], v73 offset:512
    ds_read_b64_tr_b16 a[132:133], v73 offset:4096
    ds_read_b64_tr_b16 a[134:135], v73 offset:4608
    ds_read_b64_tr_b16 a[136:137], v73 offset:8192
    ds_read_b64_tr_b16 a[138:139], v73 offset:8704
    ds_read_b64_tr_b16 a[140:141], v73 offset:12288
    ds_read_b64_tr_b16 a[142:143], v73 offset:12800
    ds_read_b64_tr_b16 a[144:145], v73 offset:32768
    ds_read_b64_tr_b16 a[146:147], v73 offset:33280
    ds_read_b64_tr_b16 a[148:149], v73 offset:36864
    ds_read_b64_tr_b16 a[150:151], v73 offset:37376
    ds_read_b64_tr_b16 a[152:153], v73 offset:40960
    ds_read_b64_tr_b16 a[154:155], v73 offset:41472
    ds_read_b64_tr_b16 a[156:157], v73 offset:45056
    ds_read_b64_tr_b16 a[158:159], v73 offset:45568
    ds_read_b64_tr_b16 a[160:161], v74 offset:0
    ds_read_b64_tr_b16 a[162:163], v74 offset:512
    ds_read_b64_tr_b16 a[164:165], v74 offset:4096
    ds_read_b64_tr_b16 a[166:167], v74 offset:4608
    ds_read_b64_tr_b16 a[168:169], v74 offset:8192
    ds_read_b64_tr_b16 a[170:171], v74 offset:8704
    ds_read_b64_tr_b16 a[172:173], v74 offset:12288
    ds_read_b64_tr_b16 a[174:175], v74 offset:12800
    ds_read_b64_tr_b16 a[176:177], v74 offset:32768
    ds_read_b64_tr_b16 a[178:179], v74 offset:33280
    ds_read_b64_tr_b16 a[180:181], v74 offset:36864
    ds_read_b64_tr_b16 a[182:183], v74 offset:37376
    ds_read_b64_tr_b16 a[184:185], v74 offset:40960
    ds_read_b64_tr_b16 a[186:187], v74 offset:41472
    ds_read_b64_tr_b16 a[188:189], v74 offset:45056
    ds_read_b64_tr_b16 a[190:191], v74 offset:45568
    ds_read_b64_tr_b16 a[192:193], v73 offset:16384
    ds_read_b64_tr_b16 a[194:195], v73 offset:16896
    ds_read_b64_tr_b16 a[196:197], v73 offset:20480
    ds_read_b64_tr_b16 a[198:199], v73 offset:20992
    ds_read_b64_tr_b16 a[200:201], v73 offset:24576
    ds_read_b64_tr_b16 a[202:203], v73 offset:25088
    ds_read_b64_tr_b16 a[204:205], v73 offset:28672
    ds_read_b64_tr_b16 a[206:207], v73 offset:29184
    ds_read_b64_tr_b16 a[208:209], v73 offset:49152
    ds_read_b64_tr_b16 a[210:211], v73 offset:49664
    ds_read_b64_tr_b16 a[212:213], v73 offset:53248
    ds_read_b64_tr_b16 a[214:215], v73 offset:53760
    ds_read_b64_tr_b16 a[216:217], v73 offset:57344
    ds_read_b64_tr_b16 a[218:219], v73 offset:57856
    ds_read_b64_tr_b16 a[220:221], v73 offset:61440
    ds_read_b64_tr_b16 a[222:223], v73 offset:61952
    ds_read_b64_tr_b16 a[224:225], v74 offset:16384
    ds_read_b64_tr_b16 a[226:227], v74 offset:16896
    ds_read_b64_tr_b16 a[228:229], v74 offset:20480
    ds_read_b64_tr_b16 a[230:231], v74 offset:20992
    ds_read_b64_tr_b16 a[232:233], v74 offset:24576
    ds_read_b64_tr_b16 a[234:235], v74 offset:25088
    ds_read_b64_tr_b16 a[236:237], v74 offset:28672
    ds_read_b64_tr_b16 a[238:239], v74 offset:29184
    ds_read_b64_tr_b16 a[240:241], v74 offset:49152
    ds_read_b64_tr_b16 a[242:243], v74 offset:49664
    ds_read_b64_tr_b16 a[244:245], v74 offset:53248
    ds_read_b64_tr_b16 a[246:247], v74 offset:53760
    ds_read_b64_tr_b16 a[248:249], v74 offset:57344
    ds_read_b64_tr_b16 a[250:251], v74 offset:57856
    ds_read_b64_tr_b16 a[252:253], v74 offset:61440
    ds_read_b64_tr_b16 a[254:255], v74 offset:61952
    s_waitcnt vmcnt(0) lgkmcnt(0)
    s_barrier
    s_cmp_lg_u32 s15, 0
    s_cbranch_scc1 T_noarr
    s_lshl_b32 s50, s3, 2
    v_mov_b32 v44, s50
    v_mov_b32 v45, 1
    s_mov_b64 exec, 1
    global_atomic_add v44, v45, s[12:13] offset:176
    s_mov_b64 exec, -1
T_noarr:
    s_load_dwordx2 s[32:33], s[0:1], 0
    s_load_dwordx2 s[42:43], s[0:1], 104
    s_cmp_lg_u32 s15, 0
    s_cbranch_scc1 dw_21_ok
    v_mov_b32 v44, 0
    s_mov_b32 s49, 0
    s_mov_b64 exec, 1
dw_21:
    global_load_dword v45, v44, s[12:13] offset:228 sc1
    s_waitcnt vmcnt(0)
    v_readfirstlane_b32 s48, v45
    s_cmp_ge_u32 s48, 32
    s_cbranch_scc1 dw_21_x
    s_sleep 32
    s_add_u32 s49, s49, 1
    s_cmp_lt_u32 s49, 100000
    s_cbranch_scc1 dw_21
dw_21_x:
    s_mov_b64 exec, -1
dw_21_ok:
    s_barrier
    s_mov_b32 s48, 0x7200800
    buffer_load_dword v56, v2, s[4:7], s48 offen offset:0 sc1
    buffer_load_dword v57, v2, s[4:7], s48 offen offset:2048 sc1
    buffer_load_dword v58, v2, s[4:7], s48 offen offset:1024 sc1
    v_bfe_u32 v47, v0, 0, 4
    v_lshlrev_b32 v60, 2, v47
    s_bfe_u32 s48, s14, 0x40001
    s_lshl_b32 s48, s48, 6
    s_add_u32 s48, s48, 0x7201400
    buffer_load_dword v59, v60, s[4:7], s48 offen sc1
    s_waitcnt vmcnt(0) lgkmcnt(0)
    v_lshlrev_b32 v16, 16, v56
    v_and_b32 v17, s17, v56
    v_lshlrev_b32 v18, 16, v57
    v_and_b32 v19, s17, v57
    v_lshlrev_b32 v20, 16, v58
    v_and_b32 v21, s17, v58
    v_lshlrev_b32 v22, 16, v59
    v_and_b32 v23, s17, v59
    v_add_f32 v18, 1.0, v18
    v_add_f32 v19, 1.0, v19
    v_cvt_pk_bf16_f32 v47, v18, v19
    v_lshlrev_b32 v18, 16, v47
    v_and_b32 v19, s17, v47
    s_mov_b32 s20, s32
    s_and_b32 s21, s33, 0xffff
    s_mov_b32 s22, 0x200000
    s_mov_b32 s23, 0x00020000
    s_mov_b32 s24, s42
    s_and_b32 s25, s43, 0xffff
    s_mov_b32 s26, 0x200000
    s_mov_b32 s27, 0x00020000
    v_and_b32 v60, 3, v0
    v_bfe_u32 v61, v0, 2, 2
    v_mov_b32 v62, 0x3f80
    v_mov_b32 v63, 0x3f800000
    v_cmp_eq_u32 vcc, 1, v60
    s_nop 1
    v_cndmask_b32 v62, v62, v63, vcc
    v_cmp_gt_u32 vcc, 2, v60
    s_nop 1
    v_cndmask_b32 v62, 0, v62, vcc
    v_cmp_eq_u32 vcc, 0, v61
    s_nop 1
    v_cndmask_b32 v32, 0, v62, vcc
    v_cmp_eq_u32 vcc, 1, v61
    s_nop 1
    v_cndmask_b32 v33, 0, v62, vcc
    v_cmp_eq_u32 vcc, 2, v61
    s_nop 1
    v_cndmask_b32 v34, 0, v62, vcc
    v_cmp_eq_u32 vcc, 3, v61
    s_nop 1
    v_cndmask_b32 v35, 0, v62, vcc
    v_bfe_u32 v47, v0, 6, 1
    v_lshlrev_b32 v60, 4, v47
    v_bfe_u32 v47, v0, 0, 4
    v_lshl_add_u32 v60, v47, 0, v60
    v_bfe_u32 v47, v0, 4, 2
    v_lshlrev_b32 v61, 2, v47
    v_mov_b32 v63, 0xf149f2ca
    v_add_u32 v62, 0, v61
    v_cmp_gt_u32 vcc, v62, v60
    s_nop 1
    v_cndmask_b32 v24, 0, v63, vcc
    v_add_u32 v62, 1, v61
    v_cmp_gt_u32 vcc, v62, v60
    s_nop 1
    v_cndmask_b32 v25, 0, v63, vcc
    v_add_u32 v62, 2, v61
    v_cmp_gt_u32 vcc, v62, v60
    s_nop 1
    v_cndmask_b32 v26, 0, v63, vcc
    v_add_u32 v62, 3, v61
    v_cmp_gt_u32 vcc, v62, v60
    s_nop 1
    v_cndmask_b32 v27, 0, v63, vcc
    v_add_u32 v62, 16, v61
    v_cmp_gt_u32 vcc, v62, v60
    s_nop 1
    v_cndmask_b32 v28, 0, v63, vcc
    v_add_u32 v62, 17, v61
    v_cmp_gt_u32 vcc, v62, v60
    s_nop 1
    v_cndmask_b32 v29, 0, v63, vcc
    v_add_u32 v62, 18, v61
    v_cmp_gt_u32 vcc, v62, v60
    s_nop 1
    v_cndmask_b32 v30, 0, v63, vcc
    v_add_u32 v62, 19, v61
    v_cmp_gt_u32 vcc, v62, v60
    s_nop 1
    v_cndmask_b32 v31, 0, v63, vcc
    s_sub_u32 s28, s3, 4
    s_mov_b32 s64, 64
    s_add_u32 s48, s3, 44
    s_cmp_lt_u32 s3, 4
    s_cselect_b32 s28, s48, s28
    s_bfe_u32 s50, s14, 0x40001
    s_lshl_b32 s50, s50, 1
    s_bfe_u32 s49, s15, 0x10001
    s_add_u32 s50, s50, s49
    s_mul_i32 s61, s50, 1064960
    s_bfe_u32 s48, s15, 0x10000
    s_lshl_b32 s48, s48, 13
    s_add_u32 s61, s61, s48
    s_mul_i32 s62, s50, 532480
    s_bfe_u32 s48, s15, 0x10000
    s_lshl_b32 s48, s48, 12
    s_add_u32 s48, s48, 0x4000000
    s_add_u32 s62, s62, s48
    s_bfe_u32 s72, s15, 0x20000
    s_lshl_b32 s72, s72, 13
    s_add_u32 s72, s72, 0x8000
    s_bfe_u32 s73, s15, 0x20000
    s_lshl_b32 s73, s73, 12
    s_add_u32 s73, s73, 0x10000
    s_mul_i32 s63, s50, 266240
    s_add_u32 s78, s63, 0x6000000
    s_bfe_u32 s67, s50, 0x50000
    s_lshl_b32 s67, s67, 7
    s_add_u32 s67, s67, 0x7210000
    s_bfe_u32 s65, s14, 0x50000
    s_lshl_b32 s65, s65, 10
    s_bfe_u32 s79, s14, 0x10000
    s_lshl_b32 s79, s79, 14
    s_bfe_u32 s49, s14, 0x40001
    s_lshl_b32 s49, s49, 6
    s_add_u32 s79, s79, s49
    s_lshl_b32 s48, s28, 12
    s_add_u32 s63, s78, s48
    s_lshl_b32 s48, s28, 15
    s_add_u32 s66, s79, s48
    s_mov_b32 s68, 0
    s_mov_b32 s29, 1
    s_mov_b32 s55, 0
    s_mov_b32 s56, 2
    s_mov_b32 s31, 100000
    s_mov_b32 s18, 0x3db504f3
    s_mov_b32 s19, 0x3fb8aa3b
    s_lshl_b32 s50, s3, 2
    s_cmp_lg_u32 s15, 0
    s_cbranch_scc1 dw_22_ok
    v_mov_b32 v44, s50
    s_mov_b32 s49, 0
    s_mov_b64 exec, 1
dw_22:
    global_load_dword v45, v44, s[12:13] offset:176 sc1
    s_waitcnt vmcnt(0)
    v_readfirstlane_b32 s48, v45
    s_cmp_ge_u32 s48, 32
    s_cbranch_scc1 dw_22_x
    s_sleep 24
    s_add_u32 s49, s49, 1
    s_cmp_lt_u32 s49, 100000
    s_cbranch_scc1 dw_22
dw_22_x:
    s_mov_b64 exec, -1
dw_22_ok:
    s_barrier
    s_cmp_lg_u32 s74, 0
    s_cbranch_scc1 T_slow
    s_cmp_ge_u32 s28, s64
    s_cbranch_scc1 TF_pf0_skip
    s_cmp_gt_u32 s68, s28
    s_cbranch_scc1 TF_pf0_fok
    s_mov_b32 s30, 0
TF_pf0_fl:
    s_mov_b64 exec, 3
    buffer_load_dword v45, v1, s[4:7], s67 offen sc1
    s_mov_b64 exec, -1
    s_waitcnt vmcnt(0)
    v_readlane_b32 s68, v45, 0
    v_readlane_b32 s48, v45, 1
    s_nop 1
    s_min_u32 s68, s68, s48
    s_cmp_gt_u32 s68, s28
    s_cbranch_scc1 TF_pf0_fok
    s_sleep 8
    s_add_u32 s30, s30, 1
    s_cmp_lt_u32 s30, s31
    s_cbranch_scc1 TF_pf0_fl
    s_mov_b32 s31, 1
TF_pf0_fok:
    s_lshl_b32 s48, s28, 14
    s_add_u32 s81, s61, s48
    s_lshl_b32 s48, s28, 13
    s_add_u32 s82, s62, s48
    s_lshl_b32 s48, s28, 15
    s_add_u32 s83, s65, s48
    s_add_u32 m0, s72, 0
    s_add_u32 s48, s81, 0
    buffer_load_dwordx4 v1, s[4:7], s48 offen offset:0 sc1 lds
    buffer_load_dwordx4 v1, s[4:7], s48 offen offset:1024 sc1 lds
    buffer_load_dwordx4 v1, s[4:7], s48 offen offset:2048 sc1 lds
    buffer_load_dwordx4 v1, s[4:7], s48 offen offset:3072 sc1 lds
    s_add_u32 m0, s72, 4096
    s_add_u32 s48, s81, 4096
    buffer_load_dwordx4 v1, s[4:7], s48 offen offset:0 sc1 lds
    buffer_load_dwordx4 v1, s[4:7], s48 offen offset:1024 sc1 lds
    buffer_load_dwordx4 v1, s[4:7], s48 offen offset:2048 sc1 lds
    buffer_load_dwordx4 v1, s[4:7], s48 offen offset:3072 sc1 lds
    s_mov_b32 m0, s73
    s_nop 0
    buffer_load_dwordx4 v1, s[4:7], s82 offen offset:0 sc1 lds
    buffer_load_dwordx4 v1, s[4:7], s82 offen offset:1024 sc1 lds
    buffer_load_dwordx4 v1, s[4:7], s82 offen offset:2048 sc1 lds
    buffer_load_dwordx4 v1, s[4:7], s82 offen offset:3072 sc1 lds
    buffer_load_dword v37, v2, s[20:23], s83 offen
TF_pf0_skip:
    s_cmp_ge_u32 s3, 4
    s_cselect_b32 s48, 1, s15
    s_cmp_lg_u32 s48, 0
    s_cbranch_scc1 TF_lw_ok
    s_sub_u32 s49, s63, 8192
    s_mov_b32 s30, 0
    s_mov_b64 exec, 1
TF_lw:
    buffer_load_dword v45, v1, s[4:7], s49 offen sc1
    s_waitcnt vmcnt(0)
    v_readfirstlane_b32 s48, v45
    s_cmp_lg_u32 s48, -1
    s_cbranch_scc1 TF_lw_x
    s_sleep 16
    s_add_u32 s30, s30, 1
    s_cmp_lt_u32 s30, 20000
    s_cbranch_scc1 TF_lw
TF_lw_x:
    s_mov_b64 exec, -1
TF_lw_ok:
    s_waitcnt vmcnt(0)
    s_barrier
.p2align 6
TF_loop:
    buffer_load_dwordx4 v[124:127], v1, s[4:7], s63 offen offset:0 sc1
    buffer_load_dwordx4 v[128:131], v1, s[4:7], s63 offen offset:1024 sc1
    buffer_load_dwordx4 v[132:135], v1, s[4:7], s63 offen offset:2048 sc1
    buffer_load_dwordx4 v[136:139], v1, s[4:7], s63 offen offset:3072 sc1
    ds_read_b128 v[48:51], v11 offset:0
    ds_read_b128 v[64:67], v12 offset:0
    ds_read_b128 v[80:83], v12 offset:8192
    ds_read_b128 v[52:55], v11 offset:1024
    ds_read_b128 v[68:71], v12 offset:1024
    ds_read_b128 v[84:87], v12 offset:9216
    ds_read_b128 v[56:59], v11 offset:2048
    ds_read_b128 v[72:75], v12 offset:4096
    ds_read_b128 v[88:91], v12 offset:12288
    ds_read_b128 v[60:63], v11 offset:3072
    ds_read_b128 v[76:79], v12 offset:5120
    ds_read_b128 v[92:95], v12 offset:13312
    s_waitcnt lgkmcnt(9)
    v_mfma_f32_16x16x32_bf16 v[112:115], v[64:67], v[48:51], v[24:27]
    v_mfma_f32_16x16x32_bf16 v[116:119], v[80:83], v[48:51], v[28:31]
    s_waitcnt lgkmcnt(6)
    v_mfma_f32_16x16x32_bf16 v[112:115], v[68:71], v[52:55], v[112:115]
    v_mfma_f32_16x16x32_bf16 v[116:119], v[84:87], v[52:55], v[116:119]
    s_waitcnt lgkmcnt(3)
    v_mfma_f32_16x16x32_bf16 v[112:115], v[72:75], v[56:59], v[112:115]
    v_mfma_f32_16x16x32_bf16 v[116:119], v[88:91], v[56:59], v[116:119]
    s_waitcnt lgkmcnt(0)
    v_mfma_f32_16x16x32_bf16 v[112:115], v[76:79], v[60:63], v[112:115]
    v_mfma_f32_16x16x32_bf16 v[116:119], v[92:95], v[60:63], v[116:119]
    ds_read_b128 v[64:67], v12 offset:2048
    ds_read_b128 v[68:71], v12 offset:3072
    ds_read_b128 v[72:75], v12 offset:6144
    ds_read_b128 v[76:79], v12 offset:7168
    ds_read_b128 v[80:83], v12 offset:10240
    ds_read_b128 v[84:87], v12 offset:11264
    ds_read_b128 v[88:91], v12 offset:14336
    ds_read_b128 v[92:95], v12 offset:15360
    v_cvt_pk_bf16_f32 v40, v112, v113
    v_lshlrev_b32 v112, 16, v40
    v_and_b32 v113, s17, v40
    v_cvt_pk_bf16_f32 v40, v114, v115
    v_lshlrev_b32 v114, 16, v40
    v_and_b32 v115, s17, v40
    v_cvt_pk_bf16_f32 v40, v116, v117
    v_lshlrev_b32 v116, 16, v40
    v_and_b32 v117, s17, v40
    v_cvt_pk_bf16_f32 v40, v118, v119
    v_lshlrev_b32 v118, 16, v40
    v_and_b32 v119, s17, v40
    v_mul_f32 v112, s18, v112
    v_mul_f32 v113, s18, v113
    v_mul_f32 v114, s18, v114
    v_mul_f32 v115, s18, v115
    v_mul_f32 v116, s18, v116
    v_mul_f32 v117, s18, v117
    v_mul_f32 v118, s18, v118
    v_mul_f32 v119, s18, v119
    v_cvt_pk_bf16_f32 v40, v112, v113
    v_lshlrev_b32 v112, 16, v40
    v_and_b32 v113, s17, v40
    v_cvt_pk_bf16_f32 v40, v114, v115
    v_lshlrev_b32 v114, 16, v40
    v_and_b32 v115, s17, v40
    v_cvt_pk_bf16_f32 v40, v116, v117
    v_lshlrev_b32 v116, 16, v40
    v_and_b32 v117, s17, v40
    v_cvt_pk_bf16_f32 v40, v118, v119
    v_lshlrev_b32 v118, 16, v40
    v_and_b32 v119, s17, v40
    v_max3_f32 v41, v112, v113, v114
    v_max3_f32 v39, v115, v116, v117
    v_max3_f32 v41, v41, v118, v119
    v_max_f32 v41, v41, v39
    v_mov_b32 v39, v41
    s_nop 1
    v_permlane32_swap_b32 v41, v39
    v_max_f32 v41, v41, v39
    v_mov_b32 v39, v41
    s_nop 1
    v_permlane16_swap_b32 v41, v39
    v_max_f32 v41, v41, v39
    v_mul_f32 v38, s19, v41
    v_fma_f32 v112, v112, s19, -v38
    v_fma_f32 v113, v113, s19, -v38
    v_fma_f32 v114, v114, s19, -v38
    v_fma_f32 v115, v115, s19, -v38
    v_fma_f32 v116, v116, s19, -v38
    v_fma_f32 v117, v117, s19, -v38
    v_fma_f32 v118, v118, s19, -v38
    v_fma_f32 v119, v119, s19, -v38
    v_exp_f32 v112, v112
    v_exp_f32 v113, v113
    v_exp_f32 v114, v114
    v_exp_f32 v115, v115
    v_exp_f32 v116, v116
    v_exp_f32 v117, v117
    v_exp_f32 v118, v118
    v_exp_f32 v119, v119
    v_add_f32 v46, v112, v113
    v_add_f32 v38, v114, v115
    v_add_f32 v39, v116, v117
    v_add_f32 v40, v118, v119
    v_add_f32 v46, v46, v38
    v_add_f32 v39, v39, v40
    v_add_f32 v46, v46, v39
    v_mov_b32 v45, 0
    s_mov_b32 s30, 0
TF_km:
    s_waitcnt vmcnt(0)
    v_max3_u32 v38, v124, v128, v132
    v_max_u32 v38, v38, v136
    v_cmp_eq_u32 vcc, -1, v38
    ds_write2st64_b32 v4, v125, v127 offset0:0 offset1:2
    ds_write2st64_b32 v4, v129, v131 offset0:4 offset1:6
    ds_write2st64_b32 v4, v133, v135 offset0:8 offset1:10
    ds_write2st64_b32 v4, v137, v139 offset0:12 offset1:14
    s_cbranch_vccnz TF_km_f
TF_km_ok:
    ds_read_b64_tr_b16 v[96:97], v5 offset:0
    ds_read_b64_tr_b16 v[98:99], v5 offset:512
    ds_read_b64_tr_b16 v[100:101], v5 offset:1024
    ds_read_b64_tr_b16 v[102:103], v5 offset:1536
    ds_read_b64_tr_b16 v[104:105], v5 offset:2048
    ds_read_b64_tr_b16 v[106:107], v5 offset:2560
    ds_read_b64_tr_b16 v[108:109], v5 offset:3072
    ds_read_b64_tr_b16 v[110:111], v5 offset:3584
    s_waitcnt lgkmcnt(6)
    v_mfma_f32_16x16x32_bf16 v[120:123], v[96:99], v[48:51], 0
    s_waitcnt lgkmcnt(4)
    v_mfma_f32_16x16x32_bf16 v[120:123], v[100:103], v[52:55], v[120:123]
    s_waitcnt lgkmcnt(2)
    v_mfma_f32_16x16x32_bf16 v[120:123], v[104:107], v[56:59], v[120:123]
    s_waitcnt lgkmcnt(0)
    v_mfma_f32_16x16x32_bf16 v[120:123], v[108:111], v[60:63], v[120:123]
    s_nop 7
    v_cvt_pk_bf16_f32 v40, v120, v121
    v_lshlrev_b32 v120, 16, v40
    v_and_b32 v121, s17, v40
    v_mul_f32 v120, s18, v120
    v_mul_f32 v121, s18, v121
    v_cvt_pk_bf16_f32 v40, v120, v121
    v_lshlrev_b32 v120, 16, v40
    v_and_b32 v121, s17, v40
    v_max3_f32 v38, v41, v120, v121
    v_mov_b32 v39, v38
    s_nop 1
    v_permlane32_swap_b32 v38, v39
    v_max_f32 v38, v38, v39
    v_mov_b32 v39, v38
    s_nop 1
    v_permlane16_swap_b32 v38, v39
    v_max_f32 v38, v38, v39
    v_mul_f32 v38, s19, v38
    v_fma_f32 v41, v41, s19, -v38
    v_fma_f32 v120, v120, s19, -v38
    v_fma_f32 v121, v121, s19, -v38
    v_exp_f32 v41, v41
    v_exp_f32 v120, v120
    v_exp_f32 v121, v121
    v_fma_f32 v46, v46, v41, v120
    v_add_f32 v46, v46, v121
    v_mov_b32 v39, v46
    s_nop 1
    v_permlane32_swap_b32 v46, v39
    v_add_f32 v46, v46, v39
    v_mov_b32 v39, v46
    s_nop 1
    v_permlane16_swap_b32 v46, v39
    v_add_f32 v46, v46, v39
    v_rcp_f32 v46, v46
    s_nop 0
    v_mul_f32 v42, v46, v41
    v_pk_mul_f32 v[120:121], v[120:121], v[46:47] op_sel_hi:[1,0]
    v_pk_mul_f32 v[112:113], v[112:113], v[42:43] op_sel_hi:[1,0]
    v_pk_mul_f32 v[114:115], v[114:115], v[42:43] op_sel_hi:[1,0]
    v_pk_mul_f32 v[116:117], v[116:117], v[42:43] op_sel_hi:[1,0]
    v_pk_mul_f32 v[118:119], v[118:119], v[42:43] op_sel_hi:[1,0]
    v_cvt_pk_bf16_f32 v44, v120, v121
    v_cvt_pk_bf16_f32 v140, v112, v113
    v_cvt_pk_bf16_f32 v141, v114, v115
    v_cvt_pk_bf16_f32 v142, v116, v117
    v_cvt_pk_bf16_f32 v143, v118, v119
    v_mfma_f32_16x16x16_bf16 v[96:99], v[124:125], v[44:45], 0
    v_mfma_f32_16x16x16_bf16 v[100:103], v[126:127], v[44:45], 0
    v_mfma_f32_16x16x16_bf16 v[104:107], v[128:129], v[44:45], 0
    v_mfma_f32_16x16x16_bf16 v[108:111], v[130:131], v[44:45], 0
    v_mfma_f32_16x16x16_bf16 v[48:51], v[132:133], v[44:45], 0
    v_mfma_f32_16x16x16_bf16 v[52:55], v[134:135], v[44:45], 0
    v_mfma_f32_16x16x16_bf16 v[56:59], v[136:137], v[44:45], 0
    v_mfma_f32_16x16x16_bf16 v[60:63], v[138:139], v[44:45], 0
    v_mfma_f32_16x16x32_bf16 v[96:99], v[64:67], v[140:143], v[96:99]
    v_mfma_f32_16x16x32_bf16 v[100:103], v[68:71], v[140:143], v[100:103]
    v_mfma_f32_16x16x32_bf16 v[104:107], v[72:75], v[140:143], v[104:107]
    v_mfma_f32_16x16x32_bf16 v[108:111], v[76:79], v[140:143], v[108:111]
    v_cvt_pk_bf16_f32 v112, v96, v97
    v_cvt_pk_bf16_f32 v113, v98, v99
    v_cvt_pk_bf16_f32 v114, v100, v101
    v_cvt_pk_bf16_f32 v115, v102, v103
    ds_write_b128 v9, v[112:115] offset:0
    v_mfma_f32_16x16x32_bf16 v[48:51], v[80:83], v[140:143], v[48:51]
    v_mfma_f32_16x16x32_bf16 v[52:55], v[84:87], v[140:143], v[52:55]
    v_cvt_pk_bf16_f32 v116, v104, v105
    v_cvt_pk_bf16_f32 v117, v106, v107
    v_cvt_pk_bf16_f32 v118, v108, v109
    v_cvt_pk_bf16_f32 v119, v110, v111
    ds_write_b128 v9, v[116:119] offset:1024
    v_mfma_f32_16x16x32_bf16 v[56:59], v[88:91], v[140:143], v[56:59]
    v_mfma_f32_16x16x32_bf16 v[60:63], v[92:95], v[140:143], v[60:63]
    v_cvt_pk_bf16_f32 v112, v48, v49
    v_cvt_pk_bf16_f32 v113, v50, v51
    v_cvt_pk_bf16_f32 v114, v52, v53
    v_cvt_pk_bf16_f32 v115, v54, v55
    ds_write_b128 v9, v[112:115] offset:2048
    s_nop 3
    v_cvt_pk_bf16_f32 v116, v56, v57
    v_cvt_pk_bf16_f32 v117, v58, v59
    v_cvt_pk_bf16_f32 v118, v60, v61
    v_cvt_pk_bf16_f32 v119, v62, v63
    ds_write_b128 v9, v[116:119] offset:3072
    s_waitcnt lgkmcnt(0)
    s_barrier
    ds_read_b128 v[48:51], v1 offset:0
    ds_read_b128 v[52:55], v1 offset:1024
    ds_read_b128 v[56:59], v1 offset:2048
    ds_read_b128 v[60:63], v1 offset:3072
    ds_read_b128 v[64:67], v1 offset:4096
    ds_read_b128 v[68:71], v1 offset:5120
    ds_read_b128 v[72:75], v1 offset:6144
    ds_read_b128 v[76:79], v1 offset:7168
    ds_read_b128 v[80:83], v1 offset:8192
    ds_read_b128 v[84:87], v1 offset:9216
    ds_read_b128 v[88:91], v1 offset:10240
    ds_read_b128 v[92:95], v1 offset:11264
    ds_read_b128 v[96:99], v1 offset:12288
    ds_read_b128 v[100:103], v1 offset:13312
    ds_read_b128 v[104:107], v1 offset:14336
    ds_read_b128 v[108:111], v1 offset:15360
    s_waitcnt lgkmcnt(15)
    v_mfma_f32_16x16x32_bf16 v[112:115], a[0:3], v[48:51], 0
    v_mfma_f32_16x16x32_bf16 v[116:119], a[32:35], v[48:51], 0
    s_waitcnt lgkmcnt(14)
    v_mfma_f32_16x16x32_bf16 v[112:115], a[4:7], v[52:55], v[112:115]
    v_mfma_f32_16x16x32_bf16 v[116:119], a[36:39], v[52:55], v[116:119]
    s_waitcnt lgkmcnt(13)
    v_mfma_f32_16x16x32_bf16 v[112:115], a[8:11], v[56:59], v[112:115]
    v_mfma_f32_16x16x32_bf16 v[116:119], a[40:43], v[56:59], v[116:119]
    s_waitcnt lgkmcnt(12)
    v_mfma_f32_16x16x32_bf16 v[112:115], a[12:15], v[60:63], v[112:115]
    v_mfma_f32_16x16x32_bf16 v[116:119], a[44:47], v[60:63], v[116:119]
    s_waitcnt lgkmcnt(11)
    v_mfma_f32_16x16x32_bf16 v[112:115], a[16:19], v[64:67], v[112:115]
    v_mfma_f32_16x16x32_bf16 v[116:119], a[48:51], v[64:67], v[116:119]
    s_waitcnt lgkmcnt(10)
    v_mfma_f32_16x16x32_bf16 v[112:115], a[20:23], v[68:71], v[112:115]
    v_mfma_f32_16x16x32_bf16 v[116:119], a[52:55], v[68:71], v[116:119]
    s_waitcnt lgkmcnt(9)
    v_mfma_f32_16x16x32_bf16 v[112:115], a[24:27], v[72:75], v[112:115]
    v_mfma_f32_16x16x32_bf16 v[116:119], a[56:59], v[72:75], v[116:119]
    s_waitcnt lgkmcnt(8)
    v_mfma_f32_16x16x32_bf16 v[112:115], a[28:31], v[76:79], v[112:115]
    v_mfma_f32_16x16x32_bf16 v[116:119], a[60:63], v[76:79], v[116:119]
    v_mfma_f32_16x16x32_bf16 v[120:123], a[64:67], v[48:51], 0
    v_mfma_f32_16x16x32_bf16 v[124:127], a[96:99], v[48:51], 0
    v_cvt_pk_bf16_f32 v128, v112, v113
    v_cvt_pk_bf16_f32 v129, v114, v115
    v_mfma_f32_16x16x32_bf16 v[120:123], a[68:71], v[52:55], v[120:123]
    v_cvt_pk_bf16_f32 v130, v116, v117
    v_cvt_pk_bf16_f32 v131, v118, v119
    v_mfma_f32_16x16x32_bf16 v[124:127], a[100:103], v[52:55], v[124:127]
    v_and_or_b32 v128, v128, -2, s29
    buffer_store_dwordx4 v[128:131], v3, s[4:7], s52 offen offset:0
    v_mfma_f32_16x16x32_bf16 v[120:123], a[72:75], v[56:59], v[120:123]
    v_mfma_f32_16x16x32_bf16 v[124:127], a[104:107], v[56:59], v[124:127]
    v_mfma_f32_16x16x32_bf16 v[120:123], a[76:79], v[60:63], v[120:123]
    v_mfma_f32_16x16x32_bf16 v[124:127], a[108:111], v[60:63], v[124:127]
    v_mfma_f32_16x16x32_bf16 v[120:123], a[80:83], v[64:67], v[120:123]
    v_mfma_f32_16x16x32_bf16 v[124:127], a[112:115], v[64:67], v[124:127]
    v_mfma_f32_16x16x32_bf16 v[120:123], a[84:87], v[68:71], v[120:123]
    v_mfma_f32_16x16x32_bf16 v[124:127], a[116:119], v[68:71], v[124:127]
    v_mfma_f32_16x16x32_bf16 v[120:123], a[88:91], v[72:75], v[120:123]
    v_mfma_f32_16x16x32_bf16 v[124:127], a[120:123], v[72:75], v[124:127]
    v_mfma_f32_16x16x32_bf16 v[120:123], a[92:95], v[76:79], v[120:123]
    v_mfma_f32_16x16x32_bf16 v[124:127], a[124:127], v[76:79], v[124:127]
    s_waitcnt lgkmcnt(0)
    v_mfma_f32_16x16x32_bf16 v[112:115], a[0:3], v[80:83], 0
    v_mfma_f32_16x16x32_bf16 v[116:119], a[32:35], v[80:83], 0
    v_cvt_pk_bf16_f32 v132, v120, v121
    v_cvt_pk_bf16_f32 v133, v122, v123
    v_mfma_f32_16x16x32_bf16 v[112:115], a[4:7], v[84:87], v[112:115]
    v_cvt_pk_bf16_f32 v134, v124, v125
    v_cvt_pk_bf16_f32 v135, v126, v127
    v_mfma_f32_16x16x32_bf16 v[116:119], a[36:39], v[84:87], v[116:119]
    v_and_or_b32 v132, v132, -2, s29
    buffer_store_dwordx4 v[132:135], v3, s[4:7], s52 offen offset:64
    v_mfma_f32_16x16x32_bf16 v[112:115], a[8:11], v[88:91], v[112:115]
    v_mfma_f32_16x16x32_bf16 v[116:119], a[40:43], v[88:91], v[116:119]
    v_mfma_f32_16x16x32_bf16 v[112:115], a[12:15], v[92:95], v[112:115]
    v_mfma_f32_16x16x32_bf16 v[116:119], a[44:47], v[92:95], v[116:119]
    v_mfma_f32_16x16x32_bf16 v[112:115], a[16:19], v[96:99], v[112:115]
    v_mfma_f32_16x16x32_bf16 v[116:119], a[48:51], v[96:99], v[116:119]
    v_mfma_f32_16x16x32_bf16 v[112:115], a[20:23], v[100:103], v[112:115]
    v_mfma_f32_16x16x32_bf16 v[116:119], a[52:55], v[100:103], v[116:119]
    v_mfma_f32_16x16x32_bf16 v[112:115], a[24:27], v[104:107], v[112:115]
    v_mfma_f32_16x16x32_bf16 v[116:119], a[56:59], v[104:107], v[116:119]
    v_mfma_f32_16x16x32_bf16 v[112:115], a[28:31], v[108:111], v[112:115]
    v_mfma_f32_16x16x32_bf16 v[116:119], a[60:63], v[108:111], v[116:119]
    v_mfma_f32_16x16x32_bf16 v[120:123], a[64:67], v[80:83], 0
    v_mfma_f32_16x16x32_bf16 v[124:127], a[96:99], v[80:83], 0
    v_cvt_pk_bf16_f32 v128, v112, v113
    v_cvt_pk_bf16_f32 v129, v114, v115
    v_mfma_f32_16x16x32_bf16 v[120:123], a[68:71], v[84:87], v[120:123]
    v_cvt_pk_bf16_f32 v130, v116, v117
    v_cvt_pk_bf16_f32 v131, v118, v119
    v_mfma_f32_16x16x32_bf16 v[124:127], a[100:103], v[84:87], v[124:127]
    v_and_or_b32 v128, v128, -2, s29
    buffer_store_dwordx4 v[128:131], v3, s[4:7], s54 offen offset:0
    v_mfma_f32_16x16x32_bf16 v[120:123], a[72:75], v[88:91], v[120:123]
    v_mfma_f32_16x16x32_bf16 v[124:127], a[104:107], v[88:91], v[124:127]
    v_mfma_f32_16x16x32_bf16 v[120:123], a[76:79], v[92:95], v[120:123]
    v_mfma_f32_16x16x32_bf16 v[124:127], a[108:111], v[92:95], v[124:127]
    v_mfma_f32_16x16x32_bf16 v[120:123], a[80:83], v[96:99], v[120:123]
    v_mfma_f32_16x16x32_bf16 v[124:127], a[112:115], v[96:99], v[124:127]
    v_mfma_f32_16x16x32_bf16 v[120:123], a[84:87], v[100:103], v[120:123]
    v_mfma_f32_16x16x32_bf16 v[124:127], a[116:119], v[100:103], v[124:127]
    v_mfma_f32_16x16x32_bf16 v[120:123], a[88:91], v[104:107], v[120:123]
    v_mfma_f32_16x16x32_bf16 v[124:127], a[120:123], v[104:107], v[124:127]
    v_mfma_f32_16x16x32_bf16 v[120:123], a[92:95], v[108:111], v[120:123]
    v_mfma_f32_16x16x32_bf16 v[124:127], a[124:127], v[108:111], v[124:127]
    s_nop 7
    v_cvt_pk_bf16_f32 v132, v120, v121
    v_cvt_pk_bf16_f32 v133, v122, v123
    v_cvt_pk_bf16_f32 v134, v124, v125
    v_cvt_pk_bf16_f32 v135, v126, v127
    v_and_or_b32 v132, v132, -2, s29
    buffer_store_dwordx4 v[132:135], v3, s[4:7], s54 offen offset:64
    s_sleep 3
    s_mov_b32 s30, 0
TF_r1:
    buffer_load_dwordx4 v[48:51], v1, s[4:7], s53 offen offset:0 sc1
    buffer_load_dwordx4 v[52:55], v1, s[4:7], s53 offen offset:1024 sc1
    buffer_load_dwordx4 v[56:59], v1, s[4:7], s53 offen offset:2048 sc1
    buffer_load_dwordx4 v[60:63], v1, s[4:7], s53 offen offset:3072 sc1
    s_waitcnt vmcnt(3)
    v_mfma_f32_16x16x32_bf16 v[112:115], v[32:35], v[48:51], 0
    v_xor_b32 v38, s29, v48
    s_waitcnt vmcnt(2)
    v_mfma_f32_16x16x32_bf16 v[112:115], v[32:35], v[52:55], v[112:115]
    v_xor_b32 v39, s29, v52
    v_or_b32 v38, v38, v39
    s_waitcnt vmcnt(1)
    v_mfma_f32_16x16x32_bf16 v[112:115], v[32:35], v[56:59], v[112:115]
    v_xor_b32 v39, s29, v56
    v_or_b32 v38, v38, v39
    s_waitcnt vmcnt(0)
    v_mfma_f32_16x16x32_bf16 v[112:115], v[32:35], v[60:63], v[112:115]
    v_xor_b32 v39, s29, v60
    v_or_b32 v38, v38, v39
    v_and_b32 v38, 1, v38
    v_cmp_ne_u32 vcc, 0, v38
    v_lshlrev_b32 v116, 16, v37
    v_and_b32 v117, s17, v37
    s_lshl_b32 s48, s15, 3
    v_mov_b32 v43, s48
    s_cbranch_vccnz TF_r1_f
TF_r1_ok:
    v_cvt_pk_bf16_f32 v38, v112, v113
    v_lshlrev_b32 v112, 16, v38
    v_and_b32 v113, s17, v38
    v_mul_f32 v112, v16, v112
    v_mul_f32 v113, v17, v113
    v_cvt_pk_bf16_f32 v38, v112, v113
    v_lshlrev_b32 v112, 16, v38
    v_and_b32 v113, s17, v38
    v_add_f32 v116, v116, v112
    v_add_f32 v117, v117, v113
    v_cvt_pk_bf16_f32 v118, v116, v117
    v_lshlrev_b32 v116, 16, v118
    v_and_b32 v117, s17, v118
    s_lshl_b32 s49, s55, 16
    s_add_u32 s50, s58, s49
    v_readfirstlane_b32 s51, v116
    s_nop 1
    v_subrev_f32 v112, s51, v116
    v_subrev_f32 v113, s51, v117
    v_add_f32 v120, v112, v113
    v_mul_f32 v121, v112, v112
    v_fmac_f32 v121, v113, v113
    s_nop 0
    v_add_f32_dpp v120, v120, v120 row_ror:1 row_mask:0xf bank_mask:0xf
    v_add_f32_dpp v121, v121, v121 row_ror:1 row_mask:0xf bank_mask:0xf
    s_nop 0
    v_add_f32_dpp v120, v120, v120 row_ror:2 row_mask:0xf bank_mask:0xf
    v_add_f32_dpp v121, v121, v121 row_ror:2 row_mask:0xf bank_mask:0xf
    s_nop 0
    v_add_f32_dpp v120, v120, v120 row_ror:4 row_mask:0xf bank_mask:0xf
    v_add_f32_dpp v121, v121, v121 row_ror:4 row_mask:0xf bank_mask:0xf
    s_nop 0
    v_add_f32_dpp v120, v120, v120 row_ror:8 row_mask:0xf bank_mask:0xf
    v_add_f32_dpp v121, v121, v121 row_ror:8 row_mask:0xf bank_mask:0xf
    v_mov_b32 v122, v120
    v_mov_b32 v123, v121
    s_nop 0
    v_permlane32_swap_b32 v120, v122
    v_permlane32_swap_b32 v121, v123
    v_add_f32 v120, v120, v122
    v_add_f32 v121, v121, v123
    v_mov_b32 v122, v120
    v_mov_b32 v123, v121
    s_nop 0
    v_permlane16_swap_b32 v120, v122
    v_permlane16_swap_b32 v121, v123
    v_add_f32 v120, v120, v122
    v_add_f32 v121, v121, v123
    v_mul_f32 v122, 0x3c000000, v120
    v_fma_f32 v121, -v120, v122, v121
    v_add_f32 v120, s51, v122
    ds_write_b64 v43, v[120:121] offset:16384
    v_mfma_f32_32x32x2_f32 v[80:95], v10, v10, 0
    s_waitcnt lgkmcnt(0)
    s_barrier
    ds_read_b128 v[124:127], v10 offset:16384
    ds_read_b128 v[128:131], v10 offset:16400
    v_mfma_f32_32x32x2_f32 v[80:95], v10, v10, 0
    s_waitcnt lgkmcnt(0)
    v_add_f32 v120, v124, v126
    v_add_f32 v121, v128, v130
    v_add_f32 v120, v120, v121
    v_mul_f32 v120, 0.25, v120
    v_add_f32 v122, v125, v127
    v_add_f32 v123, v129, v131
    v_add_f32 v122, v122, v123
    v_sub_f32 v124, v124, v120
    v_sub_f32 v126, v126, v120
    v_sub_f32 v128, v128, v120
    v_sub_f32 v130, v130, v120
    v_mul_f32 v123, v124, v124
    v_fmac_f32 v123, v126, v126
    v_fmac_f32 v123, v128, v128
    v_fmac_f32 v123, v130, v130
    v_mul_f32 v122, 0x3b000000, v122
    v_fmac_f32 v122, 0.25, v123
    v_cvt_pk_bf16_f32 v120, v120, v120
    v_and_b32 v120, s17, v120
    v_cvt_pk_bf16_f32 v122, v122, v122
    v_and_b32 v122, s17, v122
    v_add_f32 v122, 0x3727c5ac, v122
    v_cvt_pk_bf16_f32 v122, v122, v122
    v_and_b32 v122, s17, v122
    v_sqrt_f32 v122, v122
    v_sub_f32 v112, v116, v120
    v_sub_f32 v113, v117, v120
    v_cvt_pk_bf16_f32 v122, v122, v122
    v_and_b32 v122, s17, v122
    v_rcp_f32 v122, v122
    v_cvt_pk_bf16_f32 v38, v112, v113
    v_lshlrev_b32 v112, 16, v38
    v_and_b32 v113, s17, v38
    v_mul_f32 v112, v112, v122
    v_mul_f32 v113, v113, v122
    v_cvt_pk_bf16_f32 v38, v112, v113
    v_lshlrev_b32 v112, 16, v38
    v_and_b32 v113, s17, v38
    v_mul_f32 v112, v112, v18
    v_mul_f32 v113, v113, v19
    v_cvt_pk_bf16_f32 v38, v112, v113
    v_lshlrev_b32 v112, 16, v38
    v_and_b32 v113, s17, v38
    v_add_f32 v112, v112, v20
    v_add_f32 v113, v113, v21
    v_cvt_pk_bf16_f32 v38, v112, v113
    buffer_store_dword v38, v2, s[4:7], s50 offen
    buffer_store_dword v118, v2, s[4:7], s50 offen offset:1024
    s_lshl_b32 s48, s56, 16
    s_add_u32 s48, s58, s48
    v_mov_b32 v42, -1
    v_mov_b32 v43, -1
    buffer_store_dword v42, v2, s[4:7], s48 offen
    buffer_store_dword v42, v2, s[4:7], s48 offen offset:1024
    s_cmp_ge_u32 s28, 46
    s_cselect_b32 s48, 6, 4
    s_add_u32 s77, s28, s48
    s_lshr_b32 s48, s77, 1
    s_cmp_eq_u32 s48, 23
    s_cselect_b32 s48, 4, 0
    s_add_u32 s77, s77, s48
    s_cmp_ge_u32 s14, 28
    s_cbranch_scc1 TF_noffn
    s_add_u32 s50, s57, s49
    s_sleep 4
    s_mov_b32 s30, 0
TF_h2:
    s_add_u32 s48, s50, 0
    buffer_load_dwordx4 v[48:51], v6, s[4:7], s48 offen sc1
    s_add_u32 s48, s50, 8192
    buffer_load_dwordx4 v[52:55], v6, s[4:7], s48 offen sc1
    s_add_u32 s48, s50, 16384
    buffer_load_dwordx4 v[56:59], v6, s[4:7], s48 offen sc1
    s_add_u32 s48, s50, 24576
    buffer_load_dwordx4 v[60:63], v6, s[4:7], s48 offen sc1
    s_add_u32 s48, s50, 32768
    buffer_load_dwordx4 v[64:67], v6, s[4:7], s48 offen sc1
    s_add_u32 s48, s50, 40960
    buffer_load_dwordx4 v[68:71], v6, s[4:7], s48 offen sc1
    s_add_u32 s48, s50, 49152
    buffer_load_dwordx4 v[72:75], v6, s[4:7], s48 offen sc1
    s_add_u32 s48, s50, 57344
    buffer_load_dwordx4 v[76:79], v6, s[4:7], s48 offen sc1
    s_waitcnt vmcnt(7)
    ds_write_b128 v7, v[48:51] offset:0
    s_waitcnt vmcnt(6)
    ds_write_b128 v7, v[52:55] offset:64
    v_max_u32 v38, v48, v52
    s_waitcnt vmcnt(5)
    ds_write_b128 v7, v[56:59] offset:128
    v_max_u32 v38, v38, v56
    s_waitcnt vmcnt(4)
    ds_write_b128 v7, v[60:63] offset:192
    v_max_u32 v38, v38, v60
    s_waitcnt vmcnt(3)
    ds_write_b128 v7, v[64:67] offset:17408
    v_max_u32 v38, v38, v64
    s_waitcnt vmcnt(2)
    ds_write_b128 v7, v[68:71] offset:17472
    v_max_u32 v38, v38, v68
    s_waitcnt vmcnt(1)
    ds_write_b128 v7, v[72:75] offset:17536
    v_max_u32 v38, v38, v72
    s_waitcnt vmcnt(0)
    ds_write_b128 v7, v[76:79] offset:17600
    v_max_u32 v38, v38, v76
    v_cmp_eq_u32 vcc, -1, v38
    s_cbranch_vccnz TF_h2_f
TF_h2_ok:
    s_waitcnt lgkmcnt(0)
    s_barrier
    ds_read_b128 v[80:83], v8 offset:0
    ds_read_b128 v[84:87], v8 offset:17408
    ds_read_b128 v[88:91], v8 offset:1088
    ds_read_b128 v[92:95], v8 offset:18496
    ds_read_b128 v[96:99], v8 offset:2176
    ds_read_b128 v[100:103], v8 offset:19584
    s_cmp_ge_u32 s77, s64
    s_cbranch_scc1 TF_pf1_skip
    s_cmp_gt_u32 s68, s77
    s_cbranch_scc1 TF_pf1_fok
    s_mov_b32 s30, 0
TF_pf1_fl:
    s_mov_b64 exec, 3
    buffer_load_dword v45, v1, s[4:7], s67 offen sc1
    s_mov_b64 exec, -1
    s_waitcnt vmcnt(0)
    v_readlane_b32 s68, v45, 0
    v_readlane_b32 s48, v45, 1
    s_nop 1
    s_min_u32 s68, s68, s48
    s_cmp_gt_u32 s68, s77
    s_cbranch_scc1 TF_pf1_fok
    s_sleep 8
    s_add_u32 s30, s30, 1
    s_cmp_lt_u32 s30, s31
    s_cbranch_scc1 TF_pf1_fl
    s_mov_b32 s31, 1
TF_pf1_fok:
    s_lshl_b32 s48, s77, 14
    s_add_u32 s81, s61, s48
    s_lshl_b32 s48, s77, 13
    s_add_u32 s82, s62, s48
    s_lshl_b32 s48, s77, 15
    s_add_u32 s83, s65, s48
    s_waitcnt lgkmcnt(4)
    v_mfma_f32_16x16x32_bf16 v[112:115], a[128:131], v[80:83], 0
    ds_read_b128 v[104:107], v8 offset:3264
    ds_read_b128 v[108:111], v8 offset:20672
    v_mfma_f32_16x16x32_bf16 v[116:119], a[192:195], v[80:83], 0
    v_mfma_f32_16x16x32_bf16 v[120:123], a[128:131], v[84:87], 0
    s_add_u32 m0, s72, 0
    s_add_u32 s48, s81, 0
    buffer_load_dwordx4 v1, s[4:7], s48 offen offset:0 sc1 lds
    v_mfma_f32_16x16x32_bf16 v[124:127], a[192:195], v[84:87], 0
    s_waitcnt lgkmcnt(4)
    v_mfma_f32_16x16x32_bf16 v[112:115], a[132:135], v[88:91], v[112:115]
    ds_read_b128 v[80:83], v8 offset:4352
    ds_read_b128 v[84:87], v8 offset:21760
    v_mfma_f32_16x16x32_bf16 v[116:119], a[196:199], v[88:91], v[116:119]
    v_mfma_f32_16x16x32_bf16 v[120:123], a[132:135], v[92:95], v[120:123]
    buffer_load_dwordx4 v1, s[4:7], s48 offen offset:1024 sc1 lds
    v_mfma_f32_16x16x32_bf16 v[124:127], a[196:199], v[92:95], v[124:127]
    s_waitcnt lgkmcnt(4)
    v_mfma_f32_16x16x32_bf16 v[112:115], a[136:139], v[96:99], v[112:115]
    ds_read_b128 v[88:91], v8 offset:5440
    ds_read_b128 v[92:95], v8 offset:22848
    v_mfma_f32_16x16x32_bf16 v[116:119], a[200:203], v[96:99], v[116:119]
    v_mfma_f32_16x16x32_bf16 v[120:123], a[136:139], v[100:103], v[120:123]
    buffer_load_dwordx4 v1, s[4:7], s48 offen offset:2048 sc1 lds
    v_mfma_f32_16x16x32_bf16 v[124:127], a[200:203], v[100:103], v[124:127]
    s_waitcnt lgkmcnt(4)
    v_mfma_f32_16x16x32_bf16 v[112:115], a[140:143], v[104:107], v[112:115]
    ds_read_b128 v[96:99], v8 offset:6528
    ds_read_b128 v[100:103], v8 offset:23936
    v_mfma_f32_16x16x32_bf16 v[116:119], a[204:207], v[104:107], v[116:119]
    v_mfma_f32_16x16x32_bf16 v[120:123], a[140:143], v[108:111], v[120:123]
    buffer_load_dwordx4 v1, s[4:7], s48 offen offset:3072 sc1 lds
    v_mfma_f32_16x16x32_bf16 v[124:127], a[204:207], v[108:111], v[124:127]
    s_waitcnt lgkmcnt(4)
    v_mfma_f32_16x16x32_bf16 v[112:115], a[144:147], v[80:83], v[112:115]
    ds_read_b128 v[104:107], v8 offset:7616
    ds_read_b128 v[108:111], v8 offset:25024
    v_mfma_f32_16x16x32_bf16 v[116:119], a[208:211], v[80:83], v[116:119]
    v_mfma_f32_16x16x32_bf16 v[120:123], a[144:147], v[84:87], v[120:123]
    s_add_u32 m0, s72, 4096
    s_add_u32 s48, s81, 4096
    buffer_load_dwordx4 v1, s[4:7], s48 offen offset:0 sc1 lds
    v_mfma_f32_16x16x32_bf16 v[124:127], a[208:211], v[84:87], v[124:127]
    s_waitcnt lgkmcnt(4)
    v_mfma_f32_16x16x32_bf16 v[112:115], a[148:151], v[88:91], v[112:115]
    ds_read_b128 v[80:83], v8 offset:8704
    ds_read_b128 v[84:87], v8 offset:26112
    v_mfma_f32_16x16x32_bf16 v[116:119], a[212:215], v[88:91], v[116:119]
    v_mfma_f32_16x16x32_bf16 v[120:123], a[148:151], v[92:95], v[120:123]
    buffer_load_dwordx4 v1, s[4:7], s48 offen offset:1024 sc1 lds
    v_mfma_f32_16x16x32_bf16 v[124:127], a[212:215], v[92:95], v[124:127]
    s_waitcnt lgkmcnt(4)
    v_mfma_f32_16x16x32_bf16 v[112:115], a[152:155], v[96:99], v[112:115]
    ds_read_b128 v[88:91], v8 offset:9792
    ds_read_b128 v[92:95], v8 offset:27200
    v_mfma_f32_16x16x32_bf16 v[116:119], a[216:219], v[96:99], v[116:119]
    v_mfma_f32_16x16x32_bf16 v[120:123], a[152:155], v[100:103], v[120:123]
    buffer_load_dwordx4 v1, s[4:7], s48 offen offset:2048 sc1 lds
    v_mfma_f32_16x16x32_bf16 v[124:127], a[216:219], v[100:103], v[124:127]
    s_waitcnt lgkmcnt(4)
    v_mfma_f32_16x16x32_bf16 v[112:115], a[156:159], v[104:107], v[112:115]
    ds_read_b128 v[96:99], v8 offset:10880
    ds_read_b128 v[100:103], v8 offset:28288
    v_mfma_f32_16x16x32_bf16 v[116:119], a[220:223], v[104:107], v[116:119]
    v_mfma_f32_16x16x32_bf16 v[120:123], a[156:159], v[108:111], v[120:123]
    buffer_load_dwordx4 v1, s[4:7], s48 offen offset:3072 sc1 lds
    v_mfma_f32_16x16x32_bf16 v[124:127], a[220:223], v[108:111], v[124:127]
    s_waitcnt lgkmcnt(4)
    v_mfma_f32_16x16x32_bf16 v[112:115], a[160:163], v[80:83], v[112:115]
    ds_read_b128 v[104:107], v8 offset:11968
    ds_read_b128 v[108:111], v8 offset:29376
    v_mfma_f32_16x16x32_bf16 v[116:119], a[224:227], v[80:83], v[116:119]
    v_mfma_f32_16x16x32_bf16 v[120:123], a[160:163], v[84:87], v[120:123]
    s_mov_b32 m0, s73
    s_nop 0
    buffer_load_dwordx4 v1, s[4:7], s82 offen offset:0 sc1 lds
    v_mfma_f32_16x16x32_bf16 v[124:127], a[224:227], v[84:87], v[124:127]
    s_waitcnt lgkmcnt(4)
    v_mfma_f32_16x16x32_bf16 v[112:115], a[164:167], v[88:91], v[112:115]
    ds_read_b128 v[80:83], v8 offset:13056
    ds_read_b128 v[84:87], v8 offset:30464
    v_mfma_f32_16x16x32_bf16 v[116:119], a[228:231], v[88:91], v[116:119]
    v_mfma_f32_16x16x32_bf16 v[120:123], a[164:167], v[92:95], v[120:123]
    buffer_load_dwordx4 v1, s[4:7], s82 offen offset:1024 sc1 lds
    v_mfma_f32_16x16x32_bf16 v[124:127], a[228:231], v[92:95], v[124:127]
    s_waitcnt lgkmcnt(4)
    v_mfma_f32_16x16x32_bf16 v[112:115], a[168:171], v[96:99], v[112:115]
    ds_read_b128 v[88:91], v8 offset:14144
    ds_read_b128 v[92:95], v8 offset:31552
    v_mfma_f32_16x16x32_bf16 v[116:119], a[232:235], v[96:99], v[116:119]
    v_mfma_f32_16x16x32_bf16 v[120:123], a[168:171], v[100:103], v[120:123]
    buffer_load_dwordx4 v1, s[4:7], s82 offen offset:2048 sc1 lds
    v_mfma_f32_16x16x32_bf16 v[124:127], a[232:235], v[100:103], v[124:127]
    s_waitcnt lgkmcnt(4)
    v_mfma_f32_16x16x32_bf16 v[112:115], a[172:175], v[104:107], v[112:115]
    ds_read_b128 v[96:99], v8 offset:15232
    ds_read_b128 v[100:103], v8 offset:32640
    v_mfma_f32_16x16x32_bf16 v[116:119], a[236:239], v[104:107], v[116:119]
    v_mfma_f32_16x16x32_bf16 v[120:123], a[172:175], v[108:111], v[120:123]
    buffer_load_dwordx4 v1, s[4:7], s82 offen offset:3072 sc1 lds
    v_mfma_f32_16x16x32_bf16 v[124:127], a[236:239], v[108:111], v[124:127]
    s_waitcnt lgkmcnt(4)
    v_mfma_f32_16x16x32_bf16 v[112:115], a[176:179], v[80:83], v[112:115]
    ds_read_b128 v[104:107], v8 offset:16320
    ds_read_b128 v[108:111], v8 offset:33728
    v_mfma_f32_16x16x32_bf16 v[116:119], a[240:243], v[80:83], v[116:119]
    v_mfma_f32_16x16x32_bf16 v[120:123], a[176:179], v[84:87], v[120:123]
    buffer_load_dword v37, v2, s[20:23], s83 offen
    v_mfma_f32_16x16x32_bf16 v[124:127], a[240:243], v[84:87], v[124:127]
    s_waitcnt lgkmcnt(4)
    v_mfma_f32_16x16x32_bf16 v[112:115], a[180:183], v[88:91], v[112:115]
    v_mfma_f32_16x16x32_bf16 v[116:119], a[244:247], v[88:91], v[116:119]
    v_mfma_f32_16x16x32_bf16 v[120:123], a[180:183], v[92:95], v[120:123]
    v_mfma_f32_16x16x32_bf16 v[124:127], a[244:247], v[92:95], v[124:127]
    s_waitcnt lgkmcnt(2)
    v_mfma_f32_16x16x32_bf16 v[112:115], a[184:187], v[96:99], v[112:115]
    v_mfma_f32_16x16x32_bf16 v[116:119], a[248:251], v[96:99], v[116:119]
    v_mfma_f32_16x16x32_bf16 v[120:123], a[184:187], v[100:103], v[120:123]
    v_mfma_f32_16x16x32_bf16 v[124:127], a[248:251], v[100:103], v[124:127]
    s_waitcnt lgkmcnt(0)
    v_mfma_f32_16x16x32_bf16 v[112:115], a[188:191], v[104:107], v[112:115]
    v_mfma_f32_16x16x32_bf16 v[116:119], a[252:255], v[104:107], v[116:119]
    v_mfma_f32_16x16x32_bf16 v[120:123], a[188:191], v[108:111], v[120:123]
    v_mfma_f32_16x16x32_bf16 v[124:127], a[252:255], v[108:111], v[124:127]
    s_branch TF_gud
TF_pf1_skip:
    s_waitcnt lgkmcnt(4)
    v_mfma_f32_16x16x32_bf16 v[112:115], a[128:131], v[80:83], 0
    ds_read_b128 v[104:107], v8 offset:3264
    ds_read_b128 v[108:111], v8 offset:20672
    v_mfma_f32_16x16x32_bf16 v[116:119], a[192:195], v[80:83], 0
    v_mfma_f32_16x16x32_bf16 v[120:123], a[128:131], v[84:87], 0
    v_mfma_f32_16x16x32_bf16 v[124:127], a[192:195], v[84:87], 0
    s_waitcnt lgkmcnt(4)
    v_mfma_f32_16x16x32_bf16 v[112:115], a[132:135], v[88:91], v[112:115]
    ds_read_b128 v[80:83], v8 offset:4352
    ds_read_b128 v[84:87], v8 offset:21760
    v_mfma_f32_16x16x32_bf16 v[116:119], a[196:199], v[88:91], v[116:119]
    v_mfma_f32_16x16x32_bf16 v[120:123], a[132:135], v[92:95], v[120:123]
    v_mfma_f32_16x16x32_bf16 v[124:127], a[196:199], v[92:95], v[124:127]
    s_waitcnt lgkmcnt(4)
    v_mfma_f32_16x16x32_bf16 v[112:115], a[136:139], v[96:99], v[112:115]
    ds_read_b128 v[88:91], v8 offset:5440
    ds_read_b128 v[92:95], v8 offset:22848
    v_mfma_f32_16x16x32_bf16 v[116:119], a[200:203], v[96:99], v[116:119]
    v_mfma_f32_16x16x32_bf16 v[120:123], a[136:139], v[100:103], v[120:123]
    v_mfma_f32_16x16x32_bf16 v[124:127], a[200:203], v[100:103], v[124:127]
    s_waitcnt lgkmcnt(4)
    v_mfma_f32_16x16x32_bf16 v[112:115], a[140:143], v[104:107], v[112:115]
    ds_read_b128 v[96:99], v8 offset:6528
    ds_read_b128 v[100:103], v8 offset:23936
    v_mfma_f32_16x16x32_bf16 v[116:119], a[204:207], v[104:107], v[116:119]
    v_mfma_f32_16x16x32_bf16 v[120:123], a[140:143], v[108:111], v[120:123]
    v_mfma_f32_16x16x32_bf16 v[124:127], a[204:207], v[108:111], v[124:127]
    s_waitcnt lgkmcnt(4)
    v_mfma_f32_16x16x32_bf16 v[112:115], a[144:147], v[80:83], v[112:115]
    ds_read_b128 v[104:107], v8 offset:7616
    ds_read_b128 v[108:111], v8 offset:25024
    v_mfma_f32_16x16x32_bf16 v[116:119], a[208:211], v[80:83], v[116:119]
    v_mfma_f32_16x16x32_bf16 v[120:123], a[144:147], v[84:87], v[120:123]
    v_mfma_f32_16x16x32_bf16 v[124:127], a[208:211], v[84:87], v[124:127]
    s_waitcnt lgkmcnt(4)
    v_mfma_f32_16x16x32_bf16 v[112:115], a[148:151], v[88:91], v[112:115]
    ds_read_b128 v[80:83], v8 offset:8704
    ds_read_b128 v[84:87], v8 offset:26112
    v_mfma_f32_16x16x32_bf16 v[116:119], a[212:215], v[88:91], v[116:119]
    v_mfma_f32_16x16x32_bf16 v[120:123], a[148:151], v[92:95], v[120:123]
    v_mfma_f32_16x16x32_bf16 v[124:127], a[212:215], v[92:95], v[124:127]
    s_waitcnt lgkmcnt(4)
    v_mfma_f32_16x16x32_bf16 v[112:115], a[152:155], v[96:99], v[112:115]
    ds_read_b128 v[88:91], v8 offset:9792
    ds_read_b128 v[92:95], v8 offset:27200
    v_mfma_f32_16x16x32_bf16 v[116:119], a[216:219], v[96:99], v[116:119]
    v_mfma_f32_16x16x32_bf16 v[120:123], a[152:155], v[100:103], v[120:123]
    v_mfma_f32_16x16x32_bf16 v[124:127], a[216:219], v[100:103], v[124:127]
    s_waitcnt lgkmcnt(4)
    v_mfma_f32_16x16x32_bf16 v[112:115], a[156:159], v[104:107], v[112:115]
    ds_read_b128 v[96:99], v8 offset:10880
    ds_read_b128 v[100:103], v8 offset:28288
    v_mfma_f32_16x16x32_bf16 v[116:119], a[220:223], v[104:107], v[116:119]
    v_mfma_f32_16x16x32_bf16 v[120:123], a[156:159], v[108:111], v[120:123]
    v_mfma_f32_16x16x32_bf16 v[124:127], a[220:223], v[108:111], v[124:127]
    s_waitcnt lgkmcnt(4)
    v_mfma_f32_16x16x32_bf16 v[112:115], a[160:163], v[80:83], v[112:115]
    ds_read_b128 v[104:107], v8 offset:11968
    ds_read_b128 v[108:111], v8 offset:29376
    v_mfma_f32_16x16x32_bf16 v[116:119], a[224:227], v[80:83], v[116:119]
    v_mfma_f32_16x16x32_bf16 v[120:123], a[160:163], v[84:87], v[120:123]
    v_mfma_f32_16x16x32_bf16 v[124:127], a[224:227], v[84:87], v[124:127]
    s_waitcnt lgkmcnt(4)
    v_mfma_f32_16x16x32_bf16 v[112:115], a[164:167], v[88:91], v[112:115]
    ds_read_b128 v[80:83], v8 offset:13056
    ds_read_b128 v[84:87], v8 offset:30464
    v_mfma_f32_16x16x32_bf16 v[116:119], a[228:231], v[88:91], v[116:119]
    v_mfma_f32_16x16x32_bf16 v[120:123], a[164:167], v[92:95], v[120:123]
    v_mfma_f32_16x16x32_bf16 v[124:127], a[228:231], v[92:95], v[124:127]
    s_waitcnt lgkmcnt(4)
    v_mfma_f32_16x16x32_bf16 v[112:115], a[168:171], v[96:99], v[112:115]
    ds_read_b128 v[88:91], v8 offset:14144
    ds_read_b128 v[92:95], v8 offset:31552
    v_mfma_f32_16x16x32_bf16 v[116:119], a[232:235], v[96:99], v[116:119]
    v_mfma_f32_16x16x32_bf16 v[120:123], a[168:171], v[100:103], v[120:123]
    v_mfma_f32_16x16x32_bf16 v[124:127], a[232:235], v[100:103], v[124:127]
    s_waitcnt lgkmcnt(4)
    v_mfma_f32_16x16x32_bf16 v[112:115], a[172:175], v[104:107], v[112:115]
    ds_read_b128 v[96:99], v8 offset:15232
    ds_read_b128 v[100:103], v8 offset:32640
    v_mfma_f32_16x16x32_bf16 v[116:119], a[236:239], v[104:107], v[116:119]
    v_mfma_f32_16x16x32_bf16 v[120:123], a[172:175], v[108:111], v[120:123]
    v_mfma_f32_16x16x32_bf16 v[124:127], a[236:239], v[108:111], v[124:127]
    s_waitcnt lgkmcnt(4)
    v_mfma_f32_16x16x32_bf16 v[112:115], a[176:179], v[80:83], v[112:115]
    ds_read_b128 v[104:107], v8 offset:16320
    ds_read_b128 v[108:111], v8 offset:33728
    v_mfma_f32_16x16x32_bf16 v[116:119], a[240:243], v[80:83], v[116:119]
    v_mfma_f32_16x16x32_bf16 v[120:123], a[176:179], v[84:87], v[120:123]
    v_mfma_f32_16x16x32_bf16 v[124:127], a[240:243], v[84:87], v[124:127]
    s_waitcnt lgkmcnt(4)
    v_mfma_f32_16x16x32_bf16 v[112:115], a[180:183], v[88:91], v[112:115]
    v_mfma_f32_16x16x32_bf16 v[116:119], a[244:247], v[88:91], v[116:119]
    v_mfma_f32_16x16x32_bf16 v[120:123], a[180:183], v[92:95], v[120:123]
    v_mfma_f32_16x16x32_bf16 v[124:127], a[244:247], v[92:95], v[124:127]
    s_waitcnt lgkmcnt(2)
    v_mfma_f32_16x16x32_bf16 v[112:115], a[184:187], v[96:99], v[112:115]
    v_mfma_f32_16x16x32_bf16 v[116:119], a[248:251], v[96:99], v[116:119]
    v_mfma_f32_16x16x32_bf16 v[120:123], a[184:187], v[100:103], v[120:123]
    v_mfma_f32_16x16x32_bf16 v[124:127], a[248:251], v[100:103], v[124:127]
    s_waitcnt lgkmcnt(0)
    v_mfma_f32_16x16x32_bf16 v[112:115], a[188:191], v[104:107], v[112:115]
    v_mfma_f32_16x16x32_bf16 v[116:119], a[252:255], v[104:107], v[116:119]
    v_mfma_f32_16x16x32_bf16 v[120:123], a[188:191], v[108:111], v[120:123]
    v_mfma_f32_16x16x32_bf16 v[124:127], a[252:255], v[108:111], v[124:127]
TF_gud:
    s_lshl_b32 s48, s55, 17
    s_add_u32 s48, s59, s48
    s_add_u32 s50, s48, 57344
    s_nop 0
    v_cvt_pk_bf16_f32 v38, v112, v113
    v_lshlrev_b32 v112, 16, v38
    v_and_b32 v113, s17, v38
    v_cvt_pk_bf16_f32 v38, v114, v115
    v_lshlrev_b32 v114, 16, v38
    v_and_b32 v115, s17, v38
    v_cvt_pk_bf16_f32 v38, v116, v117
    v_lshlrev_b32 v116, 16, v38
    v_and_b32 v117, s17, v38
    v_cvt_pk_bf16_f32 v38, v118, v119
    v_lshlrev_b32 v118, 16, v38
    v_and_b32 v119, s17, v38
    v_mul_f32 v112, v112, v116
    v_mul_f32 v113, v113, v117
    v_mul_f32 v114, v114, v118
    v_mul_f32 v115, v115, v119
    v_cvt_pk_bf16_f32 v128, v112, v113
    v_cvt_pk_bf16_f32 v129, v114, v115
    buffer_store_dwordx2 v[128:129], v1, s[4:7], s48 offen
    v_cvt_pk_bf16_f32 v38, v120, v121
    v_lshlrev_b32 v120, 16, v38
    v_and_b32 v121, s17, v38
    v_cvt_pk_bf16_f32 v38, v122, v123
    v_lshlrev_b32 v122, 16, v38
    v_and_b32 v123, s17, v38
    v_cvt_pk_bf16_f32 v38, v124, v125
    v_lshlrev_b32 v124, 16, v38
    v_and_b32 v125, s17, v38
    v_cvt_pk_bf16_f32 v38, v126, v127
    v_lshlrev_b32 v126, 16, v38
    v_and_b32 v127, s17, v38
    v_mul_f32 v120, v120, v124
    v_mul_f32 v121, v121, v125
    v_mul_f32 v122, v122, v126
    v_mul_f32 v123, v123, v127
    v_cvt_pk_bf16_f32 v130, v120, v121
    v_cvt_pk_bf16_f32 v131, v122, v123
    buffer_store_dwordx2 v[130:131], v1, s[4:7], s50 offen
    s_lshl_b32 s48, s56, 17
    s_add_u32 s48, s59, s48
    s_add_u32 s50, s48, 57344
    buffer_store_dwordx2 v[42:43], v1, s[4:7], s48 offen
    buffer_store_dwordx2 v[42:43], v1, s[4:7], s50 offen
    s_sleep 6
    s_branch TF_E
TF_noffn:
    s_cmp_ge_u32 s77, s64
    s_cbranch_scc1 TF_pf2_skip
    s_cmp_gt_u32 s68, s77
    s_cbranch_scc1 TF_pf2_fok
    s_mov_b32 s30, 0
TF_pf2_fl:
    s_mov_b64 exec, 3
    buffer_load_dword v45, v1, s[4:7], s67 offen sc1
    s_mov_b64 exec, -1
    s_waitcnt vmcnt(0)
    v_readlane_b32 s68, v45, 0
    v_readlane_b32 s48, v45, 1
    s_nop 1
    s_min_u32 s68, s68, s48
    s_cmp_gt_u32 s68, s77
    s_cbranch_scc1 TF_pf2_fok
    s_sleep 8
    s_add_u32 s30, s30, 1
    s_cmp_lt_u32 s30, s31
    s_cbranch_scc1 TF_pf2_fl
    s_mov_b32 s31, 1
TF_pf2_fok:
    s_lshl_b32 s48, s77, 14
    s_add_u32 s81, s61, s48
    s_lshl_b32 s48, s77, 13
    s_add_u32 s82, s62, s48
    s_lshl_b32 s48, s77, 15
    s_add_u32 s83, s65, s48
    s_add_u32 m0, s72, 0
    s_add_u32 s48, s81, 0
    buffer_load_dwordx4 v1, s[4:7], s48 offen offset:0 sc1 lds
    buffer_load_dwordx4 v1, s[4:7], s48 offen offset:1024 sc1 lds
    buffer_load_dwordx4 v1, s[4:7], s48 offen offset:2048 sc1 lds
    buffer_load_dwordx4 v1, s[4:7], s48 offen offset:3072 sc1 lds
    s_add_u32 m0, s72, 4096
    s_add_u32 s48, s81, 4096
    buffer_load_dwordx4 v1, s[4:7], s48 offen offset:0 sc1 lds
    buffer_load_dwordx4 v1, s[4:7], s48 offen offset:1024 sc1 lds
    buffer_load_dwordx4 v1, s[4:7], s48 offen offset:2048 sc1 lds
    buffer_load_dwordx4 v1, s[4:7], s48 offen offset:3072 sc1 lds
    s_mov_b32 m0, s73
    s_nop 0
    buffer_load_dwordx4 v1, s[4:7], s82 offen offset:0 sc1 lds
    buffer_load_dwordx4 v1, s[4:7], s82 offen offset:1024 sc1 lds
    buffer_load_dwordx4 v1, s[4:7], s82 offen offset:2048 sc1 lds
    buffer_load_dwordx4 v1, s[4:7], s82 offen offset:3072 sc1 lds
    buffer_load_dword v37, v2, s[20:23], s83 offen
TF_pf2_skip:
    s_sleep 32
TF_E:
    s_lshl_b32 s50, s55, 17
    s_add_u32 s50, s60, s50
    s_lshl_b32 s49, s55, 16
    s_add_u32 s49, s69, s49
    s_mov_b32 s30, 0
TF_act:
    buffer_load_dword v41, v36, s[4:7], s49 offen sc1
    s_add_u32 s48, s50, 0
    buffer_load_dwordx4 v[48:51], v1, s[4:7], s48 offen offset:0 sc1
    buffer_load_dwordx4 v[52:55], v1, s[4:7], s48 offen offset:1024 sc1
    buffer_load_dwordx4 v[56:59], v1, s[4:7], s48 offen offset:2048 sc1
    buffer_load_dwordx4 v[60:63], v1, s[4:7], s48 offen offset:3072 sc1
    s_add_u32 s48, s50, 4096
    buffer_load_dwordx4 v[64:67], v1, s[4:7], s48 offen offset:0 sc1
    buffer_load_dwordx4 v[68:71], v1, s[4:7], s48 offen offset:1024 sc1
    buffer_load_dwordx4 v[72:75], v1, s[4:7], s48 offen offset:2048 sc1
    buffer_load_dwordx4 v[76:79], v1, s[4:7], s48 offen offset:3072 sc1
    s_add_u32 s48, s50, 8192
    buffer_load_dwordx4 v[80:83], v1, s[4:7], s48 offen offset:0 sc1
    buffer_load_dwordx4 v[84:87], v1, s[4:7], s48 offen offset:1024 sc1
    buffer_load_dwordx4 v[88:91], v1, s[4:7], s48 offen offset:2048 sc1
    buffer_load_dwordx4 v[92:95], v1, s[4:7], s48 offen offset:3072 sc1
    s_add_u32 s48, s50, 12288
    buffer_load_dwordx4 v[96:99], v1, s[4:7], s48 offen offset:0 sc1
    buffer_load_dwordx4 v[100:103], v1, s[4:7], s48 offen offset:1024 sc1
    s_waitcnt vmcnt(13)
    v_mfma_f32_16x16x32_bf16 v[112:115], v[144:147], v[48:51], 0
    v_mfma_f32_16x16x32_bf16 v[116:119], v[200:203], v[48:51], 0
    v_max3_u32 v38, v41, v48, v50
    s_waitcnt vmcnt(12)
    v_mfma_f32_16x16x32_bf16 v[112:115], v[148:151], v[52:55], v[112:115]
    v_mfma_f32_16x16x32_bf16 v[116:119], v[204:207], v[52:55], v[116:119]
    v_max3_u32 v38, v38, v52, v54
    s_waitcnt vmcnt(11)
    v_mfma_f32_16x16x32_bf16 v[112:115], v[152:155], v[56:59], v[112:115]
    v_mfma_f32_16x16x32_bf16 v[116:119], v[208:211], v[56:59], v[116:119]
    v_max3_u32 v38, v38, v56, v58
    s_waitcnt vmcnt(10)
    v_mfma_f32_16x16x32_bf16 v[112:115], v[156:159], v[60:63], v[112:115]
    v_mfma_f32_16x16x32_bf16 v[116:119], v[212:215], v[60:63], v[116:119]
    v_max3_u32 v38, v38, v60, v62
    s_waitcnt vmcnt(9)
    v_mfma_f32_16x16x32_bf16 v[112:115], v[160:163], v[64:67], v[112:115]
    v_mfma_f32_16x16x32_bf16 v[116:119], v[216:219], v[64:67], v[116:119]
    v_max3_u32 v38, v38, v64, v66
    s_waitcnt vmcnt(8)
    v_mfma_f32_16x16x32_bf16 v[112:115], v[164:167], v[68:71], v[112:115]
    v_mfma_f32_16x16x32_bf16 v[116:119], v[220:223], v[68:71], v[116:119]
    v_max3_u32 v38, v38, v68, v70
    s_waitcnt vmcnt(7)
    v_mfma_f32_16x16x32_bf16 v[112:115], v[168:171], v[72:75], v[112:115]
    v_mfma_f32_16x16x32_bf16 v[116:119], v[224:227], v[72:75], v[116:119]
    v_max3_u32 v38, v38, v72, v74
    s_waitcnt vmcnt(6)
    v_mfma_f32_16x16x32_bf16 v[112:115], v[172:175], v[76:79], v[112:115]
    v_mfma_f32_16x16x32_bf16 v[116:119], v[228:231], v[76:79], v[116:119]
    v_max3_u32 v38, v38, v76, v78
    s_waitcnt vmcnt(5)
    v_mfma_f32_16x16x32_bf16 v[112:115], v[176:179], v[80:83], v[112:115]
    v_mfma_f32_16x16x32_bf16 v[116:119], v[232:235], v[80:83], v[116:119]
    v_max3_u32 v38, v38, v80, v82
    s_waitcnt vmcnt(4)
    v_mfma_f32_16x16x32_bf16 v[112:115], v[180:183], v[84:87], v[112:115]
    v_mfma_f32_16x16x32_bf16 v[116:119], v[236:239], v[84:87], v[116:119]
    v_max3_u32 v38, v38, v84, v86
    s_waitcnt vmcnt(3)
    v_mfma_f32_16x16x32_bf16 v[112:115], v[184:187], v[88:91], v[112:115]
    v_mfma_f32_16x16x32_bf16 v[116:119], v[240:243], v[88:91], v[116:119]
    v_max3_u32 v38, v38, v88, v90
    s_waitcnt vmcnt(2)
    v_mfma_f32_16x16x32_bf16 v[112:115], v[188:191], v[92:95], v[112:115]
    v_mfma_f32_16x16x32_bf16 v[116:119], v[244:247], v[92:95], v[116:119]
    v_max3_u32 v38, v38, v92, v94
    s_waitcnt vmcnt(1)
    v_mfma_f32_16x16x32_bf16 v[112:115], v[192:195], v[96:99], v[112:115]
    v_mfma_f32_16x16x32_bf16 v[116:119], v[248:251], v[96:99], v[116:119]
    v_max3_u32 v38, v38, v96, v98
    s_waitcnt vmcnt(0)
    v_mfma_f32_16x16x32_bf16 v[112:115], v[196:199], v[100:103], v[112:115]
    v_mfma_f32_16x16x32_bf16 v[116:119], v[252:255], v[100:103], v[116:119]
    v_max3_u32 v38, v38, v100, v102
    v_cmp_eq_u32 vcc, -1, v38
    v_lshlrev_b32 v124, 16, v41
    v_and_b32 v125, s17, v41
    s_cbranch_vccnz TF_act_f
TF_act_ok:
    s_nop 2
    ds_write_b128 v13, v[112:115]
    ds_write_b128 v13, v[116:119] offset:1024
    v_mfma_f32_32x32x2_f32 v[80:95], v10, v10, 0
    s_waitcnt lgkmcnt(0)
    s_barrier
    ds_read_b64 v[112:113], v14 offset:0
    ds_read_b64 v[114:115], v14 offset:2048
    ds_read_b64 v[116:117], v14 offset:4096
    ds_read_b64 v[118:119], v14 offset:6144
    v_mfma_f32_32x32x2_f32 v[80:95], v10, v10, 0
    s_waitcnt lgkmcnt(0)
    v_add_f32 v112, v112, v114
    v_add_f32 v113, v113, v115
    v_add_f32 v116, v116, v118
    v_add_f32 v117, v117, v119
    v_add_f32 v112, v112, v116
    v_add_f32 v113, v113, v117
    v_cvt_pk_bf16_f32 v38, v112, v113
    v_lshlrev_b32 v112, 16, v38
    v_and_b32 v113, s17, v38
    v_mul_f32 v112, v22, v112
    v_mul_f32 v113, v23, v113
    v_cvt_pk_bf16_f32 v38, v112, v113
    v_lshlrev_b32 v112, 16, v38
    v_and_b32 v113, s17, v38
    v_add_f32 v112, v124, v112
    v_add_f32 v113, v125, v113
    v_cvt_pk_bf16_f32 v38, v112, v113
    buffer_store_dword v38, v15, s[24:27], s66 offen
    s_mov_b32 s28, s77
    s_lshl_b32 s48, s28, 12
    s_add_u32 s63, s78, s48
    s_lshl_b32 s48, s28, 15
    s_add_u32 s66, s79, s48
    s_xor_b32 s29, s29, 1
    s_mov_b32 s56, s55
    s_add_u32 s55, s55, 1
    s_cmp_ge_u32 s55, 3
    s_cselect_b32 s55, 0, s55
    s_cmp_lt_u32 s28, s64
    s_cbranch_scc1 TF_loop
    s_branch TF_fin
TF_km_f:
    s_sleep 3
    buffer_load_dwordx4 v[124:127], v1, s[4:7], s63 offen offset:0 sc1
    buffer_load_dwordx4 v[128:131], v1, s[4:7], s63 offen offset:1024 sc1
    buffer_load_dwordx4 v[132:135], v1, s[4:7], s63 offen offset:2048 sc1
    buffer_load_dwordx4 v[136:139], v1, s[4:7], s63 offen offset:3072 sc1
    s_add_u32 s30, s30, 1
    s_cmp_lt_u32 s30, s31
    s_cbranch_scc1 TF_km
    s_mov_b32 s31, 1
    s_waitcnt vmcnt(0)
    s_branch TF_km_ok
TF_r1_f:
    s_sleep 1
    s_add_u32 s30, s30, 1
    s_cmp_lt_u32 s30, s31
    s_cbranch_scc1 TF_r1
    s_mov_b32 s31, 1
    s_branch TF_r1_ok
TF_h2_f:
    s_sleep 2
    s_add_u32 s30, s30, 1
    s_cmp_lt_u32 s30, s31
    s_cbranch_scc1 TF_h2
    s_mov_b32 s31, 1
    s_branch TF_h2_ok
TF_act_f:
    s_sleep 2
    s_add_u32 s30, s30, 1
    s_cmp_lt_u32 s30, s31
    s_cbranch_scc1 TF_act
    s_mov_b32 s31, 1
    s_branch TF_act_ok
TF_fin:
    s_waitcnt vmcnt(0)
    s_branch L_done
T_slow:
    s_cmp_ge_u32 s28, s64
    s_cbranch_scc1 TS_pf0_skip
    s_cmp_gt_u32 s68, s28
    s_cbranch_scc1 TS_pf0_fok
    s_mov_b32 s30, 0
TS_pf0_fl:
    s_mov_b64 exec, 3
    buffer_load_dword v45, v1, s[4:7], s67 offen sc1
    s_mov_b64 exec, -1
    s_waitcnt vmcnt(0)
    v_readlane_b32 s68, v45, 0
    v_readlane_b32 s48, v45, 1
    s_nop 1
    s_min_u32 s68, s68, s48
    s_cmp_gt_u32 s68, s28
    s_cbranch_scc1 TS_pf0_fok
    s_sleep 8
    s_add_u32 s30, s30, 1
    s_cmp_lt_u32 s30, s31
    s_cbranch_scc1 TS_pf0_fl
    s_mov_b32 s31, 1
TS_pf0_fok:
    s_lshl_b32 s48, s28, 14
    s_add_u32 s81, s61, s48
    s_lshl_b32 s48, s28, 13
    s_add_u32 s82, s62, s48
    s_lshl_b32 s48, s28, 15
    s_add_u32 s83, s65, s48
    s_add_u32 m0, s72, 0
    s_add_u32 s48, s81, 0
    buffer_load_dwordx4 v1, s[4:7], s48 offen offset:0 sc1 lds
    buffer_load_dwordx4 v1, s[4:7], s48 offen offset:1024 sc1 lds
    buffer_load_dwordx4 v1, s[4:7], s48 offen offset:2048 sc1 lds
    buffer_load_dwordx4 v1, s[4:7], s48 offen offset:3072 sc1 lds
    s_add_u32 m0, s72, 4096
    s_add_u32 s48, s81, 4096
    buffer_load_dwordx4 v1, s[4:7], s48 offen offset:0 sc1 lds
    buffer_load_dwordx4 v1, s[4:7], s48 offen offset:1024 sc1 lds
    buffer_load_dwordx4 v1, s[4:7], s48 offen offset:2048 sc1 lds
    buffer_load_dwordx4 v1, s[4:7], s48 offen offset:3072 sc1 lds
    s_mov_b32 m0, s73
    s_nop 0
    buffer_load_dwordx4 v1, s[4:7], s82 offen offset:0 sc1 lds
    buffer_load_dwordx4 v1, s[4:7], s82 offen offset:1024 sc1 lds
    buffer_load_dwordx4 v1, s[4:7], s82 offen offset:2048 sc1 lds
    buffer_load_dwordx4 v1, s[4:7], s82 offen offset:3072 sc1 lds
    buffer_load_dword v37, v2, s[20:23], s83 offen
TS_pf0_skip:
    s_cmp_ge_u32 s3, 4
    s_cselect_b32 s48, 1, s15
    s_cmp_lg_u32 s48, 0
    s_cbranch_scc1 TS_lw_ok
    s_sub_u32 s49, s63, 8192
    s_mov_b32 s30, 0
    s_mov_b64 exec, 1
TS_lw:
    buffer_load_dword v45, v1, s[4:7], s49 offen sc1
    s_waitcnt vmcnt(0)
    v_readfirstlane_b32 s48, v45
    s_cmp_lg_u32 s48, -1
    s_cbranch_scc1 TS_lw_x
    s_sleep 16
    s_add_u32 s30, s30, 1
    s_cmp_lt_u32 s30, 20000
    s_cbranch_scc1 TS_lw
TS_lw_x:
    s_mov_b64 exec, -1
TS_lw_ok:
    s_waitcnt vmcnt(0)
    s_barrier
.p2align 6
TS_loop:
    buffer_load_dwordx4 v[124:127], v1, s[4:7], s63 offen offset:0 sc1
    buffer_load_dwordx4 v[128:131], v1, s[4:7], s63 offen offset:1024 sc1
    buffer_load_dwordx4 v[132:135], v1, s[4:7], s63 offen offset:2048 sc1
    buffer_load_dwordx4 v[136:139], v1, s[4:7], s63 offen offset:3072 sc1
    ds_read_b128 v[48:51], v11 offset:0
    ds_read_b128 v[64:67], v12 offset:0
    ds_read_b128 v[80:83], v12 offset:8192
    ds_read_b128 v[52:55], v11 offset:1024
    ds_read_b128 v[68:71], v12 offset:1024
    ds_read_b128 v[84:87], v12 offset:9216
    ds_read_b128 v[56:59], v11 offset:2048
    ds_read_b128 v[72:75], v12 offset:4096
    ds_read_b128 v[88:91], v12 offset:12288
    ds_read_b128 v[60:63], v11 offset:3072
    ds_read_b128 v[76:79], v12 offset:5120
    ds_read_b128 v[92:95], v12 offset:13312
    s_waitcnt lgkmcnt(9)
    v_mfma_f32_16x16x32_bf16 v[112:115], v[64:67], v[48:51], v[24:27]
    v_mfma_f32_16x16x32_bf16 v[116:119], v[80:83], v[48:51], v[28:31]
    s_waitcnt lgkmcnt(6)
    v_mfma_f32_16x16x32_bf16 v[112:115], v[68:71], v[52:55], v[112:115]
    v_mfma_f32_16x16x32_bf16 v[116:119], v[84:87], v[52:55], v[116:119]
    s_waitcnt lgkmcnt(3)
    v_mfma_f32_16x16x32_bf16 v[112:115], v[72:75], v[56:59], v[112:115]
    v_mfma_f32_16x16x32_bf16 v[116:119], v[88:91], v[56:59], v[116:119]
    s_waitcnt lgkmcnt(0)
    v_mfma_f32_16x16x32_bf16 v[112:115], v[76:79], v[60:63], v[112:115]
    v_mfma_f32_16x16x32_bf16 v[116:119], v[92:95], v[60:63], v[116:119]
    ds_read_b128 v[64:67], v12 offset:2048
    ds_read_b128 v[68:71], v12 offset:3072
    ds_read_b128 v[72:75], v12 offset:6144
    ds_read_b128 v[76:79], v12 offset:7168
    ds_read_b128 v[80:83], v12 offset:10240
    ds_read_b128 v[84:87], v12 offset:11264
    ds_read_b128 v[88:91], v12 offset:14336
    ds_read_b128 v[92:95], v12 offset:15360
    v_cvt_pk_bf16_f32 v40, v112, v113
    v_lshlrev_b32 v112, 16, v40
    v_and_b32 v113, s17, v40
    v_cvt_pk_bf16_f32 v40, v114, v115
    v_lshlrev_b32 v114, 16, v40
    v_and_b32 v115, s17, v40
    v_cvt_pk_bf16_f32 v40, v116, v117
    v_lshlrev_b32 v116, 16, v40
    v_and_b32 v117, s17, v40
    v_cvt_pk_bf16_f32 v40, v118, v119
    v_lshlrev_b32 v118, 16, v40
    v_and_b32 v119, s17, v40
    v_mul_f32 v112, s18, v112
    v_mul_f32 v113, s18, v113
    v_mul_f32 v114, s18, v114
    v_mul_f32 v115, s18, v115
    v_mul_f32 v116, s18, v116
    v_mul_f32 v117, s18, v117
    v_mul_f32 v118, s18, v118
    v_mul_f32 v119, s18, v119
    v_cvt_pk_bf16_f32 v40, v112, v113
    v_lshlrev_b32 v112, 16, v40
    v_and_b32 v113, s17, v40
    v_cvt_pk_bf16_f32 v40, v114, v115
    v_lshlrev_b32 v114, 16, v40
    v_and_b32 v115, s17, v40
    v_cvt_pk_bf16_f32 v40, v116, v117
    v_lshlrev_b32 v116, 16, v40
    v_and_b32 v117, s17, v40
    v_cvt_pk_bf16_f32 v40, v118, v119
    v_lshlrev_b32 v118, 16, v40
    v_and_b32 v119, s17, v40
    v_max3_f32 v41, v112, v113, v114
    v_max3_f32 v39, v115, v116, v117
    v_max3_f32 v41, v41, v118, v119
    v_max_f32 v41, v41, v39
    v_mov_b32 v39, v41
    s_nop 1
    v_permlane32_swap_b32 v41, v39
    v_max_f32 v41, v41, v39
    v_mov_b32 v39, v41
    s_nop 1
    v_permlane16_swap_b32 v41, v39
    v_max_f32 v41, v41, v39
    v_mul_f32 v38, s19, v41
    v_fma_f32 v112, v112, s19, -v38
    v_fma_f32 v113, v113, s19, -v38
    v_fma_f32 v114, v114, s19, -v38
    v_fma_f32 v115, v115, s19, -v38
    v_fma_f32 v116, v116, s19, -v38
    v_fma_f32 v117, v117, s19, -v38
    v_fma_f32 v118, v118, s19, -v38
    v_fma_f32 v119, v119, s19, -v38
    v_exp_f32 v112, v112
    v_exp_f32 v113, v113
    v_exp_f32 v114, v114
    v_exp_f32 v115, v115
    v_exp_f32 v116, v116
    v_exp_f32 v117, v117
    v_exp_f32 v118, v118
    v_exp_f32 v119, v119
    v_add_f32 v46, v112, v113
    v_add_f32 v38, v114, v115
    v_add_f32 v39, v116, v117
    v_add_f32 v40, v118, v119
    v_add_f32 v46, v46, v38
    v_add_f32 v39, v39, v40
    v_add_f32 v46, v46, v39
    v_mov_b32 v45, 0
    s_mov_b32 s30, 0
TS_km:
    s_waitcnt vmcnt(0)
    v_max3_u32 v38, v124, v128, v132
    v_max_u32 v38, v38, v136
    v_cmp_eq_u32 vcc, -1, v38
    ds_write2st64_b32 v4, v125, v127 offset0:0 offset1:2
    ds_write2st64_b32 v4, v129, v131 offset0:4 offset1:6
    ds_write2st64_b32 v4, v133, v135 offset0:8 offset1:10
    ds_write2st64_b32 v4, v137, v139 offset0:12 offset1:14
    s_cbranch_vccnz TS_km_f
TS_km_ok:
    ds_read_b64_tr_b16 v[96:97], v5 offset:0
    ds_read_b64_tr_b16 v[98:99], v5 offset:512
    ds_read_b64_tr_b16 v[100:101], v5 offset:1024
    ds_read_b64_tr_b16 v[102:103], v5 offset:1536
    ds_read_b64_tr_b16 v[104:105], v5 offset:2048
    ds_read_b64_tr_b16 v[106:107], v5 offset:2560
    ds_read_b64_tr_b16 v[108:109], v5 offset:3072
    ds_read_b64_tr_b16 v[110:111], v5 offset:3584
    s_waitcnt lgkmcnt(6)
    v_mfma_f32_16x16x32_bf16 v[120:123], v[96:99], v[48:51], 0
    s_waitcnt lgkmcnt(4)
    v_mfma_f32_16x16x32_bf16 v[120:123], v[100:103], v[52:55], v[120:123]
    s_waitcnt lgkmcnt(2)
    v_mfma_f32_16x16x32_bf16 v[120:123], v[104:107], v[56:59], v[120:123]
    s_waitcnt lgkmcnt(0)
    v_mfma_f32_16x16x32_bf16 v[120:123], v[108:111], v[60:63], v[120:123]
    s_nop 7
    v_cvt_pk_bf16_f32 v40, v120, v121
    v_lshlrev_b32 v120, 16, v40
    v_and_b32 v121, s17, v40
    v_mul_f32 v120, s18, v120
    v_mul_f32 v121, s18, v121
    v_cvt_pk_bf16_f32 v40, v120, v121
    v_lshlrev_b32 v120, 16, v40
    v_and_b32 v121, s17, v40
    v_max3_f32 v38, v41, v120, v121
    v_mov_b32 v39, v38
    s_nop 1
    v_permlane32_swap_b32 v38, v39
    v_max_f32 v38, v38, v39
    v_mov_b32 v39, v38
    s_nop 1
    v_permlane16_swap_b32 v38, v39
    v_max_f32 v38, v38, v39
    v_mul_f32 v38, s19, v38
    v_fma_f32 v41, v41, s19, -v38
    v_fma_f32 v120, v120, s19, -v38
    v_fma_f32 v121, v121, s19, -v38
    v_exp_f32 v41, v41
    v_exp_f32 v120, v120
    v_exp_f32 v121, v121
    v_fma_f32 v46, v46, v41, v120
    v_add_f32 v46, v46, v121
    v_mov_b32 v39, v46
    s_nop 1
    v_permlane32_swap_b32 v46, v39
    v_add_f32 v46, v46, v39
    v_mov_b32 v39, v46
    s_nop 1
    v_permlane16_swap_b32 v46, v39
    v_add_f32 v46, v46, v39
    v_rcp_f32 v46, v46
    s_nop 0
    v_mul_f32 v42, v46, v41
    v_pk_mul_f32 v[120:121], v[120:121], v[46:47] op_sel_hi:[1,0]
    v_pk_mul_f32 v[112:113], v[112:113], v[42:43] op_sel_hi:[1,0]
    v_pk_mul_f32 v[114:115], v[114:115], v[42:43] op_sel_hi:[1,0]
    v_pk_mul_f32 v[116:117], v[116:117], v[42:43] op_sel_hi:[1,0]
    v_pk_mul_f32 v[118:119], v[118:119], v[42:43] op_sel_hi:[1,0]
    v_cvt_pk_bf16_f32 v44, v120, v121
    v_cvt_pk_bf16_f32 v140, v112, v113
    v_cvt_pk_bf16_f32 v141, v114, v115
    v_cvt_pk_bf16_f32 v142, v116, v117
    v_cvt_pk_bf16_f32 v143, v118, v119
    v_mfma_f32_16x16x16_bf16 v[96:99], v[124:125], v[44:45], 0
    v_mfma_f32_16x16x16_bf16 v[100:103], v[126:127], v[44:45], 0
    v_mfma_f32_16x16x16_bf16 v[104:107], v[128:129], v[44:45], 0
    v_mfma_f32_16x16x16_bf16 v[108:111], v[130:131], v[44:45], 0
    v_mfma_f32_16x16x16_bf16 v[48:51], v[132:133], v[44:45], 0
    v_mfma_f32_16x16x16_bf16 v[52:55], v[134:135], v[44:45], 0
    v_mfma_f32_16x16x16_bf16 v[56:59], v[136:137], v[44:45], 0
    v_mfma_f32_16x16x16_bf16 v[60:63], v[138:139], v[44:45], 0
    v_mfma_f32_16x16x32_bf16 v[96:99], v[64:67], v[140:143], v[96:99]
    v_mfma_f32_16x16x32_bf16 v[100:103], v[68:71], v[140:143], v[100:103]
    v_mfma_f32_16x16x32_bf16 v[104:107], v[72:75], v[140:143], v[104:107]
    v_mfma_f32_16x16x32_bf16 v[108:111], v[76:79], v[140:143], v[108:111]
    v_cvt_pk_bf16_f32 v112, v96, v97
    v_cvt_pk_bf16_f32 v113, v98, v99
    v_cvt_pk_bf16_f32 v114, v100, v101
    v_cvt_pk_bf16_f32 v115, v102, v103
    ds_write_b128 v9, v[112:115] offset:0
    v_mfma_f32_16x16x32_bf16 v[48:51], v[80:83], v[140:143], v[48:51]
    v_mfma_f32_16x16x32_bf16 v[52:55], v[84:87], v[140:143], v[52:55]
    v_cvt_pk_bf16_f32 v116, v104, v105
    v_cvt_pk_bf16_f32 v117, v106, v107
    v_cvt_pk_bf16_f32 v118, v108, v109
    v_cvt_pk_bf16_f32 v119, v110, v111
    ds_write_b128 v9, v[116:119] offset:1024
    v_mfma_f32_16x16x32_bf16 v[56:59], v[88:91], v[140:143], v[56:59]
    v_mfma_f32_16x16x32_bf16 v[60:63], v[92:95], v[140:143], v[60:63]
    v_cvt_pk_bf16_f32 v112, v48, v49
    v_cvt_pk_bf16_f32 v113, v50, v51
    v_cvt_pk_bf16_f32 v114, v52, v53
    v_cvt_pk_bf16_f32 v115, v54, v55
    ds_write_b128 v9, v[112:115] offset:2048
    s_nop 3
    v_cvt_pk_bf16_f32 v116, v56, v57
    v_cvt_pk_bf16_f32 v117, v58, v59
    v_cvt_pk_bf16_f32 v118, v60, v61
    v_cvt_pk_bf16_f32 v119, v62, v63
    ds_write_b128 v9, v[116:119] offset:3072
    s_waitcnt lgkmcnt(0)
    s_barrier
    ds_read_b128 v[48:51], v1 offset:0
    ds_read_b128 v[52:55], v1 offset:1024
    ds_read_b128 v[56:59], v1 offset:2048
    ds_read_b128 v[60:63], v1 offset:3072
    ds_read_b128 v[64:67], v1 offset:4096
    ds_read_b128 v[68:71], v1 offset:5120
    ds_read_b128 v[72:75], v1 offset:6144
    ds_read_b128 v[76:79], v1 offset:7168
    ds_read_b128 v[80:83], v1 offset:8192
    ds_read_b128 v[84:87], v1 offset:9216
    ds_read_b128 v[88:91], v1 offset:10240
    ds_read_b128 v[92:95], v1 offset:11264
    ds_read_b128 v[96:99], v1 offset:12288
    ds_read_b128 v[100:103], v1 offset:13312
    ds_read_b128 v[104:107], v1 offset:14336
    ds_read_b128 v[108:111], v1 offset:15360
    s_waitcnt lgkmcnt(15)
    v_mfma_f32_16x16x32_bf16 v[112:115], a[0:3], v[48:51], 0
    v_mfma_f32_16x16x32_bf16 v[116:119], a[32:35], v[48:51], 0
    s_waitcnt lgkmcnt(14)
    v_mfma_f32_16x16x32_bf16 v[112:115], a[4:7], v[52:55], v[112:115]
    v_mfma_f32_16x16x32_bf16 v[116:119], a[36:39], v[52:55], v[116:119]
    s_waitcnt lgkmcnt(13)
    v_mfma_f32_16x16x32_bf16 v[112:115], a[8:11], v[56:59], v[112:115]
    v_mfma_f32_16x16x32_bf16 v[116:119], a[40:43], v[56:59], v[116:119]
    s_waitcnt lgkmcnt(12)
    v_mfma_f32_16x16x32_bf16 v[112:115], a[12:15], v[60:63], v[112:115]
    v_mfma_f32_16x16x32_bf16 v[116:119], a[44:47], v[60:63], v[116:119]
    s_waitcnt lgkmcnt(11)
    v_mfma_f32_16x16x32_bf16 v[112:115], a[16:19], v[64:67], v[112:115]
    v_mfma_f32_16x16x32_bf16 v[116:119], a[48:51], v[64:67], v[116:119]
    s_waitcnt lgkmcnt(10)
    v_mfma_f32_16x16x32_bf16 v[112:115], a[20:23], v[68:71], v[112:115]
    v_mfma_f32_16x16x32_bf16 v[116:119], a[52:55], v[68:71], v[116:119]
    s_waitcnt lgkmcnt(9)
    v_mfma_f32_16x16x32_bf16 v[112:115], a[24:27], v[72:75], v[112:115]
    v_mfma_f32_16x16x32_bf16 v[116:119], a[56:59], v[72:75], v[116:119]
    s_waitcnt lgkmcnt(8)
    v_mfma_f32_16x16x32_bf16 v[112:115], a[28:31], v[76:79], v[112:115]
    v_mfma_f32_16x16x32_bf16 v[116:119], a[60:63], v[76:79], v[116:119]
    v_mfma_f32_16x16x32_bf16 v[120:123], a[64:67], v[48:51], 0
    v_mfma_f32_16x16x32_bf16 v[124:127], a[96:99], v[48:51], 0
    v_cvt_pk_bf16_f32 v128, v112, v113
    v_cvt_pk_bf16_f32 v129, v114, v115
    v_mfma_f32_16x16x32_bf16 v[120:123], a[68:71], v[52:55], v[120:123]
    v_cvt_pk_bf16_f32 v130, v116, v117
    v_cvt_pk_bf16_f32 v131, v118, v119
    v_mfma_f32_16x16x32_bf16 v[124:127], a[100:103], v[52:55], v[124:127]
    v_and_or_b32 v128, v128, -2, s29
    buffer_store_dwordx4 v[128:131], v3, s[4:7], s52 offen offset:0 sc1
    v_mfma_f32_16x16x32_bf16 v[120:123], a[72:75], v[56:59], v[120:123]
    v_mfma_f32_16x16x32_bf16 v[124:127], a[104:107], v[56:59], v[124:127]
    v_mfma_f32_16x16x32_bf16 v[120:123], a[76:79], v[60:63], v[120:123]
    v_mfma_f32_16x16x32_bf16 v[124:127], a[108:111], v[60:63], v[124:127]
    v_mfma_f32_16x16x32_bf16 v[120:123], a[80:83], v[64:67], v[120:123]
    v_mfma_f32_16x16x32_bf16 v[124:127], a[112:115], v[64:67], v[124:127]
    v_mfma_f32_16x16x32_bf16 v[120:123], a[84:87], v[68:71], v[120:123]
    v_mfma_f32_16x16x32_bf16 v[124:127], a[116:119], v[68:71], v[124:127]
    v_mfma_f32_16x16x32_bf16 v[120:123], a[88:91], v[72:75], v[120:123]
    v_mfma_f32_16x16x32_bf16 v[124:127], a[120:123], v[72:75], v[124:127]
    v_mfma_f32_16x16x32_bf16 v[120:123], a[92:95], v[76:79], v[120:123]
    v_mfma_f32_16x16x32_bf16 v[124:127], a[124:127], v[76:79], v[124:127]
    s_waitcnt lgkmcnt(0)
    v_mfma_f32_16x16x32_bf16 v[112:115], a[0:3], v[80:83], 0
    v_mfma_f32_16x16x32_bf16 v[116:119], a[32:35], v[80:83], 0
    v_cvt_pk_bf16_f32 v132, v120, v121
    v_cvt_pk_bf16_f32 v133, v122, v123
    v_mfma_f32_16x16x32_bf16 v[112:115], a[4:7], v[84:87], v[112:115]
    v_cvt_pk_bf16_f32 v134, v124, v125
    v_cvt_pk_bf16_f32 v135, v126, v127
    v_mfma_f32_16x16x32_bf16 v[116:119], a[36:39], v[84:87], v[116:119]
    v_and_or_b32 v132, v132, -2, s29
    buffer_store_dwordx4 v[132:135], v3, s[4:7], s52 offen offset:64 sc1
    v_mfma_f32_16x16x32_bf16 v[112:115], a[8:11], v[88:91], v[112:115]
    v_mfma_f32_16x16x32_bf16 v[116:119], a[40:43], v[88:91], v[116:119]
    v_mfma_f32_16x16x32_bf16 v[112:115], a[12:15], v[92:95], v[112:115]
    v_mfma_f32_16x16x32_bf16 v[116:119], a[44:47], v[92:95], v[116:119]
    v_mfma_f32_16x16x32_bf16 v[112:115], a[16:19], v[96:99], v[112:115]
    v_mfma_f32_16x16x32_bf16 v[116:119], a[48:51], v[96:99], v[116:119]
    v_mfma_f32_16x16x32_bf16 v[112:115], a[20:23], v[100:103], v[112:115]
    v_mfma_f32_16x16x32_bf16 v[116:119], a[52:55], v[100:103], v[116:119]
    v_mfma_f32_16x16x32_bf16 v[112:115], a[24:27], v[104:107], v[112:115]
    v_mfma_f32_16x16x32_bf16 v[116:119], a[56:59], v[104:107], v[116:119]
    v_mfma_f32_16x16x32_bf16 v[112:115], a[28:31], v[108:111], v[112:115]
    v_mfma_f32_16x16x32_bf16 v[116:119], a[60:63], v[108:111], v[116:119]
    v_mfma_f32_16x16x32_bf16 v[120:123], a[64:67], v[80:83], 0
    v_mfma_f32_16x16x32_bf16 v[124:127], a[96:99], v[80:83], 0
    v_cvt_pk_bf16_f32 v128, v112, v113
    v_cvt_pk_bf16_f32 v129, v114, v115
    v_mfma_f32_16x16x32_bf16 v[120:123], a[68:71], v[84:87], v[120:123]
    v_cvt_pk_bf16_f32 v130, v116, v117
    v_cvt_pk_bf16_f32 v131, v118, v119
    v_mfma_f32_16x16x32_bf16 v[124:127], a[100:103], v[84:87], v[124:127]
    v_and_or_b32 v128, v128, -2, s29
    buffer_store_dwordx4 v[128:131], v3, s[4:7], s54 offen offset:0 sc1
    v_mfma_f32_16x16x32_bf16 v[120:123], a[72:75], v[88:91], v[120:123]
    v_mfma_f32_16x16x32_bf16 v[124:127], a[104:107], v[88:91], v[124:127]
    v_mfma_f32_16x16x32_bf16 v[120:123], a[76:79], v[92:95], v[120:123]
    v_mfma_f32_16x16x32_bf16 v[124:127], a[108:111], v[92:95], v[124:127]
    v_mfma_f32_16x16x32_bf16 v[120:123], a[80:83], v[96:99], v[120:123]
    v_mfma_f32_16x16x32_bf16 v[124:127], a[112:115], v[96:99], v[124:127]
    v_mfma_f32_16x16x32_bf16 v[120:123], a[84:87], v[100:103], v[120:123]
    v_mfma_f32_16x16x32_bf16 v[124:127], a[116:119], v[100:103], v[124:127]
    v_mfma_f32_16x16x32_bf16 v[120:123], a[88:91], v[104:107], v[120:123]
    v_mfma_f32_16x16x32_bf16 v[124:127], a[120:123], v[104:107], v[124:127]
    v_mfma_f32_16x16x32_bf16 v[120:123], a[92:95], v[108:111], v[120:123]
    v_mfma_f32_16x16x32_bf16 v[124:127], a[124:127], v[108:111], v[124:127]
    s_nop 7
    v_cvt_pk_bf16_f32 v132, v120, v121
    v_cvt_pk_bf16_f32 v133, v122, v123
    v_cvt_pk_bf16_f32 v134, v124, v125
    v_cvt_pk_bf16_f32 v135, v126, v127
    v_and_or_b32 v132, v132, -2, s29
    buffer_store_dwordx4 v[132:135], v3, s[4:7], s54 offen offset:64 sc1
    s_sleep 3
    s_mov_b32 s30, 0
TS_r1:
    buffer_load_dwordx4 v[48:51], v1, s[4:7], s53 offen offset:0 sc1
    buffer_load_dwordx4 v[52:55], v1, s[4:7], s53 offen offset:1024 sc1
    buffer_load_dwordx4 v[56:59], v1, s[4:7], s53 offen offset:2048 sc1
    buffer_load_dwordx4 v[60:63], v1, s[4:7], s53 offen offset:3072 sc1
    s_waitcnt vmcnt(3)
    v_mfma_f32_16x16x32_bf16 v[112:115], v[32:35], v[48:51], 0
    v_xor_b32 v38, s29, v48
    s_waitcnt vmcnt(2)
    v_mfma_f32_16x16x32_bf16 v[112:115], v[32:35], v[52:55], v[112:115]
    v_xor_b32 v39, s29, v52
    v_or_b32 v38, v38, v39
    s_waitcnt vmcnt(1)
    v_mfma_f32_16x16x32_bf16 v[112:115], v[32:35], v[56:59], v[112:115]
    v_xor_b32 v39, s29, v56
    v_or_b32 v38, v38, v39
    s_waitcnt vmcnt(0)
    v_mfma_f32_16x16x32_bf16 v[112:115], v[32:35], v[60:63], v[112:115]
    v_xor_b32 v39, s29, v60
    v_or_b32 v38, v38, v39
    v_and_b32 v38, 1, v38
    v_cmp_ne_u32 vcc, 0, v38
    v_lshlrev_b32 v116, 16, v37
    v_and_b32 v117, s17, v37
    s_lshl_b32 s48, s15, 3
    v_mov_b32 v43, s48
    s_cbranch_vccnz TS_r1_f
TS_r1_ok:
    v_cvt_pk_bf16_f32 v38, v112, v113
    v_lshlrev_b32 v112, 16, v38
    v_and_b32 v113, s17, v38
    v_mul_f32 v112, v16, v112
    v_mul_f32 v113, v17, v113
    v_cvt_pk_bf16_f32 v38, v112, v113
    v_lshlrev_b32 v112, 16, v38
    v_and_b32 v113, s17, v38
    v_add_f32 v116, v116, v112
    v_add_f32 v117, v117, v113
    v_cvt_pk_bf16_f32 v118, v116, v117
    v_lshlrev_b32 v116, 16, v118
    v_and_b32 v117, s17, v118
    s_lshl_b32 s49, s55, 16
    s_add_u32 s50, s58, s49
    v_readfirstlane_b32 s51, v116
    s_nop 1
    v_subrev_f32 v112, s51, v116
    v_subrev_f32 v113, s51, v117
    v_add_f32 v120, v112, v113
    v_mul_f32 v121, v112, v112
    v_fmac_f32 v121, v113, v113
    s_nop 0
    v_add_f32_dpp v120, v120, v120 row_ror:1 row_mask:0xf bank_mask:0xf
    v_add_f32_dpp v121, v121, v121 row_ror:1 row_mask:0xf bank_mask:0xf
    s_nop 0
    v_add_f32_dpp v120, v120, v120 row_ror:2 row_mask:0xf bank_mask:0xf
    v_add_f32_dpp v121, v121, v121 row_ror:2 row_mask:0xf bank_mask:0xf
    s_nop 0
    v_add_f32_dpp v120, v120, v120 row_ror:4 row_mask:0xf bank_mask:0xf
    v_add_f32_dpp v121, v121, v121 row_ror:4 row_mask:0xf bank_mask:0xf
    s_nop 0
    v_add_f32_dpp v120, v120, v120 row_ror:8 row_mask:0xf bank_mask:0xf
    v_add_f32_dpp v121, v121, v121 row_ror:8 row_mask:0xf bank_mask:0xf
    v_mov_b32 v122, v120
    v_mov_b32 v123, v121
    s_nop 0
    v_permlane32_swap_b32 v120, v122
    v_permlane32_swap_b32 v121, v123
    v_add_f32 v120, v120, v122
    v_add_f32 v121, v121, v123
    v_mov_b32 v122, v120
    v_mov_b32 v123, v121
    s_nop 0
    v_permlane16_swap_b32 v120, v122
    v_permlane16_swap_b32 v121, v123
    v_add_f32 v120, v120, v122
    v_add_f32 v121, v121, v123
    v_mul_f32 v122, 0x3c000000, v120
    v_fma_f32 v121, -v120, v122, v121
    v_add_f32 v120, s51, v122
    ds_write_b64 v43, v[120:121] offset:16384
    v_mfma_f32_32x32x2_f32 v[80:95], v10, v10, 0
    s_waitcnt lgkmcnt(0)
    s_barrier
    ds_read_b128 v[124:127], v10 offset:16384
    ds_read_b128 v[128:131], v10 offset:16400
    v_mfma_f32_32x32x2_f32 v[80:95], v10, v10, 0
    s_waitcnt lgkmcnt(0)
    v_add_f32 v120, v124, v126
    v_add_f32 v121, v128, v130
    v_add_f32 v120, v120, v121
    v_mul_f32 v120, 0.25, v120
    v_add_f32 v122, v125, v127
    v_add_f32 v123, v129, v131
    v_add_f32 v122, v122, v123
    v_sub_f32 v124, v124, v120
    v_sub_f32 v126, v126, v120
    v_sub_f32 v128, v128, v120
    v_sub_f32 v130, v130, v120
    v_mul_f32 v123, v124, v124
    v_fmac_f32 v123, v126, v126
    v_fmac_f32 v123, v128, v128
    v_fmac_f32 v123, v130, v130
    v_mul_f32 v122, 0x3b000000, v122
    v_fmac_f32 v122, 0.25, v123
    v_cvt_pk_bf16_f32 v120, v120, v120
    v_and_b32 v120, s17, v120
    v_cvt_pk_bf16_f32 v122, v122, v122
    v_and_b32 v122, s17, v122
    v_add_f32 v122, 0x3727c5ac, v122
    v_cvt_pk_bf16_f32 v122, v122, v122
    v_and_b32 v122, s17, v122
    v_sqrt_f32 v122, v122
    v_sub_f32 v112, v116, v120
    v_sub_f32 v113, v117, v120
    v_cvt_pk_bf16_f32 v122, v122, v122
    v_and_b32 v122, s17, v122
    v_rcp_f32 v122, v122
    v_cvt_pk_bf16_f32 v38, v112, v113
    v_lshlrev_b32 v112, 16, v38
    v_and_b32 v113, s17, v38
    v_mul_f32 v112, v112, v122
    v_mul_f32 v113, v113, v122
    v_cvt_pk_bf16_f32 v38, v112, v113
    v_lshlrev_b32 v112, 16, v38
    v_and_b32 v113, s17, v38
    v_mul_f32 v112, v112, v18
    v_mul_f32 v113, v113, v19
    v_cvt_pk_bf16_f32 v38, v112, v113
    v_lshlrev_b32 v112, 16, v38
    v_and_b32 v113, s17, v38
    v_add_f32 v112, v112, v20
    v_add_f32 v113, v113, v21
    v_cvt_pk_bf16_f32 v38, v112, v113
    buffer_store_dword v38, v2, s[4:7], s50 offen sc1
    buffer_store_dword v118, v2, s[4:7], s50 offen offset:1024 sc1
    s_lshl_b32 s48, s56, 16
    s_add_u32 s48, s58, s48
    v_mov_b32 v42, -1
    v_mov_b32 v43, -1
    buffer_store_dword v42, v2, s[4:7], s48 offen sc1
    buffer_store_dword v42, v2, s[4:7], s48 offen offset:1024 sc1
    s_cmp_ge_u32 s28, 46
    s_cselect_b32 s48, 6, 4
    s_add_u32 s77, s28, s48
    s_lshr_b32 s48, s77, 1
    s_cmp_eq_u32 s48, 23
    s_cselect_b32 s48, 4, 0
    s_add_u32 s77, s77, s48
    s_cmp_ge_u32 s14, 28
    s_cbranch_scc1 TS_noffn
    s_add_u32 s50, s57, s49
    s_sleep 4
    s_mov_b32 s30, 0
TS_h2:
    s_add_u32 s48, s50, 0
    buffer_load_dwordx4 v[48:51], v6, s[4:7], s48 offen sc1
    s_add_u32 s48, s50, 8192
    buffer_load_dwordx4 v[52:55], v6, s[4:7], s48 offen sc1
    s_add_u32 s48, s50, 16384
    buffer_load_dwordx4 v[56:59], v6, s[4:7], s48 offen sc1
    s_add_u32 s48, s50, 24576
    buffer_load_dwordx4 v[60:63], v6, s[4:7], s48 offen sc1
    s_add_u32 s48, s50, 32768
    buffer_load_dwordx4 v[64:67], v6, s[4:7], s48 offen sc1
    s_add_u32 s48, s50, 40960
    buffer_load_dwordx4 v[68:71], v6, s[4:7], s48 offen sc1
    s_add_u32 s48, s50, 49152
    buffer_load_dwordx4 v[72:75], v6, s[4:7], s48 offen sc1
    s_add_u32 s48, s50, 57344
    buffer_load_dwordx4 v[76:79], v6, s[4:7], s48 offen sc1
    s_waitcnt vmcnt(7)
    ds_write_b128 v7, v[48:51] offset:0
    s_waitcnt vmcnt(6)
    ds_write_b128 v7, v[52:55] offset:64
    v_max_u32 v38, v48, v52
    s_waitcnt vmcnt(5)
    ds_write_b128 v7, v[56:59] offset:128
    v_max_u32 v38, v38, v56
    s_waitcnt vmcnt(4)
    ds_write_b128 v7, v[60:63] offset:192
    v_max_u32 v38, v38, v60
    s_waitcnt vmcnt(3)
    ds_write_b128 v7, v[64:67] offset:17408
    v_max_u32 v38, v38, v64
    s_waitcnt vmcnt(2)
    ds_write_b128 v7, v[68:71] offset:17472
    v_max_u32 v38, v38, v68
    s_waitcnt vmcnt(1)
    ds_write_b128 v7, v[72:75] offset:17536
    v_max_u32 v38, v38, v72
    s_waitcnt vmcnt(0)
    ds_write_b128 v7, v[76:79] offset:17600
    v_max_u32 v38, v38, v76
    v_cmp_eq_u32 vcc, -1, v38
    s_cbranch_vccnz TS_h2_f
TS_h2_ok:
    s_waitcnt lgkmcnt(0)
    s_barrier
    ds_read_b128 v[80:83], v8 offset:0
    ds_read_b128 v[84:87], v8 offset:17408
    ds_read_b128 v[88:91], v8 offset:1088
    ds_read_b128 v[92:95], v8 offset:18496
    ds_read_b128 v[96:99], v8 offset:2176
    ds_read_b128 v[100:103], v8 offset:19584
    s_cmp_ge_u32 s77, s64
    s_cbranch_scc1 TS_pf1_skip
    s_cmp_gt_u32 s68, s77
    s_cbranch_scc1 TS_pf1_fok
    s_mov_b32 s30, 0
TS_pf1_fl:
    s_mov_b64 exec, 3
    buffer_load_dword v45, v1, s[4:7], s67 offen sc1
    s_mov_b64 exec, -1
    s_waitcnt vmcnt(0)
    v_readlane_b32 s68, v45, 0
    v_readlane_b32 s48, v45, 1
    s_nop 1
    s_min_u32 s68, s68, s48
    s_cmp_gt_u32 s68, s77
    s_cbranch_scc1 TS_pf1_fok
    s_sleep 8
    s_add_u32 s30, s30, 1
    s_cmp_lt_u32 s30, s31
    s_cbranch_scc1 TS_pf1_fl
    s_mov_b32 s31, 1
TS_pf1_fok:
    s_lshl_b32 s48, s77, 14
    s_add_u32 s81, s61, s48
    s_lshl_b32 s48, s77, 13
    s_add_u32 s82, s62, s48
    s_lshl_b32 s48, s77, 15
    s_add_u32 s83, s65, s48
    s_waitcnt lgkmcnt(4)
    v_mfma_f32_16x16x32_bf16 v[112:115], a[128:131], v[80:83], 0
    ds_read_b128 v[104:107], v8 offset:3264
    ds_read_b128 v[108:111], v8 offset:20672
    v_mfma_f32_16x16x32_bf16 v[116:119], a[192:195], v[80:83], 0
    v_mfma_f32_16x16x32_bf16 v[120:123], a[128:131], v[84:87], 0
    s_add_u32 m0, s72, 0
    s_add_u32 s48, s81, 0
    buffer_load_dwordx4 v1, s[4:7], s48 offen offset:0 sc1 lds
    v_mfma_f32_16x16x32_bf16 v[124:127], a[192:195], v[84:87], 0
    s_waitcnt lgkmcnt(4)
    v_mfma_f32_16x16x32_bf16 v[112:115], a[132:135], v[88:91], v[112:115]
    ds_read_b128 v[80:83], v8 offset:4352
    ds_read_b128 v[84:87], v8 offset:21760
    v_mfma_f32_16x16x32_bf16 v[116:119], a[196:199], v[88:91], v[116:119]
    v_mfma_f32_16x16x32_bf16 v[120:123], a[132:135], v[92:95], v[120:123]
    buffer_load_dwordx4 v1, s[4:7], s48 offen offset:1024 sc1 lds
    v_mfma_f32_16x16x32_bf16 v[124:127], a[196:199], v[92:95], v[124:127]
    s_waitcnt lgkmcnt(4)
    v_mfma_f32_16x16x32_bf16 v[112:115], a[136:139], v[96:99], v[112:115]
    ds_read_b128 v[88:91], v8 offset:5440
    ds_read_b128 v[92:95], v8 offset:22848
    v_mfma_f32_16x16x32_bf16 v[116:119], a[200:203], v[96:99], v[116:119]
    v_mfma_f32_16x16x32_bf16 v[120:123], a[136:139], v[100:103], v[120:123]
    buffer_load_dwordx4 v1, s[4:7], s48 offen offset:2048 sc1 lds
    v_mfma_f32_16x16x32_bf16 v[124:127], a[200:203], v[100:103], v[124:127]
    s_waitcnt lgkmcnt(4)
    v_mfma_f32_16x16x32_bf16 v[112:115], a[140:143], v[104:107], v[112:115]
    ds_read_b128 v[96:99], v8 offset:6528
    ds_read_b128 v[100:103], v8 offset:23936
    v_mfma_f32_16x16x32_bf16 v[116:119], a[204:207], v[104:107], v[116:119]
    v_mfma_f32_16x16x32_bf16 v[120:123], a[140:143], v[108:111], v[120:123]
    buffer_load_dwordx4 v1, s[4:7], s48 offen offset:3072 sc1 lds
    v_mfma_f32_16x16x32_bf16 v[124:127], a[204:207], v[108:111], v[124:127]
    s_waitcnt lgkmcnt(4)
    v_mfma_f32_16x16x32_bf16 v[112:115], a[144:147], v[80:83], v[112:115]
    ds_read_b128 v[104:107], v8 offset:7616
    ds_read_b128 v[108:111], v8 offset:25024
    v_mfma_f32_16x16x32_bf16 v[116:119], a[208:211], v[80:83], v[116:119]
    v_mfma_f32_16x16x32_bf16 v[120:123], a[144:147], v[84:87], v[120:123]
    s_add_u32 m0, s72, 4096
    s_add_u32 s48, s81, 4096
    buffer_load_dwordx4 v1, s[4:7], s48 offen offset:0 sc1 lds
    v_mfma_f32_16x16x32_bf16 v[124:127], a[208:211], v[84:87], v[124:127]
    s_waitcnt lgkmcnt(4)
    v_mfma_f32_16x16x32_bf16 v[112:115], a[148:151], v[88:91], v[112:115]
    ds_read_b128 v[80:83], v8 offset:8704
    ds_read_b128 v[84:87], v8 offset:26112
    v_mfma_f32_16x16x32_bf16 v[116:119], a[212:215], v[88:91], v[116:119]
    v_mfma_f32_16x16x32_bf16 v[120:123], a[148:151], v[92:95], v[120:123]
    buffer_load_dwordx4 v1, s[4:7], s48 offen offset:1024 sc1 lds
    v_mfma_f32_16x16x32_bf16 v[124:127], a[212:215], v[92:95], v[124:127]
    s_waitcnt lgkmcnt(4)
    v_mfma_f32_16x16x32_bf16 v[112:115], a[152:155], v[96:99], v[112:115]
    ds_read_b128 v[88:91], v8 offset:9792
    ds_read_b128 v[92:95], v8 offset:27200
    v_mfma_f32_16x16x32_bf16 v[116:119], a[216:219], v[96:99], v[116:119]
    v_mfma_f32_16x16x32_bf16 v[120:123], a[152:155], v[100:103], v[120:123]
    buffer_load_dwordx4 v1, s[4:7], s48 offen offset:2048 sc1 lds
    v_mfma_f32_16x16x32_bf16 v[124:127], a[216:219], v[100:103], v[124:127]
    s_waitcnt lgkmcnt(4)
    v_mfma_f32_16x16x32_bf16 v[112:115], a[156:159], v[104:107], v[112:115]
    ds_read_b128 v[96:99], v8 offset:10880
    ds_read_b128 v[100:103], v8 offset:28288
    v_mfma_f32_16x16x32_bf16 v[116:119], a[220:223], v[104:107], v[116:119]
    v_mfma_f32_16x16x32_bf16 v[120:123], a[156:159], v[108:111], v[120:123]
    buffer_load_dwordx4 v1, s[4:7], s48 offen offset:3072 sc1 lds
    v_mfma_f32_16x16x32_bf16 v[124:127], a[220:223], v[108:111], v[124:127]
    s_waitcnt lgkmcnt(4)
    v_mfma_f32_16x16x32_bf16 v[112:115], a[160:163], v[80:83], v[112:115]
    ds_read_b128 v[104:107], v8 offset:11968
    ds_read_b128 v[108:111], v8 offset:29376
    v_mfma_f32_16x16x32_bf16 v[116:119], a[224:227], v[80:83], v[116:119]
    v_mfma_f32_16x16x32_bf16 v[120:123], a[160:163], v[84:87], v[120:123]
    s_mov_b32 m0, s73
    s_nop 0
    buffer_load_dwordx4 v1, s[4:7], s82 offen offset:0 sc1 lds
    v_mfma_f32_16x16x32_bf16 v[124:127], a[224:227], v[84:87], v[124:127]
    s_waitcnt lgkmcnt(4)
    v_mfma_f32_16x16x32_bf16 v[112:115], a[164:167], v[88:91], v[112:115]
    ds_read_b128 v[80:83], v8 offset:13056
    ds_read_b128 v[84:87], v8 offset:30464
    v_mfma_f32_16x16x32_bf16 v[116:119], a[228:231], v[88:91], v[116:119]
    v_mfma_f32_16x16x32_bf16 v[120:123], a[164:167], v[92:95], v[120:123]
    buffer_load_dwordx4 v1, s[4:7], s82 offen offset:1024 sc1 lds
    v_mfma_f32_16x16x32_bf16 v[124:127], a[228:231], v[92:95], v[124:127]
    s_waitcnt lgkmcnt(4)
    v_mfma_f32_16x16x32_bf16 v[112:115], a[168:171], v[96:99], v[112:115]
    ds_read_b128 v[88:91], v8 offset:14144
    ds_read_b128 v[92:95], v8 offset:31552
    v_mfma_f32_16x16x32_bf16 v[116:119], a[232:235], v[96:99], v[116:119]
    v_mfma_f32_16x16x32_bf16 v[120:123], a[168:171], v[100:103], v[120:123]
    buffer_load_dwordx4 v1, s[4:7], s82 offen offset:2048 sc1 lds
    v_mfma_f32_16x16x32_bf16 v[124:127], a[232:235], v[100:103], v[124:127]
    s_waitcnt lgkmcnt(4)
    v_mfma_f32_16x16x32_bf16 v[112:115], a[172:175], v[104:107], v[112:115]
    ds_read_b128 v[96:99], v8 offset:15232
    ds_read_b128 v[100:103], v8 offset:32640
    v_mfma_f32_16x16x32_bf16 v[116:119], a[236:239], v[104:107], v[116:119]
    v_mfma_f32_16x16x32_bf16 v[120:123], a[172:175], v[108:111], v[120:123]
    buffer_load_dwordx4 v1, s[4:7], s82 offen offset:3072 sc1 lds
    v_mfma_f32_16x16x32_bf16 v[124:127], a[236:239], v[108:111], v[124:127]
    s_waitcnt lgkmcnt(4)
    v_mfma_f32_16x16x32_bf16 v[112:115], a[176:179], v[80:83], v[112:115]
    ds_read_b128 v[104:107], v8 offset:16320
    ds_read_b128 v[108:111], v8 offset:33728
    v_mfma_f32_16x16x32_bf16 v[116:119], a[240:243], v[80:83], v[116:119]
    v_mfma_f32_16x16x32_bf16 v[120:123], a[176:179], v[84:87], v[120:123]
    buffer_load_dword v37, v2, s[20:23], s83 offen
    v_mfma_f32_16x16x32_bf16 v[124:127], a[240:243], v[84:87], v[124:127]
    s_waitcnt lgkmcnt(4)
    v_mfma_f32_16x16x32_bf16 v[112:115], a[180:183], v[88:91], v[112:115]
    v_mfma_f32_16x16x32_bf16 v[116:119], a[244:247], v[88:91], v[116:119]
    v_mfma_f32_16x16x32_bf16 v[120:123], a[180:183], v[92:95], v[120:123]
    v_mfma_f32_16x16x32_bf16 v[124:127], a[244:247], v[92:95], v[124:127]
    s_waitcnt lgkmcnt(2)
    v_mfma_f32_16x16x32_bf16 v[112:115], a[184:187], v[96:99], v[112:115]
    v_mfma_f32_16x16x32_bf16 v[116:119], a[248:251], v[96:99], v[116:119]
    v_mfma_f32_16x16x32_bf16 v[120:123], a[184:187], v[100:103], v[120:123]
    v_mfma_f32_16x16x32_bf16 v[124:127], a[248:251], v[100:103], v[124:127]
    s_waitcnt lgkmcnt(0)
    v_mfma_f32_16x16x32_bf16 v[112:115], a[188:191], v[104:107], v[112:115]
    v_mfma_f32_16x16x32_bf16 v[116:119], a[252:255], v[104:107], v[116:119]
    v_mfma_f32_16x16x32_bf16 v[120:123], a[188:191], v[108:111], v[120:123]
    v_mfma_f32_16x16x32_bf16 v[124:127], a[252:255], v[108:111], v[124:127]
    s_branch TS_gud
TS_pf1_skip:
    s_waitcnt lgkmcnt(4)
    v_mfma_f32_16x16x32_bf16 v[112:115], a[128:131], v[80:83], 0
    ds_read_b128 v[104:107], v8 offset:3264
    ds_read_b128 v[108:111], v8 offset:20672
    v_mfma_f32_16x16x32_bf16 v[116:119], a[192:195], v[80:83], 0
    v_mfma_f32_16x16x32_bf16 v[120:123], a[128:131], v[84:87], 0
    v_mfma_f32_16x16x32_bf16 v[124:127], a[192:195], v[84:87], 0
    s_waitcnt lgkmcnt(4)
    v_mfma_f32_16x16x32_bf16 v[112:115], a[132:135], v[88:91], v[112:115]
    ds_read_b128 v[80:83], v8 offset:4352
    ds_read_b128 v[84:87], v8 offset:21760
    v_mfma_f32_16x16x32_bf16 v[116:119], a[196:199], v[88:91], v[116:119]
    v_mfma_f32_16x16x32_bf16 v[120:123], a[132:135], v[92:95], v[120:123]
    v_mfma_f32_16x16x32_bf16 v[124:127], a[196:199], v[92:95], v[124:127]
    s_waitcnt lgkmcnt(4)
    v_mfma_f32_16x16x32_bf16 v[112:115], a[136:139], v[96:99], v[112:115]
    ds_read_b128 v[88:91], v8 offset:5440
    ds_read_b128 v[92:95], v8 offset:22848
    v_mfma_f32_16x16x32_bf16 v[116:119], a[200:203], v[96:99], v[116:119]
    v_mfma_f32_16x16x32_bf16 v[120:123], a[136:139], v[100:103], v[120:123]
    v_mfma_f32_16x16x32_bf16 v[124:127], a[200:203], v[100:103], v[124:127]
    s_waitcnt lgkmcnt(4)
    v_mfma_f32_16x16x32_bf16 v[112:115], a[140:143], v[104:107], v[112:115]
    ds_read_b128 v[96:99], v8 offset:6528
    ds_read_b128 v[100:103], v8 offset:23936
    v_mfma_f32_16x16x32_bf16 v[116:119], a[204:207], v[104:107], v[116:119]
    v_mfma_f32_16x16x32_bf16 v[120:123], a[140:143], v[108:111], v[120:123]
    v_mfma_f32_16x16x32_bf16 v[124:127], a[204:207], v[108:111], v[124:127]
    s_waitcnt lgkmcnt(4)
    v_mfma_f32_16x16x32_bf16 v[112:115], a[144:147], v[80:83], v[112:115]
    ds_read_b128 v[104:107], v8 offset:7616
    ds_read_b128 v[108:111], v8 offset:25024
    v_mfma_f32_16x16x32_bf16 v[116:119], a[208:211], v[80:83], v[116:119]
    v_mfma_f32_16x16x32_bf16 v[120:123], a[144:147], v[84:87], v[120:123]
    v_mfma_f32_16x16x32_bf16 v[124:127], a[208:211], v[84:87], v[124:127]
    s_waitcnt lgkmcnt(4)
    v_mfma_f32_16x16x32_bf16 v[112:115], a[148:151], v[88:91], v[112:115]
    ds_read_b128 v[80:83], v8 offset:8704
    ds_read_b128 v[84:87], v8 offset:26112
    v_mfma_f32_16x16x32_bf16 v[116:119], a[212:215], v[88:91], v[116:119]
    v_mfma_f32_16x16x32_bf16 v[120:123], a[148:151], v[92:95], v[120:123]
    v_mfma_f32_16x16x32_bf16 v[124:127], a[212:215], v[92:95], v[124:127]
    s_waitcnt lgkmcnt(4)
    v_mfma_f32_16x16x32_bf16 v[112:115], a[152:155], v[96:99], v[112:115]
    ds_read_b128 v[88:91], v8 offset:9792
    ds_read_b128 v[92:95], v8 offset:27200
    v_mfma_f32_16x16x32_bf16 v[116:119], a[216:219], v[96:99], v[116:119]
    v_mfma_f32_16x16x32_bf16 v[120:123], a[152:155], v[100:103], v[120:123]
    v_mfma_f32_16x16x32_bf16 v[124:127], a[216:219], v[100:103], v[124:127]
    s_waitcnt lgkmcnt(4)
    v_mfma_f32_16x16x32_bf16 v[112:115], a[156:159], v[104:107], v[112:115]
    ds_read_b128 v[96:99], v8 offset:10880
    ds_read_b128 v[100:103], v8 offset:28288
    v_mfma_f32_16x16x32_bf16 v[116:119], a[220:223], v[104:107], v[116:119]
    v_mfma_f32_16x16x32_bf16 v[120:123], a[156:159], v[108:111], v[120:123]
    v_mfma_f32_16x16x32_bf16 v[124:127], a[220:223], v[108:111], v[124:127]
    s_waitcnt lgkmcnt(4)
    v_mfma_f32_16x16x32_bf16 v[112:115], a[160:163], v[80:83], v[112:115]
    ds_read_b128 v[104:107], v8 offset:11968
    ds_read_b128 v[108:111], v8 offset:29376
    v_mfma_f32_16x16x32_bf16 v[116:119], a[224:227], v[80:83], v[116:119]
    v_mfma_f32_16x16x32_bf16 v[120:123], a[160:163], v[84:87], v[120:123]
    v_mfma_f32_16x16x32_bf16 v[124:127], a[224:227], v[84:87], v[124:127]
    s_waitcnt lgkmcnt(4)
    v_mfma_f32_16x16x32_bf16 v[112:115], a[164:167], v[88:91], v[112:115]
    ds_read_b128 v[80:83], v8 offset:13056
    ds_read_b128 v[84:87], v8 offset:30464
    v_mfma_f32_16x16x32_bf16 v[116:119], a[228:231], v[88:91], v[116:119]
    v_mfma_f32_16x16x32_bf16 v[120:123], a[164:167], v[92:95], v[120:123]
    v_mfma_f32_16x16x32_bf16 v[124:127], a[228:231], v[92:95], v[124:127]
    s_waitcnt lgkmcnt(4)
    v_mfma_f32_16x16x32_bf16 v[112:115], a[168:171], v[96:99], v[112:115]
    ds_read_b128 v[88:91], v8 offset:14144
    ds_read_b128 v[92:95], v8 offset:31552
    v_mfma_f32_16x16x32_bf16 v[116:119], a[232:235], v[96:99], v[116:119]
    v_mfma_f32_16x16x32_bf16 v[120:123], a[168:171], v[100:103], v[120:123]
    v_mfma_f32_16x16x32_bf16 v[124:127], a[232:235], v[100:103], v[124:127]
    s_waitcnt lgkmcnt(4)
    v_mfma_f32_16x16x32_bf16 v[112:115], a[172:175], v[104:107], v[112:115]
    ds_read_b128 v[96:99], v8 offset:15232
    ds_read_b128 v[100:103], v8 offset:32640
    v_mfma_f32_16x16x32_bf16 v[116:119], a[236:239], v[104:107], v[116:119]
    v_mfma_f32_16x16x32_bf16 v[120:123], a[172:175], v[108:111], v[120:123]
    v_mfma_f32_16x16x32_bf16 v[124:127], a[236:239], v[108:111], v[124:127]
    s_waitcnt lgkmcnt(4)
    v_mfma_f32_16x16x32_bf16 v[112:115], a[176:179], v[80:83], v[112:115]
    ds_read_b128 v[104:107], v8 offset:16320
    ds_read_b128 v[108:111], v8 offset:33728
    v_mfma_f32_16x16x32_bf16 v[116:119], a[240:243], v[80:83], v[116:119]
    v_mfma_f32_16x16x32_bf16 v[120:123], a[176:179], v[84:87], v[120:123]
    v_mfma_f32_16x16x32_bf16 v[124:127], a[240:243], v[84:87], v[124:127]
    s_waitcnt lgkmcnt(4)
    v_mfma_f32_16x16x32_bf16 v[112:115], a[180:183], v[88:91], v[112:115]
    v_mfma_f32_16x16x32_bf16 v[116:119], a[244:247], v[88:91], v[116:119]
    v_mfma_f32_16x16x32_bf16 v[120:123], a[180:183], v[92:95], v[120:123]
    v_mfma_f32_16x16x32_bf16 v[124:127], a[244:247], v[92:95], v[124:127]
    s_waitcnt lgkmcnt(2)
    v_mfma_f32_16x16x32_bf16 v[112:115], a[184:187], v[96:99], v[112:115]
    v_mfma_f32_16x16x32_bf16 v[116:119], a[248:251], v[96:99], v[116:119]
    v_mfma_f32_16x16x32_bf16 v[120:123], a[184:187], v[100:103], v[120:123]
    v_mfma_f32_16x16x32_bf16 v[124:127], a[248:251], v[100:103], v[124:127]
    s_waitcnt lgkmcnt(0)
    v_mfma_f32_16x16x32_bf16 v[112:115], a[188:191], v[104:107], v[112:115]
    v_mfma_f32_16x16x32_bf16 v[116:119], a[252:255], v[104:107], v[116:119]
    v_mfma_f32_16x16x32_bf16 v[120:123], a[188:191], v[108:111], v[120:123]
    v_mfma_f32_16x16x32_bf16 v[124:127], a[252:255], v[108:111], v[124:127]
TS_gud:
    s_lshl_b32 s48, s55, 17
    s_add_u32 s48, s59, s48
    s_add_u32 s50, s48, 57344
    s_nop 0
    v_cvt_pk_bf16_f32 v38, v112, v113
    v_lshlrev_b32 v112, 16, v38
    v_and_b32 v113, s17, v38
    v_cvt_pk_bf16_f32 v38, v114, v115
    v_lshlrev_b32 v114, 16, v38
    v_and_b32 v115, s17, v38
    v_cvt_pk_bf16_f32 v38, v116, v117
    v_lshlrev_b32 v116, 16, v38
    v_and_b32 v117, s17, v38
    v_cvt_pk_bf16_f32 v38, v118, v119
    v_lshlrev_b32 v118, 16, v38
    v_and_b32 v119, s17, v38
    v_mul_f32 v112, v112, v116
    v_mul_f32 v113, v113, v117
    v_mul_f32 v114, v114, v118
    v_mul_f32 v115, v115, v119
    v_cvt_pk_bf16_f32 v128, v112, v113
    v_cvt_pk_bf16_f32 v129, v114, v115
    buffer_store_dwordx2 v[128:129], v1, s[4:7], s48 offen sc1
    v_cvt_pk_bf16_f32 v38, v120, v121
    v_lshlrev_b32 v120, 16, v38
    v_and_b32 v121, s17, v38
    v_cvt_pk_bf16_f32 v38, v122, v123
    v_lshlrev_b32 v122, 16, v38
    v_and_b32 v123, s17, v38
    v_cvt_pk_bf16_f32 v38, v124, v125
    v_lshlrev_b32 v124, 16, v38
    v_and_b32 v125, s17, v38
    v_cvt_pk_bf16_f32 v38, v126, v127
    v_lshlrev_b32 v126, 16, v38
    v_and_b32 v127, s17, v38
    v_mul_f32 v120, v120, v124
    v_mul_f32 v121, v121, v125
    v_mul_f32 v122, v122, v126
    v_mul_f32 v123, v123, v127
    v_cvt_pk_bf16_f32 v130, v120, v121
    v_cvt_pk_bf16_f32 v131, v122, v123
    buffer_store_dwordx2 v[130:131], v1, s[4:7], s50 offen sc1
    s_lshl_b32 s48, s56, 17
    s_add_u32 s48, s59, s48
    s_add_u32 s50, s48, 57344
    buffer_store_dwordx2 v[42:43], v1, s[4:7], s48 offen sc1
    buffer_store_dwordx2 v[42:43], v1, s[4:7], s50 offen sc1
    s_sleep 6
    s_branch TS_E
TS_noffn:
    s_cmp_ge_u32 s77, s64
    s_cbranch_scc1 TS_pf2_skip
    s_cmp_gt_u32 s68, s77
    s_cbranch_scc1 TS_pf2_fok
    s_mov_b32 s30, 0
TS_pf2_fl:
    s_mov_b64 exec, 3
    buffer_load_dword v45, v1, s[4:7], s67 offen sc1
    s_mov_b64 exec, -1
    s_waitcnt vmcnt(0)
    v_readlane_b32 s68, v45, 0
    v_readlane_b32 s48, v45, 1
    s_nop 1
    s_min_u32 s68, s68, s48
    s_cmp_gt_u32 s68, s77
    s_cbranch_scc1 TS_pf2_fok
    s_sleep 8
    s_add_u32 s30, s30, 1
    s_cmp_lt_u32 s30, s31
    s_cbranch_scc1 TS_pf2_fl
    s_mov_b32 s31, 1
TS_pf2_fok:
    s_lshl_b32 s48, s77, 14
    s_add_u32 s81, s61, s48
    s_lshl_b32 s48, s77, 13
    s_add_u32 s82, s62, s48
    s_lshl_b32 s48, s77, 15
    s_add_u32 s83, s65, s48
    s_add_u32 m0, s72, 0
    s_add_u32 s48, s81, 0
    buffer_load_dwordx4 v1, s[4:7], s48 offen offset:0 sc1 lds
    buffer_load_dwordx4 v1, s[4:7], s48 offen offset:1024 sc1 lds
    buffer_load_dwordx4 v1, s[4:7], s48 offen offset:2048 sc1 lds
    buffer_load_dwordx4 v1, s[4:7], s48 offen offset:3072 sc1 lds
    s_add_u32 m0, s72, 4096
    s_add_u32 s48, s81, 4096
    buffer_load_dwordx4 v1, s[4:7], s48 offen offset:0 sc1 lds
    buffer_load_dwordx4 v1, s[4:7], s48 offen offset:1024 sc1 lds
    buffer_load_dwordx4 v1, s[4:7], s48 offen offset:2048 sc1 lds
    buffer_load_dwordx4 v1, s[4:7], s48 offen offset:3072 sc1 lds
    s_mov_b32 m0, s73
    s_nop 0
    buffer_load_dwordx4 v1, s[4:7], s82 offen offset:0 sc1 lds
    buffer_load_dwordx4 v1, s[4:7], s82 offen offset:1024 sc1 lds
    buffer_load_dwordx4 v1, s[4:7], s82 offen offset:2048 sc1 lds
    buffer_load_dwordx4 v1, s[4:7], s82 offen offset:3072 sc1 lds
    buffer_load_dword v37, v2, s[20:23], s83 offen
TS_pf2_skip:
    s_sleep 32
TS_E:
    s_lshl_b32 s50, s55, 17
    s_add_u32 s50, s60, s50
    s_lshl_b32 s49, s55, 16
    s_add_u32 s49, s69, s49
    s_mov_b32 s30, 0
TS_act:
    buffer_load_dword v41, v36, s[4:7], s49 offen sc1
    s_add_u32 s48, s50, 0
    buffer_load_dwordx4 v[48:51], v1, s[4:7], s48 offen offset:0 sc1
    buffer_load_dwordx4 v[52:55], v1, s[4:7], s48 offen offset:1024 sc1
    buffer_load_dwordx4 v[56:59], v1, s[4:7], s48 offen offset:2048 sc1
    buffer_load_dwordx4 v[60:63], v1, s[4:7], s48 offen offset:3072 sc1
    s_add_u32 s48, s50, 4096
    buffer_load_dwordx4 v[64:67], v1, s[4:7], s48 offen offset:0 sc1
    buffer_load_dwordx4 v[68:71], v1, s[4:7], s48 offen offset:1024 sc1
    buffer_load_dwordx4 v[72:75], v1, s[4:7], s48 offen offset:2048 sc1
    buffer_load_dwordx4 v[76:79], v1, s[4:7], s48 offen offset:3072 sc1
    s_add_u32 s48, s50, 8192
    buffer_load_dwordx4 v[80:83], v1, s[4:7], s48 offen offset:0 sc1
    buffer_load_dwordx4 v[84:87], v1, s[4:7], s48 offen offset:1024 sc1
    buffer_load_dwordx4 v[88:91], v1, s[4:7], s48 offen offset:2048 sc1
    buffer_load_dwordx4 v[92:95], v1, s[4:7], s48 offen offset:3072 sc1
    s_add_u32 s48, s50, 12288
    buffer_load_dwordx4 v[96:99], v1, s[4:7], s48 offen offset:0 sc1
    buffer_load_dwordx4 v[100:103], v1, s[4:7], s48 offen offset:1024 sc1
    s_waitcnt vmcnt(13)
    v_mfma_f32_16x16x32_bf16 v[112:115], v[144:147], v[48:51], 0
    v_mfma_f32_16x16x32_bf16 v[116:119], v[200:203], v[48:51], 0
    v_max3_u32 v38, v41, v48, v50
    s_waitcnt vmcnt(12)
    v_mfma_f32_16x16x32_bf16 v[112:115], v[148:151], v[52:55], v[112:115]
    v_mfma_f32_16x16x32_bf16 v[116:119], v[204:207], v[52:55], v[116:119]
    v_max3_u32 v38, v38, v52, v54
    s_waitcnt vmcnt(11)
    v_mfma_f32_16x16x32_bf16 v[112:115], v[152:155], v[56:59], v[112:115]
    v_mfma_f32_16x16x32_bf16 v[116:119], v[208:211], v[56:59], v[116:119]
    v_max3_u32 v38, v38, v56, v58
    s_waitcnt vmcnt(10)
    v_mfma_f32_16x16x32_bf16 v[112:115], v[156:159], v[60:63], v[112:115]
    v_mfma_f32_16x16x32_bf16 v[116:119], v[212:215], v[60:63], v[116:119]
    v_max3_u32 v38, v38, v60, v62
    s_waitcnt vmcnt(9)
    v_mfma_f32_16x16x32_bf16 v[112:115], v[160:163], v[64:67], v[112:115]
    v_mfma_f32_16x16x32_bf16 v[116:119], v[216:219], v[64:67], v[116:119]
    v_max3_u32 v38, v38, v64, v66
    s_waitcnt vmcnt(8)
    v_mfma_f32_16x16x32_bf16 v[112:115], v[164:167], v[68:71], v[112:115]
    v_mfma_f32_16x16x32_bf16 v[116:119], v[220:223], v[68:71], v[116:119]
    v_max3_u32 v38, v38, v68, v70
    s_waitcnt vmcnt(7)
    v_mfma_f32_16x16x32_bf16 v[112:115], v[168:171], v[72:75], v[112:115]
    v_mfma_f32_16x16x32_bf16 v[116:119], v[224:227], v[72:75], v[116:119]
    v_max3_u32 v38, v38, v72, v74
    s_waitcnt vmcnt(6)
    v_mfma_f32_16x16x32_bf16 v[112:115], v[172:175], v[76:79], v[112:115]
    v_mfma_f32_16x16x32_bf16 v[116:119], v[228:231], v[76:79], v[116:119]
    v_max3_u32 v38, v38, v76, v78
    s_waitcnt vmcnt(5)
    v_mfma_f32_16x16x32_bf16 v[112:115], v[176:179], v[80:83], v[112:115]
    v_mfma_f32_16x16x32_bf16 v[116:119], v[232:235], v[80:83], v[116:119]
    v_max3_u32 v38, v38, v80, v82
    s_waitcnt vmcnt(4)
    v_mfma_f32_16x16x32_bf16 v[112:115], v[180:183], v[84:87], v[112:115]
    v_mfma_f32_16x16x32_bf16 v[116:119], v[236:239], v[84:87], v[116:119]
    v_max3_u32 v38, v38, v84, v86
    s_waitcnt vmcnt(3)
    v_mfma_f32_16x16x32_bf16 v[112:115], v[184:187], v[88:91], v[112:115]
    v_mfma_f32_16x16x32_bf16 v[116:119], v[240:243], v[88:91], v[116:119]
    v_max3_u32 v38, v38, v88, v90
    s_waitcnt vmcnt(2)
    v_mfma_f32_16x16x32_bf16 v[112:115], v[188:191], v[92:95], v[112:115]
    v_mfma_f32_16x16x32_bf16 v[116:119], v[244:247], v[92:95], v[116:119]
    v_max3_u32 v38, v38, v92, v94
    s_waitcnt vmcnt(1)
    v_mfma_f32_16x16x32_bf16 v[112:115], v[192:195], v[96:99], v[112:115]
    v_mfma_f32_16x16x32_bf16 v[116:119], v[248:251], v[96:99], v[116:119]
    v_max3_u32 v38, v38, v96, v98
    s_waitcnt vmcnt(0)
    v_mfma_f32_16x16x32_bf16 v[112:115], v[196:199], v[100:103], v[112:115]
    v_mfma_f32_16x16x32_bf16 v[116:119], v[252:255], v[100:103], v[116:119]
    v_max3_u32 v38, v38, v100, v102
    v_cmp_eq_u32 vcc, -1, v38
    v_lshlrev_b32 v124, 16, v41
    v_and_b32 v125, s17, v41
    s_cbranch_vccnz TS_act_f
TS_act_ok:
    s_nop 2
    ds_write_b128 v13, v[112:115]
    ds_write_b128 v13, v[116:119] offset:1024
    v_mfma_f32_32x32x2_f32 v[80:95], v10, v10, 0
    s_waitcnt lgkmcnt(0)
    s_barrier
    ds_read_b64 v[112:113], v14 offset:0
    ds_read_b64 v[114:115], v14 offset:2048
    ds_read_b64 v[116:117], v14 offset:4096
    ds_read_b64 v[118:119], v14 offset:6144
    v_mfma_f32_32x32x2_f32 v[80:95], v10, v10, 0
    s_waitcnt lgkmcnt(0)
    v_add_f32 v112, v112, v114
    v_add_f32 v113, v113, v115
    v_add_f32 v116, v116, v118
    v_add_f32 v117, v117, v119
    v_add_f32 v112, v112, v116
    v_add_f32 v113, v113, v117
    v_cvt_pk_bf16_f32 v38, v112, v113
    v_lshlrev_b32 v112, 16, v38
    v_and_b32 v113, s17, v38
    v_mul_f32 v112, v22, v112
    v_mul_f32 v113, v23, v113
    v_cvt_pk_bf16_f32 v38, v112, v113
    v_lshlrev_b32 v112, 16, v38
    v_and_b32 v113, s17, v38
    v_add_f32 v112, v124, v112
    v_add_f32 v113, v125, v113
    v_cvt_pk_bf16_f32 v38, v112, v113
    buffer_store_dword v38, v15, s[24:27], s66 offen
    s_mov_b32 s28, s77
    s_lshl_b32 s48, s28, 12
    s_add_u32 s63, s78, s48
    s_lshl_b32 s48, s28, 15
    s_add_u32 s66, s79, s48
    s_xor_b32 s29, s29, 1
    s_mov_b32 s56, s55
    s_add_u32 s55, s55, 1
    s_cmp_ge_u32 s55, 3
    s_cselect_b32 s55, 0, s55
    s_cmp_lt_u32 s28, s64
    s_cbranch_scc1 TS_loop
    s_branch TS_fin
TS_km_f:
    s_sleep 3
    buffer_load_dwordx4 v[124:127], v1, s[4:7], s63 offen offset:0 sc1
    buffer_load_dwordx4 v[128:131], v1, s[4:7], s63 offen offset:1024 sc1
    buffer_load_dwordx4 v[132:135], v1, s[4:7], s63 offen offset:2048 sc1
    buffer_load_dwordx4 v[136:139], v1, s[4:7], s63 offen offset:3072 sc1
    s_add_u32 s30, s30, 1
    s_cmp_lt_u32 s30, s31
    s_cbranch_scc1 TS_km
    s_mov_b32 s31, 1
    s_waitcnt vmcnt(0)
    s_branch TS_km_ok
TS_r1_f:
    s_sleep 1
    s_add_u32 s30, s30, 1
    s_cmp_lt_u32 s30, s31
    s_cbranch_scc1 TS_r1
    s_mov_b32 s31, 1
    s_branch TS_r1_ok
TS_h2_f:
    s_sleep 2
    s_add_u32 s30, s30, 1
    s_cmp_lt_u32 s30, s31
    s_cbranch_scc1 TS_h2
    s_mov_b32 s31, 1
    s_branch TS_h2_ok
TS_act_f:
    s_sleep 2
    s_add_u32 s30, s30, 1
    s_cmp_lt_u32 s30, s31
    s_cbranch_scc1 TS_act
    s_mov_b32 s31, 1
    s_branch TS_act_ok
TS_fin:
    s_waitcnt vmcnt(0)
L_done:
L_exit:
    s_endpgm
L_codeend:
.set CODE_BYTES, L_codeend - adaLN_cond__memory_aug_recurrent_mem_tr__glu_gated_bilinear__prompt_kernel - 4
.section .rodata,"a"
.p2align 6
.amdhsa_kernel adaLN_cond__memory_aug_recurrent_mem_tr__glu_gated_bilinear__prompt_kernel
  .amdhsa_next_free_vgpr 512
  .amdhsa_next_free_sgpr 102
  .amdhsa_accum_offset 256
  .amdhsa_group_segment_fixed_size 0
  .amdhsa_kernarg_size 128
  .amdhsa_user_sgpr_count 2
  .amdhsa_user_sgpr_kernarg_segment_ptr 1
  .amdhsa_system_sgpr_workgroup_id_x 1
  .amdhsa_float_denorm_mode_32 3
.end_amdhsa_kernel
```
